```python
import torch

def _softmax(x, axis=-1):
    return torch.softmax(x, dim=axis)
def _gelu(x):
    return torch.nn.functional.gelu(x, approximate="tanh")
def _silu(x):
    return torch.nn.functional.silu(x)
def _sigmoid(x):
    return torch.sigmoid(x)
def _layernorm(x, axis=-1, eps=1e-5):
    m = x.mean(dim=axis, keepdim=True)
    v = x.var(dim=axis, keepdim=True, unbiased=False)
    return (x - m) / torch.sqrt(v + eps)
def _scatter_add(tgt, idx, src, axis=0):
    return tgt.clone().index_add_(axis, idx, src)
def _segment_sum(src, seg, n):
    out = torch.zeros((n,) + src.shape[1:], dtype=src.dtype)
    return out.index_add_(0, seg, src)
def _pad(x, pw):
    flat = tuple(v for pair in reversed(pw) for v in pair)
    return torch.nn.functional.pad(x, flat)

kernel_name = 'parallel_sum__linear_attn_block__glu_gated_bilinear__prompt'

def setup_inputs():

    _w = (lambda a: (lambda t: t.to(torch.bfloat16) if t.is_floating_point() else t)(torch.as_tensor(a)))
    def _A_setup():
        B, S, D = 1, 2048, 640
        return {
            "x": _w((lambda *s: torch.randn(*s, dtype=torch.bfloat16) * 0.05)(B, S, D)),
            "wqkv": _w((lambda *s: torch.randn(*s, dtype=torch.bfloat16) * 0.05)(D, 3 * D)),
            "wo": _w((lambda *s: torch.randn(*s, dtype=torch.bfloat16) * 0.05)(D, D)),
        }
    _A_in = _A_setup()

    def _B_setup():
        B, S, D, F = 1, 2048, 640, 1536
        return {
            "x": _w((lambda *s: torch.randn(*s, dtype=torch.bfloat16) * 0.05)(B, S, D)),
            "w_gate": _w((lambda *s: torch.randn(*s, dtype=torch.bfloat16) * 0.2)(D, F) * (D ** -0.5)),
            "w_up": _w((lambda *s: torch.randn(*s, dtype=torch.bfloat16) * 0.2)(D, F) * (D ** -0.5)),
            "w_down": _w((lambda *s: torch.randn(*s, dtype=torch.bfloat16) * 0.2)(F, D) * (F ** -0.5)),
        }
    _B_in = _B_setup()

    return {
        "A_x": _A_in["x"],
        "A_wqkv": _A_in["wqkv"],
        "A_wo": _A_in["wo"],
        "B_x": _B_in["x"],
        "B_w_gate": _B_in["w_gate"],
        "B_w_up": _B_in["w_up"],
        "B_w_down": _B_in["w_down"],
    }

def reference(A_x, A_wqkv, A_wo, B_x, B_w_gate, B_w_up, B_w_down):
    def _A_ref(x, wqkv, wo):
        B, S, D = x.shape
        H = 32; Dh = D // H
        qkv = (lambda x, *d: x.permute(*d))((x @ wqkv).reshape(B, S, 3, H, Dh), 2, 0, 3, 1, 4)
        q, k, v = qkv[0], qkv[1], qkv[2]
        phi = lambda t: torch.where(t > 0, t + 1, torch.exp(t)) + 1e-6
        pq, pk = phi(q), phi(k)
        kv = torch.einsum("bhsd,bhse->bhde", pk, v)
        z = torch.einsum("bhsd->bhd", pk)
        num = torch.einsum("bhqd,bhde->bhqe", pq, kv)
        den = torch.einsum("bhqd,bhd->bhq", pq, z)[..., None] + 1e-6
        o = num / den
        return (lambda x, *d: x.permute(*d))(o, 0, 2, 1, 3).reshape(B, S, D) @ wo

    def _B_ref(x, w_gate, w_up, w_down):
        g = torch.einsum("bsd,df->bsf", x, w_gate)
        u = torch.einsum("bsd,df->bsf", x, w_up)
        h = g * u
        return torch.einsum("bsf,fd->bsd", h, w_down)

    x = A_x
    xn = _layernorm(x, axis=-1)
    return x + _A_ref(xn, A_wqkv, A_wo) + _B_ref(xn, B_w_gate, B_w_up, B_w_down)
```

```asm
; @launch grid=(256,1,1) block=(512,1,1) lds=163840
.amdgcn_target "amdgcn-amd-amdhsa--gfx950"
.text
.globl parallel_sum__linear_attn_block__glu_gated_bilinear__prompt_kernel
.p2align 8
.type parallel_sum__linear_attn_block__glu_gated_bilinear__prompt_kernel,@function
parallel_sum__linear_attn_block__glu_gated_bilinear__prompt_kernel:
    s_cmp_ge_u32 s2, 256
    s_cbranch_scc1 K_END
    s_load_dwordx16 s[4:19], s[0:1], 0
    s_load_dwordx4 s[20:23], s[0:1], 64
    s_memrealtime s[60:61]
    v_and_b32 v1, 63, v0
    v_lshrrev_b32 v2, 6, v0
    s_and_b32 s27, s2, 7
    s_lshr_b32 s28, s2, 3
    v_readfirstlane_b32 s24, v2
    s_and_b32 s25, s27, 1
    s_lshl_b32 s25, s25, 3
    s_and_b32 s29, s28, 7
    s_add_u32 s25, s25, s29
    s_and_b32 s26, s27, 6
    s_bfe_u32 s29, s28, 0x10003
    s_add_u32 s26, s26, s29
    v_lshlrev_b32 v2, 4, v1
    v_mov_b32 v3, 0
    s_cmp_lg_u32 s24, 3
    s_cbranch_scc1 NO_CPF
    s_getpc_b64 s[62:63]

PC0:
    s_sub_u32 s62, s62, PC0-parallel_sum__linear_attn_block__glu_gated_bilinear__prompt_kernel
    s_subb_u32 s63, s63, 0
    s_lshl_b32 s29, s28, 11
    v_lshl_add_u32 v4, v1, 7, s29
    v_min_u32 v4, K_END-parallel_sum__linear_attn_block__glu_gated_bilinear__prompt_kernel, v4
    s_mov_b64 exec, 0xffff
    global_load_dword v95, v4, s[62:63]
    s_mov_b64 exec, -1

NO_CPF:
    s_lshr_b32 s80, s27, 1
    s_lshl_b32 s80, s80, 3
    s_lshr_b32 s29, s28, 2
    s_add_u32 s80, s80, s29
    s_and_b32 s81, s27, 1
    s_lshl_b32 s81, s81, 2
    s_and_b32 s83, s28, 3
    s_add_u32 s81, s81, s83
    s_lshl_b32 s29, s29, 0
    s_add_u32 s83, s83, s29
    s_mul_i32 s82, s81, 5120
    s_add_u32 s82, s82, 9437184
    s_add_u32 s83, s83, s24
    s_and_b32 s83, s83, 7
    v_lshrrev_b32 v8, 3, v1
    v_mul_u32_u24 v8, 1280, v8
    v_and_b32 v9, 7, v1
    v_lshrrev_b32 v10, 4, v1
    v_xor_b32 v9, v9, v10
    v_lshl_add_u32 v5, v9, 4, v8
    v_xor_b32 v6, 64, v5
    v_add_u32 v6, 10240, v6
    s_mul_i32 s30, s25, 163840
    s_or_b32 s29, s2, s24
    s_waitcnt lgkmcnt(0)
    s_mov_b32 s32, s4
    s_mov_b32 s33, s5
    s_mov_b32 s34, 2621440
    s_mov_b32 s35, 0x20000
    s_mov_b32 s40, s22
    s_mov_b32 s41, s23
    s_mov_b32 s42, 15728640
    s_mov_b32 s43, 0x20000
    s_cmp_lg_u32 s29, 0
    s_cbranch_scc1 NO_TOKEN
    s_or_b32 s60, s60, 1
    v_mov_b32 v8, s60
    v_mov_b32 v9, s61
    s_mov_b64 exec, 1
    global_store_dwordx2 v3, v[8:9], s[20:21] sc1
    s_mov_b64 exec, -1
NO_TOKEN:
    s_cmp_lt_u32 s28, 16
    s_cbranch_scc1 GU
    s_cmp_lt_u32 s24, 4
    s_cbranch_scc1 KV
    s_setprio 0
    s_mov_b32 s36, s6
    s_mov_b32 s37, s7
    s_mov_b32 s38, 2457600
    s_mov_b32 s39, 0x20000
    s_sub_u32 s57, s24, 4
    s_mov_b32 s60, 2097408
    s_mov_b32 s61, 4195072
    s_lshl_b32 s27, s25, 2
    s_lshr_b64 s[60:61], s[60:61], s27
    s_and_b32 s75, s60, 7
    s_lshl_b32 s53, s75, 8
    s_mul_i32 s52, s75, 491520
    s_mul_i32 s27, s57, 40960
    s_add_u32 s27, s27, s30
    v_add_u32 v16, s27, v5
    v_add_u32 v17, s27, v6
    v_add_u32 v18, 20480, v16
    v_add_u32 v19, 20480, v17
    s_lshl_b32 s55, s57, 12
    s_mul_i32 s54, s57, 5120
    s_add_u32 s54, s54, 16384

    s_add_u32 m0, s55, 0
    s_nop 0
    buffer_load_dwordx4 v16, s[32:35], s53 offen lds
    s_add_u32 m0, s55, 1024
    s_nop 0
    buffer_load_dwordx4 v17, s[32:35], s53 offen lds
    s_add_u32 m0, s55, 2048
    s_nop 0
    buffer_load_dwordx4 v18, s[32:35], s53 offen lds
    s_add_u32 m0, s55, 3072
    s_nop 0
    buffer_load_dwordx4 v19, s[32:35], s53 offen lds
    s_add_u32 s53, s53, 128
    s_cmp_ge_u32 s53, 1280
    s_cselect_b32 s53, 0, s53
    s_mul_i32 s27, s57, 61440
    s_mul_i32 s29, s26, 160
    s_add_u32 s27, s27, s29
    s_add_u32 s27, s27, 1280
    v_mov_b32 v46, 1120

    v_add_u32 v40, 0, v1
    v_mul_u32_u24 v41, 3277, v40
    v_lshrrev_b32 v41, 16, v41
    v_mul_u32_u24 v42, 20, v41
    v_sub_u32 v42, v40, v42
    v_bfe_u32 v43, v41, 2, 1
    v_lshlrev_b32 v44, 1, v43
    v_xor_b32 v42, v42, v44
    v_cmp_lt_u32 vcc, 9, v42
    v_and_b32 v44, 3, v41
    v_lshl_add_u32 v44, v43, 3, v44
    v_bfe_u32 v43, v41, 3, 1
    v_lshl_add_u32 v44, v43, 2, v44
    v_mul_u32_u24 v44, 3840, v44
    v_lshl_add_u32 v44, v42, 4, v44
    v_cndmask_b32 v45, 0, v46, vcc
    v_add3_u32 v20, v44, v45, s27

    s_add_u32 m0, s54, 0
    s_nop 0
    buffer_load_dwordx4 v20, s[36:39], s52 offen lds
    v_add_u32 v40, 64, v1
    v_mul_u32_u24 v41, 3277, v40
    v_lshrrev_b32 v41, 16, v41
    v_mul_u32_u24 v42, 20, v41
    v_sub_u32 v42, v40, v42
    v_bfe_u32 v43, v41, 2, 1
    v_lshlrev_b32 v44, 1, v43
    v_xor_b32 v42, v42, v44
    v_cmp_lt_u32 vcc, 9, v42
    v_and_b32 v44, 3, v41
    v_lshl_add_u32 v44, v43, 3, v44
    v_bfe_u32 v43, v41, 3, 1
    v_lshl_add_u32 v44, v43, 2, v44
    v_mul_u32_u24 v44, 3840, v44
    v_lshl_add_u32 v44, v42, 4, v44
    v_cndmask_b32 v45, 0, v46, vcc
    v_add3_u32 v21, v44, v45, s27

    s_add_u32 m0, s54, 1024
    s_nop 0
    buffer_load_dwordx4 v21, s[36:39], s52 offen lds
    v_add_u32 v40, 128, v1
    v_mul_u32_u24 v41, 3277, v40
    v_lshrrev_b32 v41, 16, v41
    v_mul_u32_u24 v42, 20, v41
    v_sub_u32 v42, v40, v42
    v_bfe_u32 v43, v41, 2, 1
    v_lshlrev_b32 v44, 1, v43
    v_xor_b32 v42, v42, v44
    v_cmp_lt_u32 vcc, 9, v42
    v_and_b32 v44, 3, v41
    v_lshl_add_u32 v44, v43, 3, v44
    v_bfe_u32 v43, v41, 3, 1
    v_lshl_add_u32 v44, v43, 2, v44
    v_mul_u32_u24 v44, 3840, v44
    v_lshl_add_u32 v44, v42, 4, v44
    v_cndmask_b32 v45, 0, v46, vcc
    v_add3_u32 v22, v44, v45, s27

    s_add_u32 m0, s54, 2048
    s_nop 0
    buffer_load_dwordx4 v22, s[36:39], s52 offen lds
    v_add_u32 v40, 192, v1
    v_mul_u32_u24 v41, 3277, v40
    v_lshrrev_b32 v41, 16, v41
    v_mul_u32_u24 v42, 20, v41
    v_sub_u32 v42, v40, v42
    v_bfe_u32 v43, v41, 2, 1
    v_lshlrev_b32 v44, 1, v43
    v_xor_b32 v42, v42, v44
    v_cmp_lt_u32 vcc, 9, v42
    v_and_b32 v44, 3, v41
    v_lshl_add_u32 v44, v43, 3, v44
    v_bfe_u32 v43, v41, 3, 1
    v_lshl_add_u32 v44, v43, 2, v44
    v_mul_u32_u24 v44, 3840, v44
    v_lshl_add_u32 v44, v42, 4, v44
    v_cndmask_b32 v45, 0, v46, vcc
    v_add3_u32 v23, v44, v45, s27

    s_add_u32 m0, s54, 3072
    s_nop 0
    buffer_load_dwordx4 v23, s[36:39], s52 offen lds
    v_add_u32 v40, 256, v1
    v_mul_u32_u24 v41, 3277, v40
    v_lshrrev_b32 v41, 16, v41
    v_mul_u32_u24 v42, 20, v41
    v_sub_u32 v42, v40, v42
    v_bfe_u32 v43, v41, 2, 1
    v_lshlrev_b32 v44, 1, v43
    v_xor_b32 v42, v42, v44
    v_cmp_lt_u32 vcc, 9, v42
    v_and_b32 v44, 3, v41
    v_lshl_add_u32 v44, v43, 3, v44
    v_bfe_u32 v43, v41, 3, 1
    v_lshl_add_u32 v44, v43, 2, v44
    v_mul_u32_u24 v44, 3840, v44
    v_lshl_add_u32 v44, v42, 4, v44
    v_cndmask_b32 v45, 0, v46, vcc
    v_add3_u32 v24, v44, v45, s27

    s_add_u32 m0, s54, 4096
    s_nop 0
    buffer_load_dwordx4 v24, s[36:39], s52 offen lds
    s_add_u32 s52, s52, 245760
    s_cmp_ge_u32 s52, 2457600
    s_cselect_b32 s52, 0, s52
    v_and_b32 v40, 15, v1
    v_lshrrev_b32 v41, 4, v1
    v_lshrrev_b32 v30, 1, v40
    v_xor_b32 v30, v30, v41
    v_lshlrev_b32 v30, 4, v30
    v_lshl_add_u32 v30, v40, 7, v30

    s_lshl_b32 s27, s57, 12
    v_add_u32 v30, s27, v30
    v_xor_b32 v31, 64, v30
    v_add_u32 v32, 73728, v30
    v_add_u32 v33, 73728, v31

    s_add_u32 m0, s55, 36864
    s_nop 0
    buffer_load_dwordx4 v16, s[32:35], s53 offen lds
    s_add_u32 m0, s55, 37888
    s_nop 0
    buffer_load_dwordx4 v17, s[32:35], s53 offen lds
    s_add_u32 m0, s55, 38912
    s_nop 0
    buffer_load_dwordx4 v18, s[32:35], s53 offen lds
    s_add_u32 m0, s55, 39936
    s_nop 0
    buffer_load_dwordx4 v19, s[32:35], s53 offen lds
    s_add_u32 s53, s53, 128
    s_cmp_ge_u32 s53, 1280
    s_cselect_b32 s53, 0, s53
    s_add_u32 m0, s54, 36864
    s_nop 0
    buffer_load_dwordx4 v20, s[36:39], s52 offen lds
    s_add_u32 m0, s54, 37888
    s_nop 0
    buffer_load_dwordx4 v21, s[36:39], s52 offen lds
    s_add_u32 m0, s54, 38912
    s_nop 0
    buffer_load_dwordx4 v22, s[36:39], s52 offen lds
    s_add_u32 m0, s54, 39936
    s_nop 0
    buffer_load_dwordx4 v23, s[36:39], s52 offen lds
    s_add_u32 m0, s54, 40960
    s_nop 0
    buffer_load_dwordx4 v24, s[36:39], s52 offen lds
    s_add_u32 s52, s52, 245760
    s_cmp_ge_u32 s52, 2457600
    s_cselect_b32 s52, 0, s52
    s_branch Q_LOOP
GU:
    s_cmp_lt_u32 s24, 4
    s_cbranch_scc1 GC
    s_sub_u32 s57, s24, 4
    s_setprio 1
    s_mov_b32 s60, 2097408
    s_mov_b32 s61, 4195072
    s_lshl_b32 s27, s25, 2
    s_lshr_b64 s[60:61], s[60:61], s27
    s_and_b32 s60, s60, 7
    s_lshl_b32 s53, s60, 8
    s_mul_i32 s52, s60, 393216
    s_mul_i32 s27, s57, 40960
    s_add_u32 s27, s27, s30
    v_add_u32 v8, s27, v5
    v_add_u32 v9, s27, v6
    v_add_u32 v10, 20480, v8
    v_add_u32 v11, 20480, v9
    s_lshl_b32 s55, s57, 12

    s_add_u32 m0, s55, 81920
    s_nop 0
    buffer_load_dwordx4 v8, s[32:35], s53 offen lds
    s_add_u32 m0, s55, 82944
    s_nop 0
    buffer_load_dwordx4 v9, s[32:35], s53 offen lds
    s_add_u32 m0, s55, 83968
    s_nop 0
    buffer_load_dwordx4 v10, s[32:35], s53 offen lds
    s_add_u32 m0, s55, 84992
    s_nop 0
    buffer_load_dwordx4 v11, s[32:35], s53 offen lds
    s_add_u32 s53, s53, 128
    s_cmp_ge_u32 s53, 1280
    s_cselect_b32 s53, 0, s53
    s_cmp_ge_u32 s57, 2
    s_cselect_b32 s36, s14, s12
    s_cselect_b32 s37, s15, s13
    s_mov_b32 s38, 1966080
    s_mov_b32 s39, 0x20000
    s_and_b32 s27, s57, 1
    s_mul_i32 s27, s27, 49152
    s_mul_i32 s29, s26, 384
    s_add_u32 s29, s27, s29
    v_lshrrev_b32 v24, 4, v1
    v_mul_u32_u24 v25, 3072, v24
    v_lshlrev_b32 v24, 5, v24
    v_and_b32 v26, 0xf0, v2
    v_xor_b32 v26, v26, v24
    v_add3_u32 v12, v25, v26, s29
    v_xor_b32 v26, 0x80, v26
    v_add3_u32 v13, v25, v26, s29
    v_add_u32 v13, 24576, v13
    v_add_u32 v14, 12288, v12
    v_add_u32 v15, 12288, v13

    s_add_u32 m0, s55, 32768
    s_nop 0
    buffer_load_dwordx4 v12, s[36:39], s52 offen lds
    s_add_u32 m0, s55, 33792
    s_nop 0
    buffer_load_dwordx4 v13, s[36:39], s52 offen lds
    s_add_u32 m0, s55, 34816
    s_nop 0
    buffer_load_dwordx4 v14, s[36:39], s52 offen lds
    s_add_u32 m0, s55, 35840
    s_nop 0
    buffer_load_dwordx4 v15, s[36:39], s52 offen lds
    s_add_u32 s52, s52, 98304
    s_cmp_ge_u32 s52, 1966080
    s_cselect_b32 s52, 0, s52
    s_add_u32 m0, s55, 49152
    s_nop 0
    buffer_load_dwordx4 v12, s[36:39], s52 offen lds
    s_add_u32 m0, s55, 50176
    s_nop 0
    buffer_load_dwordx4 v13, s[36:39], s52 offen lds
    s_add_u32 m0, s55, 51200
    s_nop 0
    buffer_load_dwordx4 v14, s[36:39], s52 offen lds
    s_add_u32 m0, s55, 52224
    s_nop 0
    buffer_load_dwordx4 v15, s[36:39], s52 offen lds
    s_add_u32 s52, s52, 98304
    s_cmp_ge_u32 s52, 1966080
    s_cselect_b32 s52, 0, s52
    v_bfe_u32 v28, v1, 2, 3
    v_lshrrev_b32 v30, 5, v1
    v_lshl_add_u32 v28, v30, 4, v28
    v_mul_u32_u24 v28, 256, v28

    v_bfe_u32 v29, v1, 2, 3
    v_lshlrev_b32 v29, 5, v29
    v_and_b32 v30, 3, v1
    s_and_b32 s27, s57, 1
    s_lshl_b32 s27, s27, 7
    v_lshl_add_u32 v30, v30, 3, s27
    v_xor_b32 v30, v30, v29
    s_lshr_b32 s27, s57, 1
    s_lshl_b32 s27, s27, 13
    v_add3_u32 v18, v30, v28, s27

    s_add_u32 m0, s55, 65536
    s_nop 0
    buffer_load_dwordx4 v12, s[36:39], s52 offen lds
    s_add_u32 m0, s55, 66560
    s_nop 0
    buffer_load_dwordx4 v13, s[36:39], s52 offen lds
    s_add_u32 m0, s55, 67584
    s_nop 0
    buffer_load_dwordx4 v14, s[36:39], s52 offen lds
    s_add_u32 m0, s55, 68608
    s_nop 0
    buffer_load_dwordx4 v15, s[36:39], s52 offen lds
    s_add_u32 s52, s52, 98304
    s_cmp_ge_u32 s52, 1966080
    s_cselect_b32 s52, 0, s52
    s_add_u32 m0, s55, 98304
    s_nop 0
    buffer_load_dwordx4 v8, s[32:35], s53 offen lds
    s_add_u32 m0, s55, 99328
    s_nop 0
    buffer_load_dwordx4 v9, s[32:35], s53 offen lds
    s_add_u32 m0, s55, 100352
    s_nop 0
    buffer_load_dwordx4 v10, s[32:35], s53 offen lds
    s_add_u32 m0, s55, 101376
    s_nop 0
    buffer_load_dwordx4 v11, s[32:35], s53 offen lds
    s_add_u32 s53, s53, 128
    s_cmp_ge_u32 s53, 1280
    s_cselect_b32 s53, 0, s53
    s_add_u32 m0, s55, 0
    s_nop 0
    buffer_load_dwordx4 v12, s[36:39], s52 offen lds
    s_add_u32 m0, s55, 1024
    s_nop 0
    buffer_load_dwordx4 v13, s[36:39], s52 offen lds
    s_add_u32 m0, s55, 2048
    s_nop 0
    buffer_load_dwordx4 v14, s[36:39], s52 offen lds
    s_add_u32 m0, s55, 3072
    s_nop 0
    buffer_load_dwordx4 v15, s[36:39], s52 offen lds
    s_add_u32 s52, s52, 98304
    s_cmp_ge_u32 s52, 1966080
    s_cselect_b32 s52, 0, s52
    s_branch GU_LOOP
GC:
    s_and_b32 s56, s24, 1
    s_lshr_b32 s57, s24, 1
    v_and_b32 v64, 15, v1
    v_lshrrev_b32 v65, 4, v1
    v_lshrrev_b32 v8, 1, v64
    v_xor_b32 v8, v8, v65
    v_lshlrev_b32 v8, 4, v8
    v_lshl_add_u32 v8, v64, 7, v8

    s_lshl_b32 s27, s56, 13
    s_add_u32 s27, s27, 81920
    v_add_u32 v8, s27, v8
    v_xor_b32 v9, 64, v8
    v_bfe_u32 v68, v1, 2, 3
    v_lshrrev_b32 v70, 5, v1
    v_lshl_add_u32 v68, v70, 4, v68
    v_mul_u32_u24 v68, 256, v68

    v_bfe_u32 v69, v1, 2, 3
    v_lshlrev_b32 v69, 5, v69
    v_and_b32 v70, 3, v1
    s_lshl_b32 s27, s57, 7
    v_lshl_add_u32 v70, v70, 3, s27
    v_xor_b32 v70, v70, v69
    v_add_u32 v12, v70, v68

    v_xor_b32 v13, 32, v12
    v_xor_b32 v14, 64, v12
    v_xor_b32 v15, 96, v12
    v_add_u32 v16, 49152, v12
    v_add_u32 v17, 49152, v13
    v_add_u32 v18, 49152, v14
    v_add_u32 v19, 49152, v15
    s_mul_i32 s72, s83, 245760
    s_add_u32 s72, s72, s82
    s_xor_b32 s27, s83, 4
    s_mul_i32 s73, s27, 245760
    s_add_u32 s73, s73, s82
    s_mul_i32 s77, s27, 786432
    s_mul_i32 s74, s83, 786432
    s_lshl_b32 s27, s80, 12
    s_add_u32 s74, s74, s27
    s_add_u32 s77, s77, s27

    s_mul_i32 s70, s26, 6
    s_lshl_b32 s70, s70, 7
    s_lshl_b32 s29, s25, 3
    s_add_u32 s70, s70, s29
    s_lshl_b32 s29, s56, 2
    s_add_u32 s70, s70, s29
    s_lshl_b32 s70, s70, 10
    s_lshl_b32 s29, s57, 17
    s_add_u32 s71, s70, s29
    s_add_u32 s70, s71, s29
    s_add_u32 s71, s71, 524288
    s_branch GC_LOOP

KV:
    s_lshl_b32 s27, s26, 2
    s_add_u32 s27, s27, s24
    s_mul_i32 s29, s27, 5120
    s_add_u32 s29, s29, s30
    v_lshrrev_b32 v40, 4, v1
    v_mul_u32_u24 v41, 1280, v40
    v_and_b32 v42, 0xf0, v2
    v_add_u32 v41, v41, v42

    buffer_load_dwordx4 v[96:99], v41, s[32:35], s29 offen offset:0
    buffer_load_dwordx4 v[100:103], v41, s[32:35], s29 offen offset:256
    buffer_load_dwordx4 v[104:107], v41, s[32:35], s29 offen offset:512
    buffer_load_dwordx4 v[108:111], v41, s[32:35], s29 offen offset:768
    buffer_load_dwordx4 v[112:115], v41, s[32:35], s29 offen offset:1024
    global_load_dwordx2 v[32:33], v3, s[20:21] sc1
    s_lshl_b32 s69, s27, 6
    s_lshl_b32 s29, s25, 11
    s_add_u32 s69, s69, s29
    s_add_u32 s69, s69, 14155776
    v_lshlrev_b32 v36, 4, v40
    s_and_b32 s56, s24, 1
    s_lshr_b32 s57, s24, 1
    s_lshl_b32 s66, s26, 1
    s_add_u32 s66, s66, s57

    v_and_b32 v40, 15, v1
    v_lshrrev_b32 v41, 4, v1
    v_lshrrev_b32 v8, 1, v40
    v_xor_b32 v8, v8, v41
    v_lshlrev_b32 v8, 4, v8
    v_lshl_add_u32 v8, v40, 7, v8

    s_lshl_b32 s27, s56, 13
    v_add_u32 v8, s27, v8
    v_xor_b32 v9, 64, v8
    v_add_u32 v10, 73728, v8
    v_add_u32 v11, 73728, v9

    v_bfe_u32 v44, v1, 2, 3
    v_lshrrev_b32 v46, 5, v1
    v_lshl_add_u32 v44, v46, 4, v44
    v_mul_u32_u24 v44, 320, v44

    v_add_u32 v44, 16384, v44
    v_bfe_u32 v45, v1, 4, 1
    v_lshlrev_b32 v45, 5, v45
    v_and_b32 v46, 3, v1
    s_mul_i32 s27, s57, 80
    v_lshl_add_u32 v47, v46, 3, s27
    v_and_b32 v28, 1, v46
    v_mul_u32_u24 v28, 40, v28
    v_lshrrev_b32 v29, 1, v46
    v_mul_u32_u24 v29, 160, v29
    v_add3_u32 v28, v28, v29, s27

    v_add_u32 v30, 0, v47
    v_xor_b32 v30, v30, v45
    v_add_u32 v12, v30, v44
    v_add_u32 v13, 73728, v12

    v_add_u32 v30, 40, v47
    v_xor_b32 v30, v30, v45
    v_add_u32 v14, v30, v44
    v_add_u32 v15, 73728, v14

    v_add_u32 v30, 32, v28
    v_xor_b32 v30, v30, v45
    v_add_u32 v16, v30, v44
    v_add_u32 v17, 73728, v16

    v_add_u32 v30, 160, v47
    v_xor_b32 v30, v30, v45
    v_add_u32 v18, v30, v44
    v_add_u32 v19, 73728, v18

    v_add_u32 v30, 200, v47
    v_xor_b32 v30, v30, v45
    v_add_u32 v20, v30, v44
    v_add_u32 v21, 73728, v20

    v_mov_b32 v24, 1065369472
    v_mov_b32 v25, 1065369472
    v_mov_b32 v26, 1065369472
    v_mov_b32 v27, 1065369472
    v_mov_b32 v30, 1
    s_mul_i32 s72, s83, 245760
    s_add_u32 s72, s72, s82
    s_xor_b32 s27, s83, 4
    s_mul_i32 s73, s27, 245760
    s_add_u32 s73, s73, s82
    s_mul_i32 s77, s27, 786432
    s_mul_i32 s74, s83, 786432
    s_lshl_b32 s27, s80, 12
    s_add_u32 s74, s74, s27
    s_add_u32 s77, s77, s27

    s_lshl_b32 s60, s24, 7
    s_lshl_b32 s27, s25, 3
    s_add_u32 s60, s60, s27
    s_add_u32 s60, s60, s26
    s_add_u32 s60, s60, 512
    s_mul_i32 s61, s60, 6554
    s_lshr_b32 s61, s61, 16
    s_mul_i32 s62, s61, 10
    s_sub_u32 s62, s60, s62
    s_mov_b32 s47, 0x20000
    s_mov_b32 s65, 5120
    s_mov_b32 s66, 10240
    s_mov_b32 s71, 1280
    s_cmp_ge_u32 s61, 48
    s_cbranch_scc1 RP_25
    s_mov_b32 s44, s16
    s_mov_b32 s45, s17
    s_mov_b32 s46, 1966080
    s_lshl_b32 s67, s61, 5
    s_mov_b32 s70, 20480
    s_branch RP_28

RP_25:
    s_mov_b32 s44, s8
    s_mov_b32 s45, s9
    s_mov_b32 s46, 819200
    s_cmp_ge_u32 s61, 64
    s_cbranch_scc1 RP_27
    s_sub_u32 s67, s61, 48
    s_mul_i32 s67, s67, 40
    s_mov_b32 s70, 25600
    s_branch RP_28

RP_27:
    s_sub_u32 s67, s61, 64
    s_mul_i32 s67, s67, 160
    s_add_u32 s67, s67, 16
    s_mov_b32 s65, 1280
    s_mov_b32 s66, 102400
    s_mov_b32 s70, 2560
    s_mov_b32 s71, 25600

RP_28:
    s_mul_i32 s67, s67, 1280
    s_lshl_b32 s27, s62, 7
    s_add_u32 s67, s67, s27
    s_mul_i32 s64, s61, 40
    s_lshl_b32 s27, s62, 2
    s_add_u32 s64, s64, s27
    s_lshl_b32 s64, s64, 10
    s_add_u32 s64, s64, 9437184
    s_cmp_ge_u32 s60, 680
    s_cselect_b32 s67, 2130706432, s67
    s_cselect_b32 s64, 2130706432, s64
    v_bfe_u32 v92, v1, 3, 2
    v_mul_lo_u32 v92, v92, s71
    v_lshrrev_b32 v93, 5, v1
    v_mul_lo_u32 v93, v93, s70
    v_add_u32 v92, v92, v93
    v_and_b32 v93, 0x70, v2
    v_add_u32 v92, v92, v93
    s_lshl_b32 s75, s24, 12
    s_add_u32 s75, s75, 147456

    s_mov_b32 s27, s67
    s_add_u32 m0, s75, 0
    s_nop 0
    buffer_load_dwordx4 v92, s[44:47], s27 offen lds
    s_mov_b32 s27, s67
    s_add_u32 s27, s27, s65
    s_add_u32 m0, s75, 1024
    s_nop 0
    buffer_load_dwordx4 v92, s[44:47], s27 offen lds
    s_mov_b32 s27, s67
    s_add_u32 s27, s27, s66
    s_add_u32 m0, s75, 2048
    s_nop 0
    buffer_load_dwordx4 v92, s[44:47], s27 offen lds
    s_mov_b32 s27, s67
    s_add_u32 s27, s27, s65
    s_add_u32 s27, s27, s66
    s_add_u32 m0, s75, 3072
    s_nop 0
    buffer_load_dwordx4 v92, s[44:47], s27 offen lds
    s_lshl_b32 s66, s26, 1
    s_add_u32 s66, s66, s57
    s_waitcnt vmcnt(9)
    v_lshlrev_b32 v176, 16, v96
    v_and_b32 v177, 0xffff0000, v96
    v_mov_b32 v40, v176
    v_mov_b32 v41, v177
    v_lshlrev_b32 v178, 16, v97
    v_and_b32 v179, 0xffff0000, v97
    v_pk_add_f32 v[40:41], v[40:41], v[178:179]
    v_lshlrev_b32 v180, 16, v98
    v_and_b32 v181, 0xffff0000, v98
    v_pk_add_f32 v[40:41], v[40:41], v[180:181]
    v_lshlrev_b32 v182, 16, v99
    v_and_b32 v183, 0xffff0000, v99
    v_pk_add_f32 v[40:41], v[40:41], v[182:183]
    s_waitcnt vmcnt(8)
    v_lshlrev_b32 v184, 16, v100
    v_and_b32 v185, 0xffff0000, v100
    v_pk_add_f32 v[40:41], v[40:41], v[184:185]
    v_lshlrev_b32 v186, 16, v101
    v_and_b32 v187, 0xffff0000, v101
    v_pk_add_f32 v[40:41], v[40:41], v[186:187]
    v_lshlrev_b32 v188, 16, v102
    v_and_b32 v189, 0xffff0000, v102
    v_pk_add_f32 v[40:41], v[40:41], v[188:189]
    v_lshlrev_b32 v190, 16, v103
    v_and_b32 v191, 0xffff0000, v103
    v_pk_add_f32 v[40:41], v[40:41], v[190:191]
    s_waitcnt vmcnt(7)
    v_lshlrev_b32 v192, 16, v104
    v_and_b32 v193, 0xffff0000, v104
    v_pk_add_f32 v[40:41], v[40:41], v[192:193]
    v_lshlrev_b32 v194, 16, v105
    v_and_b32 v195, 0xffff0000, v105
    v_pk_add_f32 v[40:41], v[40:41], v[194:195]
    v_lshlrev_b32 v196, 16, v106
    v_and_b32 v197, 0xffff0000, v106
    v_pk_add_f32 v[40:41], v[40:41], v[196:197]
    v_lshlrev_b32 v198, 16, v107
    v_and_b32 v199, 0xffff0000, v107
    v_pk_add_f32 v[40:41], v[40:41], v[198:199]
    s_waitcnt vmcnt(6)
    v_lshlrev_b32 v200, 16, v108
    v_and_b32 v201, 0xffff0000, v108
    v_pk_add_f32 v[40:41], v[40:41], v[200:201]
    v_lshlrev_b32 v202, 16, v109
    v_and_b32 v203, 0xffff0000, v109
    v_pk_add_f32 v[40:41], v[40:41], v[202:203]
    v_lshlrev_b32 v204, 16, v110
    v_and_b32 v205, 0xffff0000, v110
    v_pk_add_f32 v[40:41], v[40:41], v[204:205]
    v_lshlrev_b32 v206, 16, v111
    v_and_b32 v207, 0xffff0000, v111
    v_pk_add_f32 v[40:41], v[40:41], v[206:207]
    s_waitcnt vmcnt(5)
    v_lshlrev_b32 v208, 16, v112
    v_and_b32 v209, 0xffff0000, v112
    v_pk_add_f32 v[40:41], v[40:41], v[208:209]
    v_lshlrev_b32 v210, 16, v113
    v_and_b32 v211, 0xffff0000, v113
    v_pk_add_f32 v[40:41], v[40:41], v[210:211]
    v_lshlrev_b32 v212, 16, v114
    v_and_b32 v213, 0xffff0000, v114
    v_pk_add_f32 v[40:41], v[40:41], v[212:213]
    v_lshlrev_b32 v214, 16, v115
    v_and_b32 v215, 0xffff0000, v115
    v_pk_add_f32 v[40:41], v[40:41], v[214:215]
    v_add_f32 v40, v40, v41
    s_nop 1
    v_add_f32_dpp v40, v40, v40 row_ror:8 row_mask:0xf bank_mask:0xf
    s_nop 1
    v_add_f32_dpp v40, v40, v40 row_ror:4 row_mask:0xf bank_mask:0xf
    s_nop 1
    v_add_f32_dpp v40, v40, v40 row_ror:2 row_mask:0xf bank_mask:0xf
    s_nop 1
    v_add_f32_dpp v40, v40, v40 row_ror:1 row_mask:0xf bank_mask:0xf
    v_mul_f32 v40, 986500301, v40
    v_mov_b32 v41, v40
    v_mov_b32 v42, 0
    v_mov_b32 v43, 0
    v_pk_add_f32 v[176:177], v[176:177], v[40:41] neg_lo:[0,1] neg_hi:[0,1]
    v_pk_fma_f32 v[42:43], v[176:177], v[176:177], v[42:43]
    v_pk_add_f32 v[178:179], v[178:179], v[40:41] neg_lo:[0,1] neg_hi:[0,1]
    v_pk_fma_f32 v[42:43], v[178:179], v[178:179], v[42:43]
    v_pk_add_f32 v[180:181], v[180:181], v[40:41] neg_lo:[0,1] neg_hi:[0,1]
    v_pk_fma_f32 v[42:43], v[180:181], v[180:181], v[42:43]
    v_pk_add_f32 v[182:183], v[182:183], v[40:41] neg_lo:[0,1] neg_hi:[0,1]
    v_pk_fma_f32 v[42:43], v[182:183], v[182:183], v[42:43]
    v_pk_add_f32 v[184:185], v[184:185], v[40:41] neg_lo:[0,1] neg_hi:[0,1]
    v_pk_fma_f32 v[42:43], v[184:185], v[184:185], v[42:43]
    v_pk_add_f32 v[186:187], v[186:187], v[40:41] neg_lo:[0,1] neg_hi:[0,1]
    v_pk_fma_f32 v[42:43], v[186:187], v[186:187], v[42:43]
    v_pk_add_f32 v[188:189], v[188:189], v[40:41] neg_lo:[0,1] neg_hi:[0,1]
    v_pk_fma_f32 v[42:43], v[188:189], v[188:189], v[42:43]
    v_pk_add_f32 v[190:191], v[190:191], v[40:41] neg_lo:[0,1] neg_hi:[0,1]
    v_pk_fma_f32 v[42:43], v[190:191], v[190:191], v[42:43]
    v_pk_add_f32 v[192:193], v[192:193], v[40:41] neg_lo:[0,1] neg_hi:[0,1]
    v_pk_fma_f32 v[42:43], v[192:193], v[192:193], v[42:43]
    v_pk_add_f32 v[194:195], v[194:195], v[40:41] neg_lo:[0,1] neg_hi:[0,1]
    v_pk_fma_f32 v[42:43], v[194:195], v[194:195], v[42:43]
    v_pk_add_f32 v[196:197], v[196:197], v[40:41] neg_lo:[0,1] neg_hi:[0,1]
    v_pk_fma_f32 v[42:43], v[196:197], v[196:197], v[42:43]
    v_pk_add_f32 v[198:199], v[198:199], v[40:41] neg_lo:[0,1] neg_hi:[0,1]
    v_pk_fma_f32 v[42:43], v[198:199], v[198:199], v[42:43]
    v_pk_add_f32 v[200:201], v[200:201], v[40:41] neg_lo:[0,1] neg_hi:[0,1]
    v_pk_fma_f32 v[42:43], v[200:201], v[200:201], v[42:43]
    v_pk_add_f32 v[202:203], v[202:203], v[40:41] neg_lo:[0,1] neg_hi:[0,1]
    v_pk_fma_f32 v[42:43], v[202:203], v[202:203], v[42:43]
    v_pk_add_f32 v[204:205], v[204:205], v[40:41] neg_lo:[0,1] neg_hi:[0,1]
    v_pk_fma_f32 v[42:43], v[204:205], v[204:205], v[42:43]
    v_pk_add_f32 v[206:207], v[206:207], v[40:41] neg_lo:[0,1] neg_hi:[0,1]
    v_pk_fma_f32 v[42:43], v[206:207], v[206:207], v[42:43]
    v_pk_add_f32 v[208:209], v[208:209], v[40:41] neg_lo:[0,1] neg_hi:[0,1]
    v_pk_fma_f32 v[42:43], v[208:209], v[208:209], v[42:43]
    v_pk_add_f32 v[210:211], v[210:211], v[40:41] neg_lo:[0,1] neg_hi:[0,1]
    v_pk_fma_f32 v[42:43], v[210:211], v[210:211], v[42:43]
    v_pk_add_f32 v[212:213], v[212:213], v[40:41] neg_lo:[0,1] neg_hi:[0,1]
    v_pk_fma_f32 v[42:43], v[212:213], v[212:213], v[42:43]
    v_pk_add_f32 v[214:215], v[214:215], v[40:41] neg_lo:[0,1] neg_hi:[0,1]
    v_pk_fma_f32 v[42:43], v[214:215], v[214:215], v[42:43]
    v_add_f32 v41, v42, v43
    s_nop 1
    v_add_f32_dpp v41, v41, v41 row_ror:8 row_mask:0xf bank_mask:0xf
    s_nop 1
    v_add_f32_dpp v41, v41, v41 row_ror:4 row_mask:0xf bank_mask:0xf
    s_nop 1
    v_add_f32_dpp v41, v41, v41 row_ror:2 row_mask:0xf bank_mask:0xf
    s_nop 1
    v_add_f32_dpp v41, v41, v41 row_ror:1 row_mask:0xf bank_mask:0xf
    v_mul_f32 v41, 986500301, v41
    v_add_f32 v41, 925353388, v41
    v_rsq_f32 v41, v41

    s_waitcnt vmcnt(4)
TOK_29:
    v_readfirstlane_b32 s58, v32
    v_readfirstlane_b32 s59, v33
    s_nop 1
    s_cmp_lg_u32 s58, 0
    s_cbranch_scc1 TOKOK_30
    global_load_dwordx2 v[32:33], v3, s[20:21] sc1
    s_waitcnt vmcnt(0)
    s_branch TOK_29

TOKOK_30:
    v_mov_b32 v42, v32
    v_mov_b32 v43, v33
    s_mov_b32 exec_lo, 0x00010001
    s_mov_b32 exec_hi, 0x00010001

    buffer_store_dwordx4 v[40:43], v36, s[40:43], s69 offen sc1
    s_mov_b64 exec, -1
    s_lshl_b32 s70, s26, 14
    s_lshl_b32 s27, s25, 10
    s_add_u32 s70, s70, s27
    s_lshl_b32 s27, s24, 8
    s_add_u32 s70, s70, s27
    s_add_u32 s70, s70, 14417920
    v_and_b32 v28, 0xf0, v2
    s_branch KV_LOOP

Q_LOOP:
    s_waitcnt vmcnt(9)
    s_barrier
    ds_read_b128 v[96:99], v30 offset:0
    ds_read_b128 v[100:103], v30 offset:2048
    ds_read_b128 v[104:107], v31 offset:0
    ds_read_b128 v[108:111], v31 offset:2048
    s_add_u32 m0, s55, 110592
    s_nop 0
    buffer_load_dwordx4 v16, s[32:35], s53 offen lds
    s_add_u32 m0, s55, 111616
    s_nop 0
    buffer_load_dwordx4 v17, s[32:35], s53 offen lds
    s_add_u32 m0, s55, 112640
    s_nop 0
    buffer_load_dwordx4 v18, s[32:35], s53 offen lds
    s_add_u32 m0, s55, 113664
    s_nop 0
    buffer_load_dwordx4 v19, s[32:35], s53 offen lds
    s_add_u32 s53, s53, 128
    s_cmp_ge_u32 s53, 1280
    s_cselect_b32 s53, 0, s53
    s_add_u32 m0, s54, 110592
    s_nop 0
    buffer_load_dwordx4 v20, s[36:39], s52 offen lds
    s_add_u32 m0, s54, 111616
    s_nop 0
    buffer_load_dwordx4 v21, s[36:39], s52 offen lds
    s_add_u32 m0, s54, 112640
    s_nop 0
    buffer_load_dwordx4 v22, s[36:39], s52 offen lds
    s_add_u32 m0, s54, 113664
    s_nop 0
    buffer_load_dwordx4 v23, s[36:39], s52 offen lds
    s_add_u32 m0, s54, 114688
    s_nop 0
    buffer_load_dwordx4 v24, s[36:39], s52 offen lds
    s_add_u32 s52, s52, 245760
    s_cmp_ge_u32 s52, 2457600
    s_cselect_b32 s52, 0, s52
    s_add_u32 m0, s55, 73728
    s_nop 0
    buffer_load_dwordx4 v16, s[32:35], s53 offen lds
    s_add_u32 m0, s55, 74752
    s_nop 0
    buffer_load_dwordx4 v17, s[32:35], s53 offen lds
    s_waitcnt lgkmcnt(0)
    s_waitcnt vmcnt(11)
    s_barrier
    ds_read_b128 v[112:115], v30 offset:36864
    ds_read_b128 v[116:119], v30 offset:38912
    ds_read_b128 v[120:123], v31 offset:36864
    ds_read_b128 v[124:127], v31 offset:38912
    s_add_u32 m0, s55, 75776
    s_nop 0
    buffer_load_dwordx4 v18, s[32:35], s53 offen lds
    s_add_u32 m0, s55, 76800
    s_nop 0
    buffer_load_dwordx4 v19, s[32:35], s53 offen lds
    s_add_u32 s53, s53, 128
    s_cmp_ge_u32 s53, 1280
    s_cselect_b32 s53, 0, s53
    s_add_u32 m0, s54, 73728
    s_nop 0
    buffer_load_dwordx4 v20, s[36:39], s52 offen lds
    s_add_u32 m0, s54, 74752
    s_nop 0
    buffer_load_dwordx4 v21, s[36:39], s52 offen lds
    s_add_u32 m0, s54, 75776
    s_nop 0
    buffer_load_dwordx4 v22, s[36:39], s52 offen lds
    s_add_u32 m0, s54, 76800
    s_nop 0
    buffer_load_dwordx4 v23, s[36:39], s52 offen lds
    s_add_u32 m0, s54, 77824
    s_nop 0
    buffer_load_dwordx4 v24, s[36:39], s52 offen lds
    s_add_u32 s52, s52, 245760
    s_cmp_ge_u32 s52, 2457600
    s_cselect_b32 s52, 0, s52
    s_add_u32 m0, s55, 0
    s_nop 0
    buffer_load_dwordx4 v16, s[32:35], s53 offen lds
    s_add_u32 m0, s55, 1024
    s_nop 0
    buffer_load_dwordx4 v17, s[32:35], s53 offen lds
    s_add_u32 m0, s55, 2048
    s_nop 0
    buffer_load_dwordx4 v18, s[32:35], s53 offen lds
    s_add_u32 m0, s55, 3072
    s_nop 0
    buffer_load_dwordx4 v19, s[32:35], s53 offen lds
    s_add_u32 s53, s53, 128
    s_cmp_ge_u32 s53, 1280
    s_cselect_b32 s53, 0, s53
    global_load_dwordx2 v[12:13], v3, s[20:21] sc1
    s_waitcnt lgkmcnt(0)
    s_waitcnt vmcnt(14)
    s_barrier
    ds_read_b128 v[128:131], v32 offset:36864
    ds_read_b128 v[132:135], v32 offset:38912
    ds_read_b128 v[136:139], v33 offset:36864
    ds_read_b128 v[140:143], v33 offset:38912
    s_add_u32 m0, s54, 0
    s_nop 0
    buffer_load_dwordx4 v20, s[36:39], s52 offen lds
    s_add_u32 m0, s54, 1024
    s_nop 0
    buffer_load_dwordx4 v21, s[36:39], s52 offen lds
    s_add_u32 m0, s54, 2048
    s_nop 0
    buffer_load_dwordx4 v22, s[36:39], s52 offen lds
    s_add_u32 m0, s54, 3072
    s_nop 0
    buffer_load_dwordx4 v23, s[36:39], s52 offen lds
    s_mul_i32 s29, s26, 160
    s_lshl_b32 s30, s57, 6
    s_lshl_b32 s66, s57, 10
    s_add_u32 s66, s66, 61440

    v_add_u32 v40, 0, v1
    v_add_u32 v40, s30, v40
    v_mul_u32_u24 v41, 6554, v40
    v_lshrrev_b32 v41, 16, v41
    v_mul_u32_u24 v42, 10, v41
    v_sub_u32 v42, v40, v42
    v_and_b32 v44, 0x73, v41
    v_bfe_u32 v43, v41, 2, 1
    v_lshl_add_u32 v44, v43, 3, v44
    v_bfe_u32 v43, v41, 3, 1
    v_lshl_add_u32 v44, v43, 2, v44
    v_mul_u32_u24 v44, 3840, v44
    v_lshl_add_u32 v44, v42, 4, v44
    v_add_u32 v25, s29, v44

    s_add_u32 m0, s54, 4096
    s_nop 0
    buffer_load_dwordx4 v24, s[36:39], s52 offen lds
    s_add_u32 s52, s52, 245760
    s_cmp_ge_u32 s52, 2457600
    s_cselect_b32 s52, 0, s52
    s_add_u32 m0, s55, 36864
    s_nop 0
    buffer_load_dwordx4 v16, s[32:35], s53 offen lds
    s_add_u32 m0, s55, 37888
    s_nop 0
    buffer_load_dwordx4 v17, s[32:35], s53 offen lds
    s_add_u32 m0, s55, 38912
    s_nop 0
    buffer_load_dwordx4 v18, s[32:35], s53 offen lds
    s_add_u32 m0, s55, 39936
    s_nop 0
    buffer_load_dwordx4 v19, s[32:35], s53 offen lds
    s_add_u32 s53, s53, 128
    s_cmp_ge_u32 s53, 1280
    s_cselect_b32 s53, 0, s53
    s_add_u32 m0, s54, 36864
    s_nop 0
    buffer_load_dwordx4 v20, s[36:39], s52 offen lds
    s_add_u32 m0, s54, 37888
    s_nop 0
    buffer_load_dwordx4 v21, s[36:39], s52 offen lds
    s_waitcnt lgkmcnt(0)
    s_waitcnt vmcnt(16)
    s_barrier
    ds_read_b128 v[144:147], v32 offset:0
    ds_read_b128 v[148:151], v32 offset:2048
    ds_read_b128 v[152:155], v33 offset:0
    ds_read_b128 v[156:159], v33 offset:2048
    s_add_u32 m0, s54, 38912
    s_nop 0
    buffer_load_dwordx4 v22, s[36:39], s52 offen lds
    s_add_u32 m0, s54, 39936
    s_nop 0
    buffer_load_dwordx4 v23, s[36:39], s52 offen lds
    s_add_u32 m0, s54, 40960
    s_nop 0
    buffer_load_dwordx4 v24, s[36:39], s52 offen lds
    s_add_u32 s52, s52, 245760
    s_cmp_ge_u32 s52, 2457600
    s_cselect_b32 s52, 0, s52
    s_add_u32 m0, s55, 110592
    s_nop 0
    buffer_load_dwordx4 v16, s[32:35], s53 offen lds
    s_mul_i32 s29, s26, 160
    s_lshl_b32 s30, s57, 6
    s_lshl_b32 s66, s57, 10
    s_add_u32 s66, s66, 61440

    v_add_u32 v40, 256, v1
    v_add_u32 v40, s30, v40
    v_mul_u32_u24 v41, 6554, v40
    v_lshrrev_b32 v41, 16, v41
    v_mul_u32_u24 v42, 10, v41
    v_sub_u32 v42, v40, v42
    v_and_b32 v44, 0x73, v41
    v_bfe_u32 v43, v41, 2, 1
    v_lshl_add_u32 v44, v43, 3, v44
    v_bfe_u32 v43, v41, 3, 1
    v_lshl_add_u32 v44, v43, 2, v44
    v_mul_u32_u24 v44, 3840, v44
    v_lshl_add_u32 v44, v42, 4, v44
    v_add_u32 v26, s29, v44

    s_add_u32 m0, s55, 111616
    s_nop 0
    buffer_load_dwordx4 v17, s[32:35], s53 offen lds
    s_add_u32 m0, s55, 112640
    s_nop 0
    buffer_load_dwordx4 v18, s[32:35], s53 offen lds
    s_add_u32 m0, s55, 113664
    s_nop 0
    buffer_load_dwordx4 v19, s[32:35], s53 offen lds
    s_add_u32 s53, s53, 128
    s_cmp_ge_u32 s53, 1280
    s_cselect_b32 s53, 0, s53
    s_add_u32 m0, s54, 110592
    s_nop 0
    buffer_load_dwordx4 v20, s[36:39], s52 offen lds
    s_add_u32 m0, s54, 111616
    s_nop 0
    buffer_load_dwordx4 v21, s[36:39], s52 offen lds
    s_add_u32 m0, s54, 112640
    s_nop 0
    buffer_load_dwordx4 v22, s[36:39], s52 offen lds
    s_add_u32 m0, s54, 113664
    s_nop 0
    buffer_load_dwordx4 v23, s[36:39], s52 offen lds
    s_waitcnt lgkmcnt(0)
    s_waitcnt vmcnt(17)
    s_barrier
    ds_read_b128 v[160:163], v30 offset:0
    ds_read_b128 v[164:167], v30 offset:2048
    ds_read_b128 v[168:171], v31 offset:0
    ds_read_b128 v[172:175], v31 offset:2048
    s_add_u32 m0, s54, 114688
    s_nop 0
    buffer_load_dwordx4 v24, s[36:39], s52 offen lds
    s_add_u32 s52, s52, 245760
    s_cmp_ge_u32 s52, 2457600
    s_cselect_b32 s52, 0, s52
    s_add_u32 m0, s55, 73728
    s_nop 0
    buffer_load_dwordx4 v16, s[32:35], s53 offen lds
    s_add_u32 m0, s55, 74752
    s_nop 0
    buffer_load_dwordx4 v17, s[32:35], s53 offen lds
    s_add_u32 m0, s55, 75776
    s_nop 0
    buffer_load_dwordx4 v18, s[32:35], s53 offen lds
    s_mul_i32 s29, s26, 160
    s_lshl_b32 s30, s57, 6
    s_lshl_b32 s66, s57, 10
    s_add_u32 s66, s66, 61440

    v_add_u32 v40, 512, v1
    v_add_u32 v40, s30, v40
    v_mul_u32_u24 v41, 6554, v40
    v_lshrrev_b32 v41, 16, v41
    v_mul_u32_u24 v42, 10, v41
    v_sub_u32 v42, v40, v42
    v_and_b32 v44, 0x73, v41
    v_bfe_u32 v43, v41, 2, 1
    v_lshl_add_u32 v44, v43, 3, v44
    v_bfe_u32 v43, v41, 3, 1
    v_lshl_add_u32 v44, v43, 2, v44
    v_mul_u32_u24 v44, 3840, v44
    v_lshl_add_u32 v44, v42, 4, v44
    v_add_u32 v27, s29, v44

    s_add_u32 m0, s55, 76800
    s_nop 0
    buffer_load_dwordx4 v19, s[32:35], s53 offen lds
    s_add_u32 s53, s53, 128
    s_cmp_ge_u32 s53, 1280
    s_cselect_b32 s53, 0, s53
    s_add_u32 m0, s54, 73728
    s_nop 0
    buffer_load_dwordx4 v20, s[36:39], s52 offen lds
    s_add_u32 m0, s54, 74752
    s_nop 0
    buffer_load_dwordx4 v21, s[36:39], s52 offen lds
    s_add_u32 m0, s54, 75776
    s_nop 0
    buffer_load_dwordx4 v22, s[36:39], s52 offen lds
    s_add_u32 m0, s54, 76800
    s_nop 0
    buffer_load_dwordx4 v23, s[36:39], s52 offen lds
    s_add_u32 m0, s54, 77824
    s_nop 0
    buffer_load_dwordx4 v24, s[36:39], s52 offen lds
    s_add_u32 s52, s52, 245760
    s_cmp_ge_u32 s52, 2457600
    s_cselect_b32 s52, 0, s52
    s_waitcnt vmcnt(32)
TOK_39:
    v_readfirstlane_b32 s58, v12
    v_readfirstlane_b32 s59, v13
    s_nop 1
    s_cmp_lg_u32 s58, 0
    s_cbranch_scc1 TOKOK_40
    global_load_dwordx2 v[12:13], v3, s[20:21] sc1
    s_waitcnt vmcnt(0)
    s_branch TOK_39

TOKOK_40:
    s_waitcnt lgkmcnt(0)
    s_waitcnt vmcnt(18)
    s_barrier
    ds_read_b128 v[176:179], v30 offset:36864
    ds_read_b128 v[180:183], v30 offset:38912
    ds_read_b128 v[184:187], v31 offset:36864
    ds_read_b128 v[188:191], v31 offset:38912
    s_add_u32 m0, s55, 0
    s_nop 0
    buffer_load_dwordx4 v16, s[32:35], s53 offen lds
    s_add_u32 m0, s55, 1024
    s_nop 0
    buffer_load_dwordx4 v17, s[32:35], s53 offen lds
    s_add_u32 m0, s55, 2048
    s_nop 0
    buffer_load_dwordx4 v18, s[32:35], s53 offen lds
    s_add_u32 m0, s55, 3072
    s_nop 0
    buffer_load_dwordx4 v19, s[32:35], s53 offen lds
    s_add_u32 s53, s53, 128
    s_cmp_ge_u32 s53, 1280
    s_cselect_b32 s53, 0, s53
    s_mul_i32 s29, s26, 160
    s_lshl_b32 s30, s57, 6
    s_lshl_b32 s66, s57, 10
    s_add_u32 s66, s66, 61440

    v_add_u32 v40, 768, v1
    v_add_u32 v40, s30, v40
    v_mul_u32_u24 v41, 6554, v40
    v_lshrrev_b32 v41, 16, v41
    v_mul_u32_u24 v42, 10, v41
    v_sub_u32 v42, v40, v42
    v_and_b32 v44, 0x73, v41
    v_bfe_u32 v43, v41, 2, 1
    v_lshl_add_u32 v44, v43, 3, v44
    v_bfe_u32 v43, v41, 3, 1
    v_lshl_add_u32 v44, v43, 2, v44
    v_mul_u32_u24 v44, 3840, v44
    v_lshl_add_u32 v44, v42, 4, v44
    v_add_u32 v28, s29, v44

    s_add_u32 m0, s54, 0
    s_nop 0
    buffer_load_dwordx4 v20, s[36:39], s52 offen lds
    s_add_u32 m0, s54, 1024
    s_nop 0
    buffer_load_dwordx4 v21, s[36:39], s52 offen lds
    s_add_u32 m0, s54, 2048
    s_nop 0
    buffer_load_dwordx4 v22, s[36:39], s52 offen lds
    s_add_u32 m0, s54, 3072
    s_nop 0
    buffer_load_dwordx4 v23, s[36:39], s52 offen lds
    s_add_u32 m0, s54, 4096
    s_nop 0
    buffer_load_dwordx4 v24, s[36:39], s52 offen lds
    s_add_u32 s52, s52, 245760
    s_cmp_ge_u32 s52, 2457600
    s_cselect_b32 s52, 0, s52
    s_waitcnt lgkmcnt(0)
    s_waitcnt vmcnt(18)
    s_barrier
    ds_read_b128 v[192:195], v32 offset:36864
    ds_read_b128 v[196:199], v32 offset:38912
    ds_read_b128 v[200:203], v33 offset:36864
    ds_read_b128 v[204:207], v33 offset:38912
    s_add_u32 m0, s55, 36864
    s_nop 0
    buffer_load_dwordx4 v16, s[32:35], s53 offen lds
    s_add_u32 m0, s55, 37888
    s_nop 0
    buffer_load_dwordx4 v17, s[32:35], s53 offen lds
    s_add_u32 m0, s55, 38912
    s_nop 0
    buffer_load_dwordx4 v18, s[32:35], s53 offen lds
    s_add_u32 m0, s55, 39936
    s_nop 0
    buffer_load_dwordx4 v19, s[32:35], s53 offen lds
    s_add_u32 s53, s53, 128
    s_cmp_ge_u32 s53, 1280
    s_cselect_b32 s53, 0, s53
    s_mul_i32 s29, s26, 160
    s_lshl_b32 s30, s57, 6
    s_lshl_b32 s66, s57, 10
    s_add_u32 s66, s66, 61440

    v_add_u32 v40, 1024, v1
    v_add_u32 v40, s30, v40
    v_mul_u32_u24 v41, 6554, v40
    v_lshrrev_b32 v41, 16, v41
    v_mul_u32_u24 v42, 10, v41
    v_sub_u32 v42, v40, v42
    v_and_b32 v44, 0x73, v41
    v_bfe_u32 v43, v41, 2, 1
    v_lshl_add_u32 v44, v43, 3, v44
    v_bfe_u32 v43, v41, 3, 1
    v_lshl_add_u32 v44, v43, 2, v44
    v_mul_u32_u24 v44, 3840, v44
    v_lshl_add_u32 v44, v42, 4, v44
    v_add_u32 v29, s29, v44

    s_add_u32 m0, s54, 36864
    s_nop 0
    buffer_load_dwordx4 v20, s[36:39], s52 offen lds
    s_add_u32 m0, s54, 37888
    s_nop 0
    buffer_load_dwordx4 v21, s[36:39], s52 offen lds
    s_add_u32 m0, s54, 38912
    s_nop 0
    buffer_load_dwordx4 v22, s[36:39], s52 offen lds
    s_add_u32 m0, s54, 39936
    s_nop 0
    buffer_load_dwordx4 v23, s[36:39], s52 offen lds
    s_add_u32 m0, s54, 40960
    s_nop 0
    buffer_load_dwordx4 v24, s[36:39], s52 offen lds
    s_add_u32 s52, s52, 245760
    s_cmp_ge_u32 s52, 2457600
    s_cselect_b32 s52, 0, s52
    s_mul_i32 s72, s83, 245760
    s_add_u32 s72, s72, s82
    s_xor_b32 s27, s83, 4
    s_mul_i32 s73, s27, 245760
    s_add_u32 s73, s73, s82
    s_mul_i32 s77, s27, 786432
    s_mul_i32 s74, s83, 786432
    s_lshl_b32 s27, s80, 12
    s_add_u32 s74, s74, s27
    s_add_u32 s77, s77, s27

    s_waitcnt lgkmcnt(0)
    s_waitcnt vmcnt(18)
    s_barrier
    ds_read_b128 v[208:211], v32 offset:0
    ds_read_b128 v[212:215], v32 offset:2048
    ds_read_b128 v[216:219], v33 offset:0
    ds_read_b128 v[220:223], v33 offset:2048
    s_cmp_lg_u32 s24, 4
    s_cbranch_scc1 OW_41
    s_lshl_b32 s27, s26, 14
    s_add_u32 s27, s27, 14417920
    buffer_load_dwordx4 v[56:59], v2, s[40:43], s27 offen sc1
    s_lshl_b32 s27, s26, 14
    s_add_u32 s27, s27, 14419968
    buffer_load_dwordx4 v[60:63], v2, s[40:43], s27 offen sc1
    s_lshl_b32 s27, s26, 14
    s_add_u32 s27, s27, 14423040
    buffer_load_dwordx4 v[64:67], v2, s[40:43], s27 offen sc1
    s_lshl_b32 s27, s26, 14
    s_add_u32 s27, s27, 14428160
    buffer_load_dwordx4 v[68:71], v2, s[40:43], s27 offen sc1
    s_lshl_b32 s27, s26, 14
    s_add_u32 s27, s27, 14431232
    buffer_load_dwordx4 v[72:75], v2, s[40:43], s27 offen sc1
OW_41:
    s_lshl_b32 s63, s25, 11
    s_lshl_b32 s29, s57, 9
    s_add_u32 s63, s63, s29
    s_add_u32 s63, s63, 14155776
    v_and_b32 v36, 0xf0, v2
    buffer_load_dwordx4 v[4:7], v36, s[40:43], s63 offen offset:0 sc1
    buffer_load_dwordx4 v[8:11], v36, s[40:43], s63 offen offset:256 sc1
    s_add_u32 s30, s75, 4
    s_cmp_ge_u32 s30, 5
    s_cselect_b32 s29, 5, 0
    s_sub_u32 s30, s30, s29
    s_mul_i32 s30, s30, 491520
    s_add_u32 m0, s66, 86016
    s_nop 0
    buffer_load_dwordx4 v26, s[36:39], s30 offen lds
    s_add_u32 m0, s66, 90112
    s_nop 0
    buffer_load_dwordx4 v27, s[36:39], s30 offen lds
    s_add_u32 m0, s66, 94208
    s_nop 0
    buffer_load_dwordx4 v28, s[36:39], s30 offen lds
    s_add_u32 m0, s66, 98304
    s_nop 0
    buffer_load_dwordx4 v29, s[36:39], s30 offen lds
    s_waitcnt lgkmcnt(0)
    s_waitcnt vmcnt(15)
    s_barrier
    ds_read_b128 v[224:227], v30 offset:0
    ds_read_b128 v[228:231], v30 offset:2048
    ds_read_b128 v[232:235], v31 offset:0
    ds_read_b128 v[236:239], v31 offset:2048
    s_add_u32 s30, s75, 3
    s_cmp_ge_u32 s30, 5
    s_cselect_b32 s29, 5, 0
    s_sub_u32 s30, s30, s29
    s_mul_i32 s30, s30, 491520
    s_add_u32 m0, s66, 73728
    s_nop 0
    buffer_load_dwordx4 v28, s[36:39], s30 offen lds
    s_add_u32 m0, s66, 77824
    s_nop 0
    buffer_load_dwordx4 v29, s[36:39], s30 offen lds
    s_add_u32 s30, s75, 4
    s_cmp_ge_u32 s30, 5
    s_cselect_b32 s29, 5, 0
    s_sub_u32 s30, s30, s29
    s_mul_i32 s30, s30, 491520
    s_add_u32 m0, s66, 81920
    s_nop 0
    buffer_load_dwordx4 v25, s[36:39], s30 offen lds
    s_waitcnt lgkmcnt(0)
    s_waitcnt vmcnt(9)
    s_barrier
    ds_read_b128 v[240:243], v30 offset:36864
    ds_read_b128 v[244:247], v30 offset:38912
    ds_read_b128 v[248:251], v31 offset:36864
    ds_read_b128 v[252:255], v31 offset:38912
    s_waitcnt lgkmcnt(0)
    s_waitcnt vmcnt(7)
    v_xor_b32 v34, s58, v6
    v_xor_b32 v35, s58, v10
    v_or_b32 v34, v34, v35
    s_mov_b32 s79, 200000
RT_42:
    v_cmp_ne_u32 vcc, 0, v34
    s_nop 1
    s_cmp_eq_u64 vcc, 0
    s_cbranch_scc1 RTOK_43
    s_sub_u32 s79, s79, 1
    s_cbranch_scc1 RTOK_43
    s_sleep 8

    buffer_load_dwordx4 v[4:7], v36, s[40:43], s63 offen offset:0 sc1
    buffer_load_dwordx4 v[8:11], v36, s[40:43], s63 offen offset:256 sc1
    s_waitcnt vmcnt(0)
    v_xor_b32 v34, s58, v6
    v_xor_b32 v35, s58, v10
    v_or_b32 v34, v34, v35
    s_branch RT_42
RTOK_43:
    s_cmp_lg_u32 s24, 4
    s_cbranch_scc1 OW_44
    v_xor_b32 v34, s58, v59
    v_xor_b32 v35, s58, v63
    v_or_b32 v34, v34, v35
    v_xor_b32 v35, s58, v67
    v_or_b32 v34, v34, v35
    v_xor_b32 v35, s58, v71
    v_or_b32 v34, v34, v35
    v_xor_b32 v35, s58, v75
    v_or_b32 v34, v34, v35
    s_mov_b32 s79, 200000
RT_45:
    v_cmp_ne_u32 vcc, 0, v34
    s_nop 1
    s_cmp_eq_u64 vcc, 0
    s_cbranch_scc1 RTOK_46
    s_sub_u32 s79, s79, 1
    s_cbranch_scc1 RTOK_46
    s_sleep 8

    s_lshl_b32 s27, s26, 14
    s_add_u32 s27, s27, 14417920
    buffer_load_dwordx4 v[56:59], v2, s[40:43], s27 offen sc1
    s_lshl_b32 s27, s26, 14
    s_add_u32 s27, s27, 14419968
    buffer_load_dwordx4 v[60:63], v2, s[40:43], s27 offen sc1
    s_lshl_b32 s27, s26, 14
    s_add_u32 s27, s27, 14423040
    buffer_load_dwordx4 v[64:67], v2, s[40:43], s27 offen sc1
    s_lshl_b32 s27, s26, 14
    s_add_u32 s27, s27, 14428160
    buffer_load_dwordx4 v[68:71], v2, s[40:43], s27 offen sc1
    s_lshl_b32 s27, s26, 14
    s_add_u32 s27, s27, 14431232
    buffer_load_dwordx4 v[72:75], v2, s[40:43], s27 offen sc1
    s_waitcnt vmcnt(0)
    v_xor_b32 v34, s58, v59
    v_xor_b32 v35, s58, v63
    v_or_b32 v34, v34, v35
    v_xor_b32 v35, s58, v67
    v_or_b32 v34, v34, v35
    v_xor_b32 v35, s58, v71
    v_or_b32 v34, v34, v35
    v_xor_b32 v35, s58, v75
    v_or_b32 v34, v34, v35
    s_branch RT_45
RTOK_46:
    v_add_f32 v56, v56, v60
    v_add_f32 v57, v57, v61
    v_add_f32 v58, v58, v62
    v_add_f32 v56, v56, v64
    v_add_f32 v57, v57, v65
    v_add_f32 v58, v58, v66
    v_add_f32 v56, v56, v68
    v_add_f32 v57, v57, v69
    v_add_f32 v58, v58, v70
    v_add_f32 v56, v56, v72
    v_add_f32 v57, v57, v73
    v_add_f32 v58, v58, v74
    ds_write_b128 v2, v[56:59] offset:31744
OW_44:
    v_lshrrev_b32 v42, 2, v36
    s_lshl_b32 s27, s57, 7
    v_add_u32 v42, s27, v42
    v_mul_f32 v6, 1069066811, v5
    v_mul_f32 v10, 1069066811, v9
    v_and_b32 v43, 15, v1
    v_lshlrev_b32 v43, 2, v43
    ds_write_b32 v43, v3 offset:30720

    ds_write_b32 v42, v4 offset:24576
    ds_write_b32 v42, v5 offset:25088
    ds_write_b32 v42, v6 offset:25600
    ds_write_b32 v42, v8 offset:24640
    ds_write_b32 v42, v9 offset:25152
    ds_write_b32 v42, v10 offset:25664
    s_waitcnt lgkmcnt(0)
    s_barrier
    s_branch Q_TAIL
KV_LOOP:
    s_barrier
    ds_read_b128 v[96:99], v8 offset:0
    ds_read_b128 v[100:103], v8 offset:2048
    ds_read_b128 v[104:107], v8 offset:4096
    ds_read_b128 v[108:111], v8 offset:6144
    ds_read_b64_tr_b16 v[128:129], v12 offset:0
    ds_read_b64_tr_b16 v[130:131], v12 offset:2560
    ds_read_b64_tr_b16 v[132:133], v14 offset:0
    ds_read_b64_tr_b16 v[134:135], v14 offset:2560
    ds_read_b64_tr_b16 v[136:137], v16 offset:0
    ds_read_b64_tr_b16 v[138:139], v16 offset:2560
    ds_read_b64_tr_b16 v[140:141], v18 offset:0
    ds_read_b64_tr_b16 v[142:143], v18 offset:2560
    ds_read_b64_tr_b16 v[144:145], v20 offset:0
    ds_read_b64_tr_b16 v[146:147], v20 offset:2560
    s_waitcnt lgkmcnt(0)
    v_mfma_f32_16x16x32_bf16 v[176:179], v[96:99], v[128:131], 0
    ds_read_b128 v[112:115], v9 offset:0
    v_mfma_f32_16x16x32_bf16 v[180:183], v[100:103], v[128:131], 0
    ds_read_b128 v[116:119], v9 offset:2048
    ds_read_b128 v[120:123], v9 offset:4096
    v_mfma_f32_16x16x32_bf16 v[184:187], v[104:107], v[128:131], 0
    ds_read_b128 v[124:127], v9 offset:6144
    v_mfma_f32_16x16x32_bf16 v[188:191], v[108:111], v[128:131], 0
    ds_read_b64_tr_b16 v[148:149], v12 offset:10240
    ds_read_b64_tr_b16 v[150:151], v12 offset:12800
    v_mfma_f32_16x16x32_bf16 v[48:51], v[24:27], v[128:131], 0
    ds_read_b64_tr_b16 v[152:153], v14 offset:10240
    v_mfma_f32_16x16x32_bf16 v[192:195], v[96:99], v[132:135], 0
    ds_read_b64_tr_b16 v[154:155], v14 offset:12800
    ds_read_b64_tr_b16 v[156:157], v16 offset:10240
    v_mfma_f32_16x16x32_bf16 v[196:199], v[100:103], v[132:135], 0
    ds_read_b64_tr_b16 v[158:159], v16 offset:12800
    v_mfma_f32_16x16x32_bf16 v[200:203], v[104:107], v[132:135], 0
    ds_read_b64_tr_b16 v[160:161], v18 offset:10240
    ds_read_b64_tr_b16 v[162:163], v18 offset:12800
    v_mfma_f32_16x16x32_bf16 v[204:207], v[108:111], v[132:135], 0
    ds_read_b64_tr_b16 v[164:165], v20 offset:10240
    ds_read_b64_tr_b16 v[166:167], v20 offset:12800
    v_mfma_f32_16x16x32_bf16 v[52:55], v[24:27], v[132:135], 0
    v_mfma_f32_16x16x32_bf16 v[208:211], v[96:99], v[136:139], 0
    v_mfma_f32_16x16x32_bf16 v[212:215], v[100:103], v[136:139], 0
    v_mfma_f32_16x16x32_bf16 v[216:219], v[104:107], v[136:139], 0
    v_mfma_f32_16x16x32_bf16 v[220:223], v[108:111], v[136:139], 0
    v_mfma_f32_16x16x32_bf16 v[56:59], v[24:27], v[136:139], 0
    v_mfma_f32_16x16x32_bf16 v[224:227], v[96:99], v[140:143], 0
    v_mfma_f32_16x16x32_bf16 v[228:231], v[100:103], v[140:143], 0
    v_mfma_f32_16x16x32_bf16 v[232:235], v[104:107], v[140:143], 0
    v_mfma_f32_16x16x32_bf16 v[236:239], v[108:111], v[140:143], 0
    v_mfma_f32_16x16x32_bf16 v[60:63], v[24:27], v[140:143], 0
    v_mfma_f32_16x16x32_bf16 v[240:243], v[96:99], v[144:147], 0
    v_mfma_f32_16x16x32_bf16 v[244:247], v[100:103], v[144:147], 0
    v_mfma_f32_16x16x32_bf16 v[248:251], v[104:107], v[144:147], 0
    v_mfma_f32_16x16x32_bf16 v[252:255], v[108:111], v[144:147], 0
    v_mfma_f32_16x16x32_bf16 v[64:67], v[24:27], v[144:147], 0
    s_waitcnt lgkmcnt(0)
    s_barrier
    v_mfma_f32_16x16x32_bf16 v[176:179], v[112:115], v[148:151], v[176:179]
    ds_read_b128 v[96:99], v8 offset:36864
    v_mfma_f32_16x16x32_bf16 v[180:183], v[116:119], v[148:151], v[180:183]
    ds_read_b128 v[100:103], v8 offset:38912
    ds_read_b128 v[104:107], v8 offset:40960
    v_mfma_f32_16x16x32_bf16 v[184:187], v[120:123], v[148:151], v[184:187]
    ds_read_b128 v[108:111], v8 offset:43008
    v_mfma_f32_16x16x32_bf16 v[188:191], v[124:127], v[148:151], v[188:191]
    ds_read_b64_tr_b16 v[128:129], v12 offset:36864
    ds_read_b64_tr_b16 v[130:131], v12 offset:39424
    v_mfma_f32_16x16x32_bf16 v[48:51], v[24:27], v[148:151], v[48:51]
    ds_read_b64_tr_b16 v[132:133], v14 offset:36864
    v_mfma_f32_16x16x32_bf16 v[192:195], v[112:115], v[152:155], v[192:195]
    ds_read_b64_tr_b16 v[134:135], v14 offset:39424
    ds_read_b64_tr_b16 v[136:137], v16 offset:36864
    v_mfma_f32_16x16x32_bf16 v[196:199], v[116:119], v[152:155], v[196:199]
    ds_read_b64_tr_b16 v[138:139], v16 offset:39424
    v_mfma_f32_16x16x32_bf16 v[200:203], v[120:123], v[152:155], v[200:203]
    ds_read_b64_tr_b16 v[140:141], v18 offset:36864
    ds_read_b64_tr_b16 v[142:143], v18 offset:39424
    v_mfma_f32_16x16x32_bf16 v[204:207], v[124:127], v[152:155], v[204:207]
    ds_read_b64_tr_b16 v[144:145], v20 offset:36864
    ds_read_b64_tr_b16 v[146:147], v20 offset:39424
    v_mfma_f32_16x16x32_bf16 v[52:55], v[24:27], v[152:155], v[52:55]
    v_mfma_f32_16x16x32_bf16 v[208:211], v[112:115], v[156:159], v[208:211]
    v_mfma_f32_16x16x32_bf16 v[212:215], v[116:119], v[156:159], v[212:215]
    v_mfma_f32_16x16x32_bf16 v[216:219], v[120:123], v[156:159], v[216:219]
    v_mfma_f32_16x16x32_bf16 v[220:223], v[124:127], v[156:159], v[220:223]
    v_mfma_f32_16x16x32_bf16 v[56:59], v[24:27], v[156:159], v[56:59]
    v_mfma_f32_16x16x32_bf16 v[224:227], v[112:115], v[160:163], v[224:227]
    v_mfma_f32_16x16x32_bf16 v[228:231], v[116:119], v[160:163], v[228:231]
    v_mfma_f32_16x16x32_bf16 v[232:235], v[120:123], v[160:163], v[232:235]
    v_mfma_f32_16x16x32_bf16 v[236:239], v[124:127], v[160:163], v[236:239]
    v_mfma_f32_16x16x32_bf16 v[60:63], v[24:27], v[160:163], v[60:63]
    v_mfma_f32_16x16x32_bf16 v[240:243], v[112:115], v[164:167], v[240:243]
    v_mfma_f32_16x16x32_bf16 v[244:247], v[116:119], v[164:167], v[244:247]
    v_mfma_f32_16x16x32_bf16 v[248:251], v[120:123], v[164:167], v[248:251]
    v_mfma_f32_16x16x32_bf16 v[252:255], v[124:127], v[164:167], v[252:255]
    v_mfma_f32_16x16x32_bf16 v[64:67], v[24:27], v[164:167], v[64:67]
    s_waitcnt lgkmcnt(0)
    v_mfma_f32_16x16x32_bf16 v[176:179], v[96:99], v[128:131], v[176:179]
    ds_read_b128 v[112:115], v9 offset:36864
    v_mfma_f32_16x16x32_bf16 v[180:183], v[100:103], v[128:131], v[180:183]
    ds_read_b128 v[116:119], v9 offset:38912
    ds_read_b128 v[120:123], v9 offset:40960
    v_mfma_f32_16x16x32_bf16 v[184:187], v[104:107], v[128:131], v[184:187]
    ds_read_b128 v[124:127], v9 offset:43008
    v_mfma_f32_16x16x32_bf16 v[188:191], v[108:111], v[128:131], v[188:191]
    ds_read_b64_tr_b16 v[148:149], v12 offset:47104
    ds_read_b64_tr_b16 v[150:151], v12 offset:49664
    v_mfma_f32_16x16x32_bf16 v[48:51], v[24:27], v[128:131], v[48:51]
    ds_read_b64_tr_b16 v[152:153], v14 offset:47104
    v_mfma_f32_16x16x32_bf16 v[192:195], v[96:99], v[132:135], v[192:195]
    ds_read_b64_tr_b16 v[154:155], v14 offset:49664
    ds_read_b64_tr_b16 v[156:157], v16 offset:47104
    v_mfma_f32_16x16x32_bf16 v[196:199], v[100:103], v[132:135], v[196:199]
    ds_read_b64_tr_b16 v[158:159], v16 offset:49664
    v_mfma_f32_16x16x32_bf16 v[200:203], v[104:107], v[132:135], v[200:203]
    ds_read_b64_tr_b16 v[160:161], v18 offset:47104
    ds_read_b64_tr_b16 v[162:163], v18 offset:49664
    v_mfma_f32_16x16x32_bf16 v[204:207], v[108:111], v[132:135], v[204:207]
    ds_read_b64_tr_b16 v[164:165], v20 offset:47104
    ds_read_b64_tr_b16 v[166:167], v20 offset:49664
    v_mfma_f32_16x16x32_bf16 v[52:55], v[24:27], v[132:135], v[52:55]
    v_mfma_f32_16x16x32_bf16 v[208:211], v[96:99], v[136:139], v[208:211]
    v_lshrrev_b32 v93, 4, v1
    v_lshlrev_b32 v93, 10, v93
    v_mfma_f32_16x16x32_bf16 v[212:215], v[100:103], v[136:139], v[212:215]
    v_mfma_f32_16x16x32_bf16 v[216:219], v[104:107], v[136:139], v[216:219]
    v_bfe_u32 v94, v1, 2, 2
    v_lshl_add_u32 v93, v94, 7, v93
    v_mfma_f32_16x16x32_bf16 v[220:223], v[108:111], v[136:139], v[220:223]
    v_and_b32 v94, 3, v1
    v_lshl_add_u32 v93, v94, 3, v93
    v_mfma_f32_16x16x32_bf16 v[56:59], v[24:27], v[136:139], v[56:59]
    v_mfma_f32_16x16x32_bf16 v[224:227], v[96:99], v[140:143], v[224:227]
    s_lshl_b32 s75, s24, 12
    s_add_u32 s75, s75, 147456
    v_mfma_f32_16x16x32_bf16 v[228:231], v[100:103], v[140:143], v[228:231]
    v_add_u32 v93, s75, v93
    v_mfma_f32_16x16x32_bf16 v[232:235], v[104:107], v[140:143], v[232:235]
    v_mfma_f32_16x16x32_bf16 v[236:239], v[108:111], v[140:143], v[236:239]
    s_waitcnt vmcnt(1)
    v_mfma_f32_16x16x32_bf16 v[60:63], v[24:27], v[140:143], v[60:63]
    v_mfma_f32_16x16x32_bf16 v[240:243], v[96:99], v[144:147], v[240:243]
    ds_read_b64_tr_b16 v[68:69], v93 offset:0
    ds_read_b64_tr_b16 v[70:71], v93 offset:512
    v_mfma_f32_16x16x32_bf16 v[244:247], v[100:103], v[144:147], v[244:247]
    ds_read_b64_tr_b16 v[72:73], v93 offset:32
    ds_read_b64_tr_b16 v[74:75], v93 offset:544
    v_mfma_f32_16x16x32_bf16 v[248:251], v[104:107], v[144:147], v[248:251]
    v_mfma_f32_16x16x32_bf16 v[252:255], v[108:111], v[144:147], v[252:255]
    ds_read_b64_tr_b16 v[76:77], v93 offset:64
    ds_read_b64_tr_b16 v[78:79], v93 offset:576
    v_mfma_f32_16x16x32_bf16 v[64:67], v[24:27], v[144:147], v[64:67]
    ds_read_b64_tr_b16 v[80:81], v93 offset:96
    ds_read_b64_tr_b16 v[82:83], v93 offset:608
    s_waitcnt lgkmcnt(0)
    s_barrier
    v_mfma_f32_16x16x32_bf16 v[176:179], v[112:115], v[148:151], v[176:179]
    ds_read_b128 v[96:99], v10 offset:36864
    v_mfma_f32_16x16x32_bf16 v[180:183], v[116:119], v[148:151], v[180:183]
    ds_read_b128 v[100:103], v10 offset:38912
    ds_read_b128 v[104:107], v10 offset:40960
    v_mfma_f32_16x16x32_bf16 v[184:187], v[120:123], v[148:151], v[184:187]
    ds_read_b128 v[108:111], v10 offset:43008
    v_mfma_f32_16x16x32_bf16 v[188:191], v[124:127], v[148:151], v[188:191]
    ds_read_b64_tr_b16 v[128:129], v13 offset:36864
    ds_read_b64_tr_b16 v[130:131], v13 offset:39424
    v_mfma_f32_16x16x32_bf16 v[48:51], v[24:27], v[148:151], v[48:51]
    ds_read_b64_tr_b16 v[132:133], v15 offset:36864
    v_mfma_f32_16x16x32_bf16 v[192:195], v[112:115], v[152:155], v[192:195]
    ds_read_b64_tr_b16 v[134:135], v15 offset:39424
    ds_read_b64_tr_b16 v[136:137], v17 offset:36864
    v_mfma_f32_16x16x32_bf16 v[196:199], v[116:119], v[152:155], v[196:199]
    ds_read_b64_tr_b16 v[138:139], v17 offset:39424
    v_mfma_f32_16x16x32_bf16 v[200:203], v[120:123], v[152:155], v[200:203]
    ds_read_b64_tr_b16 v[140:141], v19 offset:36864
    ds_read_b64_tr_b16 v[142:143], v19 offset:39424
    v_mfma_f32_16x16x32_bf16 v[204:207], v[124:127], v[152:155], v[204:207]
    ds_read_b64_tr_b16 v[144:145], v21 offset:36864
    ds_read_b64_tr_b16 v[146:147], v21 offset:39424
    v_mfma_f32_16x16x32_bf16 v[52:55], v[24:27], v[152:155], v[52:55]
    v_mfma_f32_16x16x32_bf16 v[208:211], v[112:115], v[156:159], v[208:211]
    v_mfma_f32_16x16x32_bf16 v[212:215], v[116:119], v[156:159], v[212:215]
    v_mfma_f32_16x16x32_bf16 v[216:219], v[120:123], v[156:159], v[216:219]
    buffer_store_dwordx4 v[68:71], v2, s[40:43], s64 offen offset:0 sc1
    v_mfma_f32_16x16x32_bf16 v[220:223], v[124:127], v[156:159], v[220:223]
    v_mfma_f32_16x16x32_bf16 v[56:59], v[24:27], v[156:159], v[56:59]
    v_mfma_f32_16x16x32_bf16 v[224:227], v[112:115], v[160:163], v[224:227]
    v_mfma_f32_16x16x32_bf16 v[228:231], v[116:119], v[160:163], v[228:231]
    buffer_store_dwordx4 v[72:75], v2, s[40:43], s64 offen offset:1024 sc1
    v_mfma_f32_16x16x32_bf16 v[232:235], v[120:123], v[160:163], v[232:235]
    v_mfma_f32_16x16x32_bf16 v[236:239], v[124:127], v[160:163], v[236:239]
    v_mfma_f32_16x16x32_bf16 v[60:63], v[24:27], v[160:163], v[60:63]
    v_mfma_f32_16x16x32_bf16 v[240:243], v[112:115], v[164:167], v[240:243]
    buffer_store_dwordx4 v[76:79], v2, s[40:43], s64 offen offset:2048 sc1
    v_mfma_f32_16x16x32_bf16 v[244:247], v[116:119], v[164:167], v[244:247]
    v_mfma_f32_16x16x32_bf16 v[248:251], v[120:123], v[164:167], v[248:251]
    v_mfma_f32_16x16x32_bf16 v[252:255], v[124:127], v[164:167], v[252:255]
    v_mfma_f32_16x16x32_bf16 v[64:67], v[24:27], v[164:167], v[64:67]
    buffer_store_dwordx4 v[80:83], v2, s[40:43], s64 offen offset:3072 sc1
    s_waitcnt lgkmcnt(0)
    v_mfma_f32_16x16x32_bf16 v[176:179], v[96:99], v[128:131], v[176:179]
    ds_read_b128 v[112:115], v11 offset:36864
    v_mfma_f32_16x16x32_bf16 v[180:183], v[100:103], v[128:131], v[180:183]
    ds_read_b128 v[116:119], v11 offset:38912
    ds_read_b128 v[120:123], v11 offset:40960
    v_mfma_f32_16x16x32_bf16 v[184:187], v[104:107], v[128:131], v[184:187]
    ds_read_b128 v[124:127], v11 offset:43008
    v_mfma_f32_16x16x32_bf16 v[188:191], v[108:111], v[128:131], v[188:191]
    ds_read_b64_tr_b16 v[148:149], v13 offset:47104
    ds_read_b64_tr_b16 v[150:151], v13 offset:49664
    v_mfma_f32_16x16x32_bf16 v[192:195], v[96:99], v[132:135], v[192:195]
    ds_read_b64_tr_b16 v[152:153], v15 offset:47104
    v_mfma_f32_16x16x32_bf16 v[196:199], v[100:103], v[132:135], v[196:199]
    ds_read_b64_tr_b16 v[154:155], v15 offset:49664
    ds_read_b64_tr_b16 v[156:157], v17 offset:47104
    v_mfma_f32_16x16x32_bf16 v[200:203], v[104:107], v[132:135], v[200:203]
    ds_read_b64_tr_b16 v[158:159], v17 offset:49664
    v_mfma_f32_16x16x32_bf16 v[204:207], v[108:111], v[132:135], v[204:207]
    ds_read_b64_tr_b16 v[160:161], v19 offset:47104
    ds_read_b64_tr_b16 v[162:163], v19 offset:49664
    v_mfma_f32_16x16x32_bf16 v[208:211], v[96:99], v[136:139], v[208:211]
    ds_read_b64_tr_b16 v[164:165], v21 offset:47104
    ds_read_b64_tr_b16 v[166:167], v21 offset:49664
    v_mfma_f32_16x16x32_bf16 v[212:215], v[100:103], v[136:139], v[212:215]
    v_mfma_f32_16x16x32_bf16 v[216:219], v[104:107], v[136:139], v[216:219]
    v_mfma_f32_16x16x32_bf16 v[220:223], v[108:111], v[136:139], v[220:223]
    s_cmp_eq_u32 s56, 0
    s_cselect_b64 vcc, -1, 0
    v_mfma_f32_16x16x32_bf16 v[224:227], v[96:99], v[140:143], v[224:227]
    v_mfma_f32_16x16x32_bf16 v[228:231], v[100:103], v[140:143], v[228:231]
    v_mfma_f32_16x16x32_bf16 v[232:235], v[104:107], v[140:143], v[232:235]
    v_mov_b32 v42, v56
    v_mov_b32 v43, v32
    v_mfma_f32_16x16x32_bf16 v[236:239], v[108:111], v[140:143], v[236:239]
    v_mfma_f32_16x16x32_bf16 v[240:243], v[96:99], v[144:147], v[240:243]
    v_mfma_f32_16x16x32_bf16 v[244:247], v[100:103], v[144:147], v[244:247]
    v_cndmask_b32 v40, v60, v48, vcc
    v_cndmask_b32 v41, v64, v52, vcc
    v_mfma_f32_16x16x32_bf16 v[248:251], v[104:107], v[144:147], v[248:251]
    v_mfma_f32_16x16x32_bf16 v[252:255], v[108:111], v[144:147], v[252:255]
    buffer_store_dwordx4 v[40:43], v28, s[40:43], s70 offen sc1
    s_waitcnt lgkmcnt(0)
    s_barrier
    v_mfma_f32_16x16x32_bf16 v[176:179], v[112:115], v[148:151], v[176:179]
    ds_read_b128 v[96:99], v10 offset:0
    v_mfma_f32_16x16x32_bf16 v[180:183], v[116:119], v[148:151], v[180:183]
    ds_read_b128 v[100:103], v10 offset:2048
    ds_read_b128 v[104:107], v10 offset:4096
    v_mfma_f32_16x16x32_bf16 v[184:187], v[120:123], v[148:151], v[184:187]
    ds_read_b128 v[108:111], v10 offset:6144
    v_mfma_f32_16x16x32_bf16 v[188:191], v[124:127], v[148:151], v[188:191]
    ds_read_b64_tr_b16 v[128:129], v13 offset:0
    ds_read_b64_tr_b16 v[130:131], v13 offset:2560
    v_mfma_f32_16x16x32_bf16 v[192:195], v[112:115], v[152:155], v[192:195]
    ds_read_b64_tr_b16 v[132:133], v15 offset:0
    v_mfma_f32_16x16x32_bf16 v[196:199], v[116:119], v[152:155], v[196:199]
    ds_read_b64_tr_b16 v[134:135], v15 offset:2560
    ds_read_b64_tr_b16 v[136:137], v17 offset:0
    v_mfma_f32_16x16x32_bf16 v[200:203], v[120:123], v[152:155], v[200:203]
    ds_read_b64_tr_b16 v[138:139], v17 offset:2560
    v_mfma_f32_16x16x32_bf16 v[204:207], v[124:127], v[152:155], v[204:207]
    ds_read_b64_tr_b16 v[140:141], v19 offset:0
    ds_read_b64_tr_b16 v[142:143], v19 offset:2560
    v_mfma_f32_16x16x32_bf16 v[208:211], v[112:115], v[156:159], v[208:211]
    ds_read_b64_tr_b16 v[144:145], v21 offset:0
    ds_read_b64_tr_b16 v[146:147], v21 offset:2560
    v_mfma_f32_16x16x32_bf16 v[212:215], v[116:119], v[156:159], v[212:215]
    v_mfma_f32_16x16x32_bf16 v[216:219], v[120:123], v[156:159], v[216:219]
    v_mfma_f32_16x16x32_bf16 v[220:223], v[124:127], v[156:159], v[220:223]
    v_mfma_f32_16x16x32_bf16 v[224:227], v[112:115], v[160:163], v[224:227]
    v_mfma_f32_16x16x32_bf16 v[228:231], v[116:119], v[160:163], v[228:231]
    v_mfma_f32_16x16x32_bf16 v[232:235], v[120:123], v[160:163], v[232:235]
    v_mfma_f32_16x16x32_bf16 v[236:239], v[124:127], v[160:163], v[236:239]
    v_mfma_f32_16x16x32_bf16 v[240:243], v[112:115], v[164:167], v[240:243]
    v_mfma_f32_16x16x32_bf16 v[244:247], v[116:119], v[164:167], v[244:247]
    v_mfma_f32_16x16x32_bf16 v[248:251], v[120:123], v[164:167], v[248:251]
    v_mfma_f32_16x16x32_bf16 v[252:255], v[124:127], v[164:167], v[252:255]
    s_waitcnt lgkmcnt(0)
    v_mfma_f32_16x16x32_bf16 v[176:179], v[96:99], v[128:131], v[176:179]
    ds_read_b128 v[112:115], v11 offset:0
    v_mfma_f32_16x16x32_bf16 v[180:183], v[100:103], v[128:131], v[180:183]
    ds_read_b128 v[116:119], v11 offset:2048
    ds_read_b128 v[120:123], v11 offset:4096
    v_mfma_f32_16x16x32_bf16 v[184:187], v[104:107], v[128:131], v[184:187]
    ds_read_b128 v[124:127], v11 offset:6144
    v_mfma_f32_16x16x32_bf16 v[188:191], v[108:111], v[128:131], v[188:191]
    ds_read_b64_tr_b16 v[148:149], v13 offset:10240
    ds_read_b64_tr_b16 v[150:151], v13 offset:12800
    v_mfma_f32_16x16x32_bf16 v[192:195], v[96:99], v[132:135], v[192:195]
    ds_read_b64_tr_b16 v[152:153], v15 offset:10240
    v_mfma_f32_16x16x32_bf16 v[196:199], v[100:103], v[132:135], v[196:199]
    ds_read_b64_tr_b16 v[154:155], v15 offset:12800
    ds_read_b64_tr_b16 v[156:157], v17 offset:10240
    v_mfma_f32_16x16x32_bf16 v[200:203], v[104:107], v[132:135], v[200:203]
    ds_read_b64_tr_b16 v[158:159], v17 offset:12800
    v_mfma_f32_16x16x32_bf16 v[204:207], v[108:111], v[132:135], v[204:207]
    ds_read_b64_tr_b16 v[160:161], v19 offset:10240
    ds_read_b64_tr_b16 v[162:163], v19 offset:12800
    v_mfma_f32_16x16x32_bf16 v[208:211], v[96:99], v[136:139], v[208:211]
    ds_read_b64_tr_b16 v[164:165], v21 offset:10240
    ds_read_b64_tr_b16 v[166:167], v21 offset:12800
    v_mfma_f32_16x16x32_bf16 v[212:215], v[100:103], v[136:139], v[212:215]
    v_mfma_f32_16x16x32_bf16 v[216:219], v[104:107], v[136:139], v[216:219]
    v_mfma_f32_16x16x32_bf16 v[220:223], v[108:111], v[136:139], v[220:223]
    v_mfma_f32_16x16x32_bf16 v[224:227], v[96:99], v[140:143], v[224:227]
    v_mfma_f32_16x16x32_bf16 v[228:231], v[100:103], v[140:143], v[228:231]
    v_mfma_f32_16x16x32_bf16 v[232:235], v[104:107], v[140:143], v[232:235]
    v_mfma_f32_16x16x32_bf16 v[236:239], v[108:111], v[140:143], v[236:239]
    v_mfma_f32_16x16x32_bf16 v[240:243], v[96:99], v[144:147], v[240:243]
    v_mfma_f32_16x16x32_bf16 v[244:247], v[100:103], v[144:147], v[244:247]
    v_mfma_f32_16x16x32_bf16 v[248:251], v[104:107], v[144:147], v[248:251]
    v_mfma_f32_16x16x32_bf16 v[252:255], v[108:111], v[144:147], v[252:255]
    s_waitcnt lgkmcnt(0)
    s_barrier
    v_mfma_f32_16x16x32_bf16 v[176:179], v[112:115], v[148:151], v[176:179]
    ds_read_b128 v[96:99], v8 offset:0
    v_mfma_f32_16x16x32_bf16 v[180:183], v[116:119], v[148:151], v[180:183]
    ds_read_b128 v[100:103], v8 offset:2048
    ds_read_b128 v[104:107], v8 offset:4096
    v_mfma_f32_16x16x32_bf16 v[184:187], v[120:123], v[148:151], v[184:187]
    ds_read_b128 v[108:111], v8 offset:6144
    v_mfma_f32_16x16x32_bf16 v[188:191], v[124:127], v[148:151], v[188:191]
    ds_read_b64_tr_b16 v[128:129], v12 offset:0
    ds_read_b64_tr_b16 v[130:131], v12 offset:2560
    v_mfma_f32_16x16x32_bf16 v[192:195], v[112:115], v[152:155], v[192:195]
    ds_read_b64_tr_b16 v[132:133], v14 offset:0
    v_mfma_f32_16x16x32_bf16 v[196:199], v[116:119], v[152:155], v[196:199]
    ds_read_b64_tr_b16 v[134:135], v14 offset:2560
    ds_read_b64_tr_b16 v[136:137], v16 offset:0
    v_mfma_f32_16x16x32_bf16 v[200:203], v[120:123], v[152:155], v[200:203]
    ds_read_b64_tr_b16 v[138:139], v16 offset:2560
    v_mfma_f32_16x16x32_bf16 v[204:207], v[124:127], v[152:155], v[204:207]
    ds_read_b64_tr_b16 v[140:141], v18 offset:0
    ds_read_b64_tr_b16 v[142:143], v18 offset:2560
    v_mfma_f32_16x16x32_bf16 v[208:211], v[112:115], v[156:159], v[208:211]
    ds_read_b64_tr_b16 v[144:145], v20 offset:0
    ds_read_b64_tr_b16 v[146:147], v20 offset:2560
    v_mfma_f32_16x16x32_bf16 v[212:215], v[116:119], v[156:159], v[212:215]
    v_mfma_f32_16x16x32_bf16 v[216:219], v[120:123], v[156:159], v[216:219]
    v_mfma_f32_16x16x32_bf16 v[220:223], v[124:127], v[156:159], v[220:223]
    v_mfma_f32_16x16x32_bf16 v[224:227], v[112:115], v[160:163], v[224:227]
    v_mfma_f32_16x16x32_bf16 v[228:231], v[116:119], v[160:163], v[228:231]
    v_mfma_f32_16x16x32_bf16 v[232:235], v[120:123], v[160:163], v[232:235]
    v_mfma_f32_16x16x32_bf16 v[236:239], v[124:127], v[160:163], v[236:239]
    v_mfma_f32_16x16x32_bf16 v[240:243], v[112:115], v[164:167], v[240:243]
    v_mfma_f32_16x16x32_bf16 v[244:247], v[116:119], v[164:167], v[244:247]
    v_mfma_f32_16x16x32_bf16 v[248:251], v[120:123], v[164:167], v[248:251]
    v_mfma_f32_16x16x32_bf16 v[252:255], v[124:127], v[164:167], v[252:255]
    s_waitcnt lgkmcnt(0)
    v_mfma_f32_16x16x32_bf16 v[176:179], v[96:99], v[128:131], v[176:179]
    ds_read_b128 v[112:115], v9 offset:0
    v_mfma_f32_16x16x32_bf16 v[180:183], v[100:103], v[128:131], v[180:183]
    ds_read_b128 v[116:119], v9 offset:2048
    ds_read_b128 v[120:123], v9 offset:4096
    v_mfma_f32_16x16x32_bf16 v[184:187], v[104:107], v[128:131], v[184:187]
    ds_read_b128 v[124:127], v9 offset:6144
    v_mfma_f32_16x16x32_bf16 v[188:191], v[108:111], v[128:131], v[188:191]
    ds_read_b64_tr_b16 v[148:149], v12 offset:10240
    ds_read_b64_tr_b16 v[150:151], v12 offset:12800
    v_mfma_f32_16x16x32_bf16 v[192:195], v[96:99], v[132:135], v[192:195]
    ds_read_b64_tr_b16 v[152:153], v14 offset:10240
    v_mfma_f32_16x16x32_bf16 v[196:199], v[100:103], v[132:135], v[196:199]
    ds_read_b64_tr_b16 v[154:155], v14 offset:12800
    ds_read_b64_tr_b16 v[156:157], v16 offset:10240
    v_mfma_f32_16x16x32_bf16 v[200:203], v[104:107], v[132:135], v[200:203]
    ds_read_b64_tr_b16 v[158:159], v16 offset:12800
    v_mfma_f32_16x16x32_bf16 v[204:207], v[108:111], v[132:135], v[204:207]
    ds_read_b64_tr_b16 v[160:161], v18 offset:10240
    ds_read_b64_tr_b16 v[162:163], v18 offset:12800
    v_mfma_f32_16x16x32_bf16 v[208:211], v[96:99], v[136:139], v[208:211]
    ds_read_b64_tr_b16 v[164:165], v20 offset:10240
    ds_read_b64_tr_b16 v[166:167], v20 offset:12800
    v_mfma_f32_16x16x32_bf16 v[212:215], v[100:103], v[136:139], v[212:215]
    v_mfma_f32_16x16x32_bf16 v[216:219], v[104:107], v[136:139], v[216:219]
    v_mfma_f32_16x16x32_bf16 v[220:223], v[108:111], v[136:139], v[220:223]
    v_mfma_f32_16x16x32_bf16 v[224:227], v[96:99], v[140:143], v[224:227]
    v_mfma_f32_16x16x32_bf16 v[228:231], v[100:103], v[140:143], v[228:231]
    v_mfma_f32_16x16x32_bf16 v[232:235], v[104:107], v[140:143], v[232:235]
    v_mfma_f32_16x16x32_bf16 v[236:239], v[108:111], v[140:143], v[236:239]
    v_mfma_f32_16x16x32_bf16 v[240:243], v[96:99], v[144:147], v[240:243]
    v_mfma_f32_16x16x32_bf16 v[244:247], v[100:103], v[144:147], v[244:247]
    v_mfma_f32_16x16x32_bf16 v[248:251], v[104:107], v[144:147], v[248:251]
    v_mfma_f32_16x16x32_bf16 v[252:255], v[108:111], v[144:147], v[252:255]
    s_waitcnt vmcnt(0)
    s_waitcnt lgkmcnt(0)
    s_barrier
    v_mfma_f32_16x16x32_bf16 v[176:179], v[112:115], v[148:151], v[176:179]
    ds_read_b128 v[96:99], v8 offset:36864
    v_mfma_f32_16x16x32_bf16 v[180:183], v[116:119], v[148:151], v[180:183]
    ds_read_b128 v[100:103], v8 offset:38912
    ds_read_b128 v[104:107], v8 offset:40960
    v_mfma_f32_16x16x32_bf16 v[184:187], v[120:123], v[148:151], v[184:187]
    ds_read_b128 v[108:111], v8 offset:43008
    v_mfma_f32_16x16x32_bf16 v[188:191], v[124:127], v[148:151], v[188:191]
    ds_read_b64_tr_b16 v[128:129], v12 offset:36864
    ds_read_b64_tr_b16 v[130:131], v12 offset:39424
    v_mfma_f32_16x16x32_bf16 v[192:195], v[112:115], v[152:155], v[192:195]
    ds_read_b64_tr_b16 v[132:133], v14 offset:36864
    v_mfma_f32_16x16x32_bf16 v[196:199], v[116:119], v[152:155], v[196:199]
    ds_read_b64_tr_b16 v[134:135], v14 offset:39424
    ds_read_b64_tr_b16 v[136:137], v16 offset:36864
    v_mfma_f32_16x16x32_bf16 v[200:203], v[120:123], v[152:155], v[200:203]
    ds_read_b64_tr_b16 v[138:139], v16 offset:39424
    v_mfma_f32_16x16x32_bf16 v[204:207], v[124:127], v[152:155], v[204:207]
    ds_read_b64_tr_b16 v[140:141], v18 offset:36864
    ds_read_b64_tr_b16 v[142:143], v18 offset:39424
    v_mfma_f32_16x16x32_bf16 v[208:211], v[112:115], v[156:159], v[208:211]
    ds_read_b64_tr_b16 v[144:145], v20 offset:36864
    ds_read_b64_tr_b16 v[146:147], v20 offset:39424
    v_mfma_f32_16x16x32_bf16 v[212:215], v[116:119], v[156:159], v[212:215]
    v_mfma_f32_16x16x32_bf16 v[216:219], v[120:123], v[156:159], v[216:219]
    v_mfma_f32_16x16x32_bf16 v[220:223], v[124:127], v[156:159], v[220:223]
    v_mfma_f32_16x16x32_bf16 v[224:227], v[112:115], v[160:163], v[224:227]
    v_mfma_f32_16x16x32_bf16 v[228:231], v[116:119], v[160:163], v[228:231]
    v_mfma_f32_16x16x32_bf16 v[232:235], v[120:123], v[160:163], v[232:235]
    v_mfma_f32_16x16x32_bf16 v[236:239], v[124:127], v[160:163], v[236:239]
    v_mfma_f32_16x16x32_bf16 v[240:243], v[112:115], v[164:167], v[240:243]
    v_mfma_f32_16x16x32_bf16 v[244:247], v[116:119], v[164:167], v[244:247]
    v_mfma_f32_16x16x32_bf16 v[248:251], v[120:123], v[164:167], v[248:251]
    v_mfma_f32_16x16x32_bf16 v[252:255], v[124:127], v[164:167], v[252:255]
    s_cmp_lg_u32 s24, 0
    s_cbranch_scc1 RFS_31
    s_lshl_b32 s62, s25, 3
    s_add_u32 s62, s62, s26
    s_lshl_b32 s62, s62, 3
    s_add_u32 s62, s62, 14976000

    v_mov_b32 v34, s58
    v_mov_b32 v35, s59
    s_mov_b64 exec, 1
    buffer_store_dwordx2 v[34:35], v3, s[40:43], s62 offen sc1
    s_mov_b64 exec, -1

RFS_31:
    s_waitcnt lgkmcnt(0)
    v_mfma_f32_16x16x32_bf16 v[176:179], v[96:99], v[128:131], v[176:179]
    ds_read_b128 v[112:115], v9 offset:36864
    v_mfma_f32_16x16x32_bf16 v[180:183], v[100:103], v[128:131], v[180:183]
    ds_read_b128 v[116:119], v9 offset:38912
    ds_read_b128 v[120:123], v9 offset:40960
    v_mfma_f32_16x16x32_bf16 v[184:187], v[104:107], v[128:131], v[184:187]
    ds_read_b128 v[124:127], v9 offset:43008
    v_mfma_f32_16x16x32_bf16 v[188:191], v[108:111], v[128:131], v[188:191]
    ds_read_b64_tr_b16 v[148:149], v12 offset:47104
    ds_read_b64_tr_b16 v[150:151], v12 offset:49664
    v_mfma_f32_16x16x32_bf16 v[192:195], v[96:99], v[132:135], v[192:195]
    ds_read_b64_tr_b16 v[152:153], v14 offset:47104
    v_mfma_f32_16x16x32_bf16 v[196:199], v[100:103], v[132:135], v[196:199]
    ds_read_b64_tr_b16 v[154:155], v14 offset:49664
    ds_read_b64_tr_b16 v[156:157], v16 offset:47104
    v_mfma_f32_16x16x32_bf16 v[200:203], v[104:107], v[132:135], v[200:203]
    ds_read_b64_tr_b16 v[158:159], v16 offset:49664
    v_mfma_f32_16x16x32_bf16 v[204:207], v[108:111], v[132:135], v[204:207]
    ds_read_b64_tr_b16 v[160:161], v18 offset:47104
    ds_read_b64_tr_b16 v[162:163], v18 offset:49664
    v_mfma_f32_16x16x32_bf16 v[208:211], v[96:99], v[136:139], v[208:211]
    ds_read_b64_tr_b16 v[164:165], v20 offset:47104
    ds_read_b64_tr_b16 v[166:167], v20 offset:49664
    v_mfma_f32_16x16x32_bf16 v[212:215], v[100:103], v[136:139], v[212:215]
    v_mfma_f32_16x16x32_bf16 v[216:219], v[104:107], v[136:139], v[216:219]
    v_mfma_f32_16x16x32_bf16 v[220:223], v[108:111], v[136:139], v[220:223]
    v_mfma_f32_16x16x32_bf16 v[224:227], v[96:99], v[140:143], v[224:227]
    v_mfma_f32_16x16x32_bf16 v[228:231], v[100:103], v[140:143], v[228:231]
    v_mfma_f32_16x16x32_bf16 v[232:235], v[104:107], v[140:143], v[232:235]
    v_mfma_f32_16x16x32_bf16 v[236:239], v[108:111], v[140:143], v[236:239]
    v_mfma_f32_16x16x32_bf16 v[240:243], v[96:99], v[144:147], v[240:243]
    v_mfma_f32_16x16x32_bf16 v[244:247], v[100:103], v[144:147], v[244:247]
    v_mfma_f32_16x16x32_bf16 v[248:251], v[104:107], v[144:147], v[248:251]
    v_mfma_f32_16x16x32_bf16 v[252:255], v[108:111], v[144:147], v[252:255]
    s_waitcnt lgkmcnt(0)
    s_barrier
    v_mfma_f32_16x16x32_bf16 v[176:179], v[112:115], v[148:151], v[176:179]
    ds_read_b128 v[96:99], v10 offset:36864
    v_mfma_f32_16x16x32_bf16 v[180:183], v[116:119], v[148:151], v[180:183]
    ds_read_b128 v[100:103], v10 offset:38912
    ds_read_b128 v[104:107], v10 offset:40960
    v_mfma_f32_16x16x32_bf16 v[184:187], v[120:123], v[148:151], v[184:187]
    ds_read_b128 v[108:111], v10 offset:43008
    v_mfma_f32_16x16x32_bf16 v[188:191], v[124:127], v[148:151], v[188:191]
    ds_read_b64_tr_b16 v[128:129], v13 offset:36864
    ds_read_b64_tr_b16 v[130:131], v13 offset:39424
    v_mfma_f32_16x16x32_bf16 v[192:195], v[112:115], v[152:155], v[192:195]
    ds_read_b64_tr_b16 v[132:133], v15 offset:36864
    v_mfma_f32_16x16x32_bf16 v[196:199], v[116:119], v[152:155], v[196:199]
    ds_read_b64_tr_b16 v[134:135], v15 offset:39424
    ds_read_b64_tr_b16 v[136:137], v17 offset:36864
    v_mfma_f32_16x16x32_bf16 v[200:203], v[120:123], v[152:155], v[200:203]
    ds_read_b64_tr_b16 v[138:139], v17 offset:39424
    v_mfma_f32_16x16x32_bf16 v[204:207], v[124:127], v[152:155], v[204:207]
    ds_read_b64_tr_b16 v[140:141], v19 offset:36864
    ds_read_b64_tr_b16 v[142:143], v19 offset:39424
    v_mfma_f32_16x16x32_bf16 v[208:211], v[112:115], v[156:159], v[208:211]
    ds_read_b64_tr_b16 v[144:145], v21 offset:36864
    ds_read_b64_tr_b16 v[146:147], v21 offset:39424
    v_mfma_f32_16x16x32_bf16 v[212:215], v[116:119], v[156:159], v[212:215]
    v_mfma_f32_16x16x32_bf16 v[216:219], v[120:123], v[156:159], v[216:219]
    v_mfma_f32_16x16x32_bf16 v[220:223], v[124:127], v[156:159], v[220:223]
    v_mfma_f32_16x16x32_bf16 v[224:227], v[112:115], v[160:163], v[224:227]
    v_mfma_f32_16x16x32_bf16 v[228:231], v[116:119], v[160:163], v[228:231]
    v_mfma_f32_16x16x32_bf16 v[232:235], v[120:123], v[160:163], v[232:235]
    v_mfma_f32_16x16x32_bf16 v[236:239], v[124:127], v[160:163], v[236:239]
    v_mfma_f32_16x16x32_bf16 v[240:243], v[112:115], v[164:167], v[240:243]
    v_mfma_f32_16x16x32_bf16 v[244:247], v[116:119], v[164:167], v[244:247]
    v_mfma_f32_16x16x32_bf16 v[248:251], v[120:123], v[164:167], v[248:251]
    v_mfma_f32_16x16x32_bf16 v[252:255], v[124:127], v[164:167], v[252:255]
    s_waitcnt lgkmcnt(0)
    v_mfma_f32_16x16x32_bf16 v[176:179], v[96:99], v[128:131], v[176:179]
    ds_read_b128 v[112:115], v11 offset:36864
    v_mfma_f32_16x16x32_bf16 v[180:183], v[100:103], v[128:131], v[180:183]
    ds_read_b128 v[116:119], v11 offset:38912
    ds_read_b128 v[120:123], v11 offset:40960
    v_mfma_f32_16x16x32_bf16 v[184:187], v[104:107], v[128:131], v[184:187]
    ds_read_b128 v[124:127], v11 offset:43008
    v_mfma_f32_16x16x32_bf16 v[188:191], v[108:111], v[128:131], v[188:191]
    ds_read_b64_tr_b16 v[148:149], v13 offset:47104
    ds_read_b64_tr_b16 v[150:151], v13 offset:49664
    v_mfma_f32_16x16x32_bf16 v[192:195], v[96:99], v[132:135], v[192:195]
    ds_read_b64_tr_b16 v[152:153], v15 offset:47104
    v_mfma_f32_16x16x32_bf16 v[196:199], v[100:103], v[132:135], v[196:199]
    ds_read_b64_tr_b16 v[154:155], v15 offset:49664
    ds_read_b64_tr_b16 v[156:157], v17 offset:47104
    v_mfma_f32_16x16x32_bf16 v[200:203], v[104:107], v[132:135], v[200:203]
    ds_read_b64_tr_b16 v[158:159], v17 offset:49664
    v_mfma_f32_16x16x32_bf16 v[204:207], v[108:111], v[132:135], v[204:207]
    ds_read_b64_tr_b16 v[160:161], v19 offset:47104
    ds_read_b64_tr_b16 v[162:163], v19 offset:49664
    v_mfma_f32_16x16x32_bf16 v[208:211], v[96:99], v[136:139], v[208:211]
    ds_read_b64_tr_b16 v[164:165], v21 offset:47104
    ds_read_b64_tr_b16 v[166:167], v21 offset:49664
    v_mfma_f32_16x16x32_bf16 v[212:215], v[100:103], v[136:139], v[212:215]
    v_mfma_f32_16x16x32_bf16 v[216:219], v[104:107], v[136:139], v[216:219]
    v_mfma_f32_16x16x32_bf16 v[220:223], v[108:111], v[136:139], v[220:223]
    v_mfma_f32_16x16x32_bf16 v[224:227], v[96:99], v[140:143], v[224:227]
    v_mfma_f32_16x16x32_bf16 v[228:231], v[100:103], v[140:143], v[228:231]
    v_mfma_f32_16x16x32_bf16 v[232:235], v[104:107], v[140:143], v[232:235]
    v_mfma_f32_16x16x32_bf16 v[236:239], v[108:111], v[140:143], v[236:239]
    v_mfma_f32_16x16x32_bf16 v[240:243], v[96:99], v[144:147], v[240:243]
    v_mfma_f32_16x16x32_bf16 v[244:247], v[100:103], v[144:147], v[244:247]
    v_mfma_f32_16x16x32_bf16 v[248:251], v[104:107], v[144:147], v[248:251]
    v_mfma_f32_16x16x32_bf16 v[252:255], v[108:111], v[144:147], v[252:255]
    s_waitcnt lgkmcnt(0)
    s_barrier
    v_mfma_f32_16x16x32_bf16 v[176:179], v[112:115], v[148:151], v[176:179]
    ds_read_b128 v[96:99], v10 offset:0
    v_mfma_f32_16x16x32_bf16 v[180:183], v[116:119], v[148:151], v[180:183]
    ds_read_b128 v[100:103], v10 offset:2048
    ds_read_b128 v[104:107], v10 offset:4096
    v_mfma_f32_16x16x32_bf16 v[184:187], v[120:123], v[148:151], v[184:187]
    ds_read_b128 v[108:111], v10 offset:6144
    v_mfma_f32_16x16x32_bf16 v[188:191], v[124:127], v[148:151], v[188:191]
    ds_read_b64_tr_b16 v[128:129], v13 offset:0
    ds_read_b64_tr_b16 v[130:131], v13 offset:2560
    v_mfma_f32_16x16x32_bf16 v[192:195], v[112:115], v[152:155], v[192:195]
    ds_read_b64_tr_b16 v[132:133], v15 offset:0
    v_mfma_f32_16x16x32_bf16 v[196:199], v[116:119], v[152:155], v[196:199]
    ds_read_b64_tr_b16 v[134:135], v15 offset:2560
    ds_read_b64_tr_b16 v[136:137], v17 offset:0
    v_mfma_f32_16x16x32_bf16 v[200:203], v[120:123], v[152:155], v[200:203]
    ds_read_b64_tr_b16 v[138:139], v17 offset:2560
    v_mfma_f32_16x16x32_bf16 v[204:207], v[124:127], v[152:155], v[204:207]
    ds_read_b64_tr_b16 v[140:141], v19 offset:0
    ds_read_b64_tr_b16 v[142:143], v19 offset:2560
    v_mfma_f32_16x16x32_bf16 v[208:211], v[112:115], v[156:159], v[208:211]
    ds_read_b64_tr_b16 v[144:145], v21 offset:0
    ds_read_b64_tr_b16 v[146:147], v21 offset:2560
    v_mfma_f32_16x16x32_bf16 v[212:215], v[116:119], v[156:159], v[212:215]
    v_mfma_f32_16x16x32_bf16 v[216:219], v[120:123], v[156:159], v[216:219]
    v_mfma_f32_16x16x32_bf16 v[220:223], v[124:127], v[156:159], v[220:223]
    v_mfma_f32_16x16x32_bf16 v[224:227], v[112:115], v[160:163], v[224:227]
    v_mfma_f32_16x16x32_bf16 v[228:231], v[116:119], v[160:163], v[228:231]
    v_mfma_f32_16x16x32_bf16 v[232:235], v[120:123], v[160:163], v[232:235]
    v_mfma_f32_16x16x32_bf16 v[236:239], v[124:127], v[160:163], v[236:239]
    v_mfma_f32_16x16x32_bf16 v[240:243], v[112:115], v[164:167], v[240:243]
    v_mfma_f32_16x16x32_bf16 v[244:247], v[116:119], v[164:167], v[244:247]
    v_mfma_f32_16x16x32_bf16 v[248:251], v[120:123], v[164:167], v[248:251]
    v_mfma_f32_16x16x32_bf16 v[252:255], v[124:127], v[164:167], v[252:255]
    s_waitcnt lgkmcnt(0)
    v_mfma_f32_16x16x32_bf16 v[176:179], v[96:99], v[128:131], v[176:179]
    ds_read_b128 v[112:115], v11 offset:0
    v_mfma_f32_16x16x32_bf16 v[180:183], v[100:103], v[128:131], v[180:183]
    ds_read_b128 v[116:119], v11 offset:2048
    ds_read_b128 v[120:123], v11 offset:4096
    v_mfma_f32_16x16x32_bf16 v[184:187], v[104:107], v[128:131], v[184:187]
    ds_read_b128 v[124:127], v11 offset:6144
    v_mfma_f32_16x16x32_bf16 v[188:191], v[108:111], v[128:131], v[188:191]
    ds_read_b64_tr_b16 v[148:149], v13 offset:10240
    ds_read_b64_tr_b16 v[150:151], v13 offset:12800
    v_mfma_f32_16x16x32_bf16 v[192:195], v[96:99], v[132:135], v[192:195]
    ds_read_b64_tr_b16 v[152:153], v15 offset:10240
    v_mfma_f32_16x16x32_bf16 v[196:199], v[100:103], v[132:135], v[196:199]
    ds_read_b64_tr_b16 v[154:155], v15 offset:12800
    ds_read_b64_tr_b16 v[156:157], v17 offset:10240
    v_mfma_f32_16x16x32_bf16 v[200:203], v[104:107], v[132:135], v[200:203]
    ds_read_b64_tr_b16 v[158:159], v17 offset:12800
    v_mfma_f32_16x16x32_bf16 v[204:207], v[108:111], v[132:135], v[204:207]
    ds_read_b64_tr_b16 v[160:161], v19 offset:10240
    ds_read_b64_tr_b16 v[162:163], v19 offset:12800
    v_mfma_f32_16x16x32_bf16 v[208:211], v[96:99], v[136:139], v[208:211]
    ds_read_b64_tr_b16 v[164:165], v21 offset:10240
    ds_read_b64_tr_b16 v[166:167], v21 offset:12800
    v_mfma_f32_16x16x32_bf16 v[212:215], v[100:103], v[136:139], v[212:215]
    v_mfma_f32_16x16x32_bf16 v[216:219], v[104:107], v[136:139], v[216:219]
    v_mfma_f32_16x16x32_bf16 v[220:223], v[108:111], v[136:139], v[220:223]
    v_mfma_f32_16x16x32_bf16 v[224:227], v[96:99], v[140:143], v[224:227]
    v_mfma_f32_16x16x32_bf16 v[228:231], v[100:103], v[140:143], v[228:231]
    v_mfma_f32_16x16x32_bf16 v[232:235], v[104:107], v[140:143], v[232:235]
    v_mfma_f32_16x16x32_bf16 v[236:239], v[108:111], v[140:143], v[236:239]
    v_mfma_f32_16x16x32_bf16 v[240:243], v[96:99], v[144:147], v[240:243]
    v_mfma_f32_16x16x32_bf16 v[244:247], v[100:103], v[144:147], v[244:247]
    v_mfma_f32_16x16x32_bf16 v[248:251], v[104:107], v[144:147], v[248:251]
    v_mfma_f32_16x16x32_bf16 v[252:255], v[108:111], v[144:147], v[252:255]
    s_waitcnt lgkmcnt(0)
    s_barrier
    v_mfma_f32_16x16x32_bf16 v[176:179], v[112:115], v[148:151], v[176:179]
    ds_read_b128 v[96:99], v8 offset:0
    v_mfma_f32_16x16x32_bf16 v[180:183], v[116:119], v[148:151], v[180:183]
    ds_read_b128 v[100:103], v8 offset:2048
    ds_read_b128 v[104:107], v8 offset:4096
    v_mfma_f32_16x16x32_bf16 v[184:187], v[120:123], v[148:151], v[184:187]
    ds_read_b128 v[108:111], v8 offset:6144
    v_mfma_f32_16x16x32_bf16 v[188:191], v[124:127], v[148:151], v[188:191]
    ds_read_b64_tr_b16 v[128:129], v12 offset:0
    ds_read_b64_tr_b16 v[130:131], v12 offset:2560
    v_mfma_f32_16x16x32_bf16 v[192:195], v[112:115], v[152:155], v[192:195]
    ds_read_b64_tr_b16 v[132:133], v14 offset:0
    v_mfma_f32_16x16x32_bf16 v[196:199], v[116:119], v[152:155], v[196:199]
    ds_read_b64_tr_b16 v[134:135], v14 offset:2560
    ds_read_b64_tr_b16 v[136:137], v16 offset:0
    v_mfma_f32_16x16x32_bf16 v[200:203], v[120:123], v[152:155], v[200:203]
    ds_read_b64_tr_b16 v[138:139], v16 offset:2560
    v_mfma_f32_16x16x32_bf16 v[204:207], v[124:127], v[152:155], v[204:207]
    ds_read_b64_tr_b16 v[140:141], v18 offset:0
    ds_read_b64_tr_b16 v[142:143], v18 offset:2560
    v_mfma_f32_16x16x32_bf16 v[208:211], v[112:115], v[156:159], v[208:211]
    ds_read_b64_tr_b16 v[144:145], v20 offset:0
    ds_read_b64_tr_b16 v[146:147], v20 offset:2560
    v_mfma_f32_16x16x32_bf16 v[212:215], v[116:119], v[156:159], v[212:215]
    v_mfma_f32_16x16x32_bf16 v[216:219], v[120:123], v[156:159], v[216:219]
    v_mfma_f32_16x16x32_bf16 v[220:223], v[124:127], v[156:159], v[220:223]
    v_mfma_f32_16x16x32_bf16 v[224:227], v[112:115], v[160:163], v[224:227]
    v_mfma_f32_16x16x32_bf16 v[228:231], v[116:119], v[160:163], v[228:231]
    v_mfma_f32_16x16x32_bf16 v[232:235], v[120:123], v[160:163], v[232:235]
    v_mfma_f32_16x16x32_bf16 v[236:239], v[124:127], v[160:163], v[236:239]
    v_mfma_f32_16x16x32_bf16 v[240:243], v[112:115], v[164:167], v[240:243]
    v_mfma_f32_16x16x32_bf16 v[244:247], v[116:119], v[164:167], v[244:247]
    v_mfma_f32_16x16x32_bf16 v[248:251], v[120:123], v[164:167], v[248:251]
    v_mfma_f32_16x16x32_bf16 v[252:255], v[124:127], v[164:167], v[252:255]
    s_waitcnt lgkmcnt(0)
    v_mfma_f32_16x16x32_bf16 v[176:179], v[96:99], v[128:131], v[176:179]
    ds_read_b128 v[112:115], v9 offset:0
    v_mfma_f32_16x16x32_bf16 v[180:183], v[100:103], v[128:131], v[180:183]
    ds_read_b128 v[116:119], v9 offset:2048
    ds_read_b128 v[120:123], v9 offset:4096
    v_mfma_f32_16x16x32_bf16 v[184:187], v[104:107], v[128:131], v[184:187]
    ds_read_b128 v[124:127], v9 offset:6144
    v_mfma_f32_16x16x32_bf16 v[188:191], v[108:111], v[128:131], v[188:191]
    ds_read_b64_tr_b16 v[148:149], v12 offset:10240
    ds_read_b64_tr_b16 v[150:151], v12 offset:12800
    v_mfma_f32_16x16x32_bf16 v[192:195], v[96:99], v[132:135], v[192:195]
    ds_read_b64_tr_b16 v[152:153], v14 offset:10240
    v_mfma_f32_16x16x32_bf16 v[196:199], v[100:103], v[132:135], v[196:199]
    ds_read_b64_tr_b16 v[154:155], v14 offset:12800
    ds_read_b64_tr_b16 v[156:157], v16 offset:10240
    v_mfma_f32_16x16x32_bf16 v[200:203], v[104:107], v[132:135], v[200:203]
    ds_read_b64_tr_b16 v[158:159], v16 offset:12800
    v_mfma_f32_16x16x32_bf16 v[204:207], v[108:111], v[132:135], v[204:207]
    ds_read_b64_tr_b16 v[160:161], v18 offset:10240
    ds_read_b64_tr_b16 v[162:163], v18 offset:12800
    v_mfma_f32_16x16x32_bf16 v[208:211], v[96:99], v[136:139], v[208:211]
    ds_read_b64_tr_b16 v[164:165], v20 offset:10240
    ds_read_b64_tr_b16 v[166:167], v20 offset:12800
    v_mfma_f32_16x16x32_bf16 v[212:215], v[100:103], v[136:139], v[212:215]
    v_mfma_f32_16x16x32_bf16 v[216:219], v[104:107], v[136:139], v[216:219]
    v_mfma_f32_16x16x32_bf16 v[220:223], v[108:111], v[136:139], v[220:223]
    v_mfma_f32_16x16x32_bf16 v[224:227], v[96:99], v[140:143], v[224:227]
    v_mfma_f32_16x16x32_bf16 v[228:231], v[100:103], v[140:143], v[228:231]
    v_mfma_f32_16x16x32_bf16 v[232:235], v[104:107], v[140:143], v[232:235]
    v_mfma_f32_16x16x32_bf16 v[236:239], v[108:111], v[140:143], v[236:239]
    v_mfma_f32_16x16x32_bf16 v[240:243], v[96:99], v[144:147], v[240:243]
    v_mfma_f32_16x16x32_bf16 v[244:247], v[100:103], v[144:147], v[244:247]
    v_mfma_f32_16x16x32_bf16 v[248:251], v[104:107], v[144:147], v[248:251]
    v_mfma_f32_16x16x32_bf16 v[252:255], v[108:111], v[144:147], v[252:255]
    s_waitcnt lgkmcnt(0)
    s_barrier
    v_mfma_f32_16x16x32_bf16 v[176:179], v[112:115], v[148:151], v[176:179]
    ds_read_b128 v[96:99], v8 offset:36864
    v_mfma_f32_16x16x32_bf16 v[180:183], v[116:119], v[148:151], v[180:183]
    ds_read_b128 v[100:103], v8 offset:38912
    ds_read_b128 v[104:107], v8 offset:40960
    v_mfma_f32_16x16x32_bf16 v[184:187], v[120:123], v[148:151], v[184:187]
    ds_read_b128 v[108:111], v8 offset:43008
    v_mfma_f32_16x16x32_bf16 v[188:191], v[124:127], v[148:151], v[188:191]
    ds_read_b64_tr_b16 v[128:129], v12 offset:36864
    ds_read_b64_tr_b16 v[130:131], v12 offset:39424
    v_mfma_f32_16x16x32_bf16 v[192:195], v[112:115], v[152:155], v[192:195]
    ds_read_b64_tr_b16 v[132:133], v14 offset:36864
    v_mfma_f32_16x16x32_bf16 v[196:199], v[116:119], v[152:155], v[196:199]
    ds_read_b64_tr_b16 v[134:135], v14 offset:39424
    ds_read_b64_tr_b16 v[136:137], v16 offset:36864
    v_mfma_f32_16x16x32_bf16 v[200:203], v[120:123], v[152:155], v[200:203]
    ds_read_b64_tr_b16 v[138:139], v16 offset:39424
    v_mfma_f32_16x16x32_bf16 v[204:207], v[124:127], v[152:155], v[204:207]
    ds_read_b64_tr_b16 v[140:141], v18 offset:36864
    ds_read_b64_tr_b16 v[142:143], v18 offset:39424
    v_mfma_f32_16x16x32_bf16 v[208:211], v[112:115], v[156:159], v[208:211]
    ds_read_b64_tr_b16 v[144:145], v20 offset:36864
    ds_read_b64_tr_b16 v[146:147], v20 offset:39424
    v_mfma_f32_16x16x32_bf16 v[212:215], v[116:119], v[156:159], v[212:215]
    v_mfma_f32_16x16x32_bf16 v[216:219], v[120:123], v[156:159], v[216:219]
    v_mfma_f32_16x16x32_bf16 v[220:223], v[124:127], v[156:159], v[220:223]
    v_mfma_f32_16x16x32_bf16 v[224:227], v[112:115], v[160:163], v[224:227]
    v_mfma_f32_16x16x32_bf16 v[228:231], v[116:119], v[160:163], v[228:231]
    v_mfma_f32_16x16x32_bf16 v[232:235], v[120:123], v[160:163], v[232:235]
    v_mfma_f32_16x16x32_bf16 v[236:239], v[124:127], v[160:163], v[236:239]
    v_mfma_f32_16x16x32_bf16 v[240:243], v[112:115], v[164:167], v[240:243]
    v_mfma_f32_16x16x32_bf16 v[244:247], v[116:119], v[164:167], v[244:247]
    v_mfma_f32_16x16x32_bf16 v[248:251], v[120:123], v[164:167], v[248:251]
    v_mfma_f32_16x16x32_bf16 v[252:255], v[124:127], v[164:167], v[252:255]
    s_waitcnt lgkmcnt(0)
    v_mfma_f32_16x16x32_bf16 v[176:179], v[96:99], v[128:131], v[176:179]
    ds_read_b128 v[112:115], v9 offset:36864
    v_mfma_f32_16x16x32_bf16 v[180:183], v[100:103], v[128:131], v[180:183]
    ds_read_b128 v[116:119], v9 offset:38912
    ds_read_b128 v[120:123], v9 offset:40960
    v_mfma_f32_16x16x32_bf16 v[184:187], v[104:107], v[128:131], v[184:187]
    ds_read_b128 v[124:127], v9 offset:43008
    v_mfma_f32_16x16x32_bf16 v[188:191], v[108:111], v[128:131], v[188:191]
    ds_read_b64_tr_b16 v[148:149], v12 offset:47104
    ds_read_b64_tr_b16 v[150:151], v12 offset:49664
    v_mfma_f32_16x16x32_bf16 v[192:195], v[96:99], v[132:135], v[192:195]
    ds_read_b64_tr_b16 v[152:153], v14 offset:47104
    v_mfma_f32_16x16x32_bf16 v[196:199], v[100:103], v[132:135], v[196:199]
    ds_read_b64_tr_b16 v[154:155], v14 offset:49664
    ds_read_b64_tr_b16 v[156:157], v16 offset:47104
    v_mfma_f32_16x16x32_bf16 v[200:203], v[104:107], v[132:135], v[200:203]
    ds_read_b64_tr_b16 v[158:159], v16 offset:49664
    v_mfma_f32_16x16x32_bf16 v[204:207], v[108:111], v[132:135], v[204:207]
    ds_read_b64_tr_b16 v[160:161], v18 offset:47104
    ds_read_b64_tr_b16 v[162:163], v18 offset:49664
    v_mfma_f32_16x16x32_bf16 v[208:211], v[96:99], v[136:139], v[208:211]
    ds_read_b64_tr_b16 v[164:165], v20 offset:47104
    ds_read_b64_tr_b16 v[166:167], v20 offset:49664
    v_mfma_f32_16x16x32_bf16 v[212:215], v[100:103], v[136:139], v[212:215]
    v_mfma_f32_16x16x32_bf16 v[216:219], v[104:107], v[136:139], v[216:219]
    v_mfma_f32_16x16x32_bf16 v[220:223], v[108:111], v[136:139], v[220:223]
    v_mfma_f32_16x16x32_bf16 v[224:227], v[96:99], v[140:143], v[224:227]
    v_mfma_f32_16x16x32_bf16 v[228:231], v[100:103], v[140:143], v[228:231]
    v_mfma_f32_16x16x32_bf16 v[232:235], v[104:107], v[140:143], v[232:235]
    v_mfma_f32_16x16x32_bf16 v[236:239], v[108:111], v[140:143], v[236:239]
    v_mfma_f32_16x16x32_bf16 v[240:243], v[96:99], v[144:147], v[240:243]
    v_mfma_f32_16x16x32_bf16 v[244:247], v[100:103], v[144:147], v[244:247]
    v_mfma_f32_16x16x32_bf16 v[248:251], v[104:107], v[144:147], v[248:251]
    v_mfma_f32_16x16x32_bf16 v[252:255], v[108:111], v[144:147], v[252:255]
    s_waitcnt lgkmcnt(0)
    v_mfma_f32_16x16x32_bf16 v[176:179], v[112:115], v[148:151], v[176:179]
    v_mfma_f32_16x16x32_bf16 v[180:183], v[116:119], v[148:151], v[180:183]
    v_mfma_f32_16x16x32_bf16 v[184:187], v[120:123], v[148:151], v[184:187]
    v_mfma_f32_16x16x32_bf16 v[188:191], v[124:127], v[148:151], v[188:191]
    v_mfma_f32_16x16x32_bf16 v[192:195], v[112:115], v[152:155], v[192:195]
    v_mfma_f32_16x16x32_bf16 v[196:199], v[116:119], v[152:155], v[196:199]
    v_mfma_f32_16x16x32_bf16 v[200:203], v[120:123], v[152:155], v[200:203]
    v_mfma_f32_16x16x32_bf16 v[204:207], v[124:127], v[152:155], v[204:207]
    v_mfma_f32_16x16x32_bf16 v[208:211], v[112:115], v[156:159], v[208:211]
    v_mfma_f32_16x16x32_bf16 v[212:215], v[116:119], v[156:159], v[212:215]
    v_mfma_f32_16x16x32_bf16 v[216:219], v[120:123], v[156:159], v[216:219]
    v_mfma_f32_16x16x32_bf16 v[220:223], v[124:127], v[156:159], v[220:223]
    v_mfma_f32_16x16x32_bf16 v[224:227], v[112:115], v[160:163], v[224:227]
    v_mfma_f32_16x16x32_bf16 v[228:231], v[116:119], v[160:163], v[228:231]
    v_mfma_f32_16x16x32_bf16 v[232:235], v[120:123], v[160:163], v[232:235]
    v_mfma_f32_16x16x32_bf16 v[236:239], v[124:127], v[160:163], v[236:239]
    v_mfma_f32_16x16x32_bf16 v[240:243], v[112:115], v[164:167], v[240:243]
    v_mfma_f32_16x16x32_bf16 v[244:247], v[116:119], v[164:167], v[244:247]
    v_mfma_f32_16x16x32_bf16 v[248:251], v[120:123], v[164:167], v[248:251]
    v_mfma_f32_16x16x32_bf16 v[252:255], v[124:127], v[164:167], v[252:255]
    s_branch KV_TAIL
GU_LOOP:
    v_mov_b32 v20, 1065369472
    v_mov_b32 v21, 1065369472
    v_mov_b32 v22, 1065369472
    v_mov_b32 v23, 1065369472
    s_lshl_b32 s68, s26, 15
    s_lshl_b32 s27, s57, 9
    s_add_u32 s68, s68, s27
    s_add_u32 s68, s68, 13631488
    v_and_b32 v6, 15, v1
    v_lshrrev_b32 v7, 4, v1
    v_lshrrev_b32 v28, 1, v6
    v_xor_b32 v28, v28, v7
    v_lshlrev_b32 v28, 4, v28
    v_lshl_add_u32 v28, v6, 7, v28

    s_lshl_b32 s27, s57, 12
    s_add_u32 s27, s27, 81920
    v_add_u32 v28, s27, v28
    v_xor_b32 v29, 64, v28
    s_lshl_b32 s60, s57, 7
    s_lshl_b32 s27, s25, 3
    s_add_u32 s60, s60, s27
    s_add_u32 s60, s60, s26
    s_add_u32 s60, s60, 0
    s_mul_i32 s61, s60, 6554
    s_lshr_b32 s61, s61, 16
    s_mul_i32 s62, s61, 10
    s_sub_u32 s62, s60, s62
    s_mov_b32 s47, 0x20000
    s_mov_b32 s65, 5120
    s_mov_b32 s66, 10240
    s_mov_b32 s71, 1280
    s_cmp_ge_u32 s61, 48
    s_cbranch_scc1 RP_1
    s_mov_b32 s44, s16
    s_mov_b32 s45, s17
    s_mov_b32 s46, 1966080
    s_lshl_b32 s67, s61, 5
    s_mov_b32 s70, 20480
    s_branch RP_4

RP_1:
    s_mov_b32 s44, s8
    s_mov_b32 s45, s9
    s_mov_b32 s46, 819200
    s_cmp_ge_u32 s61, 64
    s_cbranch_scc1 RP_3
    s_sub_u32 s67, s61, 48
    s_mul_i32 s67, s67, 40
    s_mov_b32 s70, 25600
    s_branch RP_4

RP_3:
    s_sub_u32 s67, s61, 64
    s_mul_i32 s67, s67, 160
    s_add_u32 s67, s67, 16
    s_mov_b32 s65, 1280
    s_mov_b32 s66, 102400
    s_mov_b32 s70, 2560
    s_mov_b32 s71, 25600

RP_4:
    s_mul_i32 s67, s67, 1280
    s_lshl_b32 s27, s62, 7
    s_add_u32 s67, s67, s27
    s_mul_i32 s64, s61, 40
    s_lshl_b32 s27, s62, 2
    s_add_u32 s64, s64, s27
    s_lshl_b32 s64, s64, 10
    s_add_u32 s64, s64, 9437184
    s_cmp_ge_u32 s60, 680
    s_cselect_b32 s67, 2130706432, s67
    s_cselect_b32 s64, 2130706432, s64
    v_bfe_u32 v80, v1, 3, 2
    v_mul_lo_u32 v80, v80, s71
    v_lshrrev_b32 v81, 5, v1
    v_mul_lo_u32 v81, v81, s70
    v_add_u32 v80, v80, v81
    v_and_b32 v81, 0x70, v2
    v_add_u32 v80, v80, v81
    s_lshl_b32 s75, s57, 12
    s_add_u32 s75, s75, 147456

    s_mul_i32 s72, s83, 245760
    s_add_u32 s72, s72, s82
    s_xor_b32 s27, s83, 4
    s_mul_i32 s73, s27, 245760
    s_add_u32 s73, s73, s82
    s_mul_i32 s77, s27, 786432
    s_mul_i32 s74, s83, 786432
    s_lshl_b32 s27, s80, 12
    s_add_u32 s74, s74, s27
    s_add_u32 s77, s77, s27

    s_waitcnt vmcnt(12)
    s_barrier
    ds_read_b128 v[96:99], v28 offset:0
    ds_read_b128 v[100:103], v28 offset:2048
    v_add_u32 v6, 32768, v18
    v_xor_b32 v7, 0, v6
    ds_read_b64_tr_b16 v[48:49], v7 offset:0
    ds_read_b64_tr_b16 v[50:51], v7 offset:2048
    v_xor_b32 v7, 32, v6
    ds_read_b64_tr_b16 v[52:53], v7 offset:0
    ds_read_b64_tr_b16 v[54:55], v7 offset:2048
    v_xor_b32 v7, 64, v6
    ds_read_b64_tr_b16 v[56:57], v7 offset:0
    ds_read_b64_tr_b16 v[58:59], v7 offset:2048
    v_xor_b32 v7, 96, v6
    ds_read_b64_tr_b16 v[60:61], v7 offset:0
    ds_read_b64_tr_b16 v[62:63], v7 offset:2048
    s_add_u32 m0, s55, 16384
    s_nop 0
    buffer_load_dwordx4 v12, s[36:39], s52 offen lds
    s_add_u32 m0, s55, 17408
    s_nop 0
    buffer_load_dwordx4 v13, s[36:39], s52 offen lds
    s_add_u32 m0, s55, 18432
    s_nop 0
    buffer_load_dwordx4 v14, s[36:39], s52 offen lds
    s_add_u32 m0, s55, 19456
    s_nop 0
    buffer_load_dwordx4 v15, s[36:39], s52 offen lds
    s_add_u32 s52, s52, 98304
    s_cmp_ge_u32 s52, 1966080
    s_cselect_b32 s52, 0, s52
    s_add_u32 m0, s55, 114688
    s_nop 0
    buffer_load_dwordx4 v8, s[32:35], s53 offen lds
    s_add_u32 m0, s55, 115712
    s_nop 0
    buffer_load_dwordx4 v9, s[32:35], s53 offen lds
    s_add_u32 m0, s55, 116736
    s_nop 0
    buffer_load_dwordx4 v10, s[32:35], s53 offen lds
    s_add_u32 m0, s55, 117760
    s_nop 0
    buffer_load_dwordx4 v11, s[32:35], s53 offen lds
    s_add_u32 s53, s53, 128
    s_cmp_ge_u32 s53, 1280
    s_cselect_b32 s53, 0, s53
    s_waitcnt lgkmcnt(0)
    v_mfma_f32_16x16x32_bf16 v[32:35], v[20:23], v[48:51], 0
    v_mfma_f32_16x16x32_bf16 v[36:39], v[20:23], v[52:55], 0
    v_mfma_f32_16x16x32_bf16 v[40:43], v[20:23], v[56:59], 0
    v_mfma_f32_16x16x32_bf16 v[44:47], v[20:23], v[60:63], 0
    s_waitcnt vmcnt(12) lgkmcnt(0)
    s_barrier
    ds_read_b128 v[104:107], v29 offset:0
    ds_read_b128 v[108:111], v29 offset:2048
    v_add_u32 v6, 49152, v18
    v_xor_b32 v7, 0, v6
    ds_read_b64_tr_b16 v[48:49], v7 offset:0
    ds_read_b64_tr_b16 v[50:51], v7 offset:2048
    v_xor_b32 v7, 32, v6
    ds_read_b64_tr_b16 v[52:53], v7 offset:0
    ds_read_b64_tr_b16 v[54:55], v7 offset:2048
    v_xor_b32 v7, 64, v6
    ds_read_b64_tr_b16 v[56:57], v7 offset:0
    ds_read_b64_tr_b16 v[58:59], v7 offset:2048
    v_xor_b32 v7, 96, v6
    ds_read_b64_tr_b16 v[60:61], v7 offset:0
    ds_read_b64_tr_b16 v[62:63], v7 offset:2048
    s_add_u32 m0, s55, 32768
    s_nop 0
    buffer_load_dwordx4 v12, s[36:39], s52 offen lds
    s_add_u32 m0, s55, 33792
    s_nop 0
    buffer_load_dwordx4 v13, s[36:39], s52 offen lds
    s_add_u32 m0, s55, 34816
    s_nop 0
    buffer_load_dwordx4 v14, s[36:39], s52 offen lds
    s_add_u32 m0, s55, 35840
    s_nop 0
    buffer_load_dwordx4 v15, s[36:39], s52 offen lds
    s_add_u32 s52, s52, 98304
    s_cmp_ge_u32 s52, 1966080
    s_cselect_b32 s52, 0, s52
    s_add_u32 m0, s55, 131072
    s_nop 0
    buffer_load_dwordx4 v8, s[32:35], s53 offen lds
    s_add_u32 m0, s55, 132096
    s_nop 0
    buffer_load_dwordx4 v9, s[32:35], s53 offen lds
    s_waitcnt lgkmcnt(0)
    v_mfma_f32_16x16x32_bf16 v[32:35], v[20:23], v[48:51], v[32:35]
    v_mfma_f32_16x16x32_bf16 v[36:39], v[20:23], v[52:55], v[36:39]
    v_mfma_f32_16x16x32_bf16 v[40:43], v[20:23], v[56:59], v[40:43]
    v_mfma_f32_16x16x32_bf16 v[44:47], v[20:23], v[60:63], v[44:47]
    global_load_dwordx2 v[16:17], v3, s[20:21] sc1
    s_waitcnt vmcnt(15) lgkmcnt(0)
    s_barrier
    ds_read_b128 v[112:115], v28 offset:16384
    ds_read_b128 v[116:119], v28 offset:18432
    v_add_u32 v6, 65536, v18
    v_xor_b32 v7, 0, v6
    ds_read_b64_tr_b16 v[48:49], v7 offset:0
    ds_read_b64_tr_b16 v[50:51], v7 offset:2048
    v_xor_b32 v7, 32, v6
    ds_read_b64_tr_b16 v[52:53], v7 offset:0
    ds_read_b64_tr_b16 v[54:55], v7 offset:2048
    v_xor_b32 v7, 64, v6
    ds_read_b64_tr_b16 v[56:57], v7 offset:0
    ds_read_b64_tr_b16 v[58:59], v7 offset:2048
    v_xor_b32 v7, 96, v6
    ds_read_b64_tr_b16 v[60:61], v7 offset:0
    ds_read_b64_tr_b16 v[62:63], v7 offset:2048
    s_add_u32 m0, s55, 49152
    s_nop 0
    buffer_load_dwordx4 v12, s[36:39], s52 offen lds
    s_add_u32 m0, s55, 50176
    s_nop 0
    buffer_load_dwordx4 v13, s[36:39], s52 offen lds
    s_add_u32 m0, s55, 51200
    s_nop 0
    buffer_load_dwordx4 v14, s[36:39], s52 offen lds
    s_add_u32 m0, s55, 52224
    s_nop 0
    buffer_load_dwordx4 v15, s[36:39], s52 offen lds
    s_add_u32 s52, s52, 98304
    s_cmp_ge_u32 s52, 1966080
    s_cselect_b32 s52, 0, s52
    s_add_u32 m0, s55, 133120
    s_nop 0
    buffer_load_dwordx4 v10, s[32:35], s53 offen lds
    s_add_u32 m0, s55, 134144
    s_nop 0
    buffer_load_dwordx4 v11, s[32:35], s53 offen lds
    s_add_u32 s53, s53, 128
    s_cmp_ge_u32 s53, 1280
    s_cselect_b32 s53, 0, s53
    s_waitcnt lgkmcnt(0)
    v_mfma_f32_16x16x32_bf16 v[32:35], v[20:23], v[48:51], v[32:35]
    v_mfma_f32_16x16x32_bf16 v[36:39], v[20:23], v[52:55], v[36:39]
    v_mfma_f32_16x16x32_bf16 v[40:43], v[20:23], v[56:59], v[40:43]
    v_mfma_f32_16x16x32_bf16 v[44:47], v[20:23], v[60:63], v[44:47]
    s_mov_b32 s27, s67
    s_add_u32 m0, s75, 0
    s_nop 0
    buffer_load_dwordx4 v80, s[44:47], s27 offen lds
    s_mov_b32 s27, s67
    s_add_u32 s27, s27, s65
    s_add_u32 m0, s75, 1024
    s_nop 0
    buffer_load_dwordx4 v80, s[44:47], s27 offen lds
    s_waitcnt vmcnt(15) lgkmcnt(0)
    s_barrier
    ds_read_b128 v[120:123], v29 offset:16384
    ds_read_b128 v[124:127], v29 offset:18432
    v_add_u32 v6, 0, v18
    v_xor_b32 v7, 0, v6
    ds_read_b64_tr_b16 v[48:49], v7 offset:0
    ds_read_b64_tr_b16 v[50:51], v7 offset:2048
    v_xor_b32 v7, 32, v6
    ds_read_b64_tr_b16 v[52:53], v7 offset:0
    ds_read_b64_tr_b16 v[54:55], v7 offset:2048
    v_xor_b32 v7, 64, v6
    ds_read_b64_tr_b16 v[56:57], v7 offset:0
    ds_read_b64_tr_b16 v[58:59], v7 offset:2048
    v_xor_b32 v7, 96, v6
    ds_read_b64_tr_b16 v[60:61], v7 offset:0
    ds_read_b64_tr_b16 v[62:63], v7 offset:2048
    s_add_u32 m0, s55, 65536
    s_nop 0
    buffer_load_dwordx4 v12, s[36:39], s52 offen lds
    s_add_u32 m0, s55, 66560
    s_nop 0
    buffer_load_dwordx4 v13, s[36:39], s52 offen lds
    s_add_u32 m0, s55, 67584
    s_nop 0
    buffer_load_dwordx4 v14, s[36:39], s52 offen lds
    s_add_u32 m0, s55, 68608
    s_nop 0
    buffer_load_dwordx4 v15, s[36:39], s52 offen lds
    s_add_u32 s52, s52, 98304
    s_cmp_ge_u32 s52, 1966080
    s_cselect_b32 s52, 0, s52
    s_add_u32 m0, s55, 81920
    s_nop 0
    buffer_load_dwordx4 v8, s[32:35], s53 offen lds
    s_add_u32 m0, s55, 82944
    s_nop 0
    buffer_load_dwordx4 v9, s[32:35], s53 offen lds
    s_waitcnt lgkmcnt(0)
    v_mfma_f32_16x16x32_bf16 v[32:35], v[20:23], v[48:51], v[32:35]
    v_mfma_f32_16x16x32_bf16 v[36:39], v[20:23], v[52:55], v[36:39]
    v_mfma_f32_16x16x32_bf16 v[40:43], v[20:23], v[56:59], v[40:43]
    v_mfma_f32_16x16x32_bf16 v[44:47], v[20:23], v[60:63], v[44:47]
    s_mov_b32 s27, s67
    s_add_u32 s27, s27, s66
    s_add_u32 m0, s75, 2048
    s_nop 0
    buffer_load_dwordx4 v80, s[44:47], s27 offen lds
    s_mov_b32 s27, s67
    s_add_u32 s27, s27, s65
    s_add_u32 s27, s27, s66
    s_add_u32 m0, s75, 3072
    s_nop 0
    buffer_load_dwordx4 v80, s[44:47], s27 offen lds
    s_waitcnt vmcnt(19) lgkmcnt(0)
    s_barrier
    ds_read_b128 v[128:131], v28 offset:32768
    ds_read_b128 v[132:135], v28 offset:34816
    s_add_u32 m0, s55, 0
    s_nop 0
    buffer_load_dwordx4 v12, s[36:39], s52 offen lds
    s_add_u32 m0, s55, 1024
    s_nop 0
    buffer_load_dwordx4 v13, s[36:39], s52 offen lds
    s_add_u32 m0, s55, 2048
    s_nop 0
    buffer_load_dwordx4 v14, s[36:39], s52 offen lds
    s_add_u32 m0, s55, 3072
    s_nop 0
    buffer_load_dwordx4 v15, s[36:39], s52 offen lds
    s_add_u32 s52, s52, 98304
    s_cmp_ge_u32 s52, 1966080
    s_cselect_b32 s52, 0, s52
    s_add_u32 m0, s55, 83968
    s_nop 0
    buffer_load_dwordx4 v10, s[32:35], s53 offen lds
    s_add_u32 m0, s55, 84992
    s_nop 0
    buffer_load_dwordx4 v11, s[32:35], s53 offen lds
    s_add_u32 s53, s53, 128
    s_cmp_ge_u32 s53, 1280
    s_cselect_b32 s53, 0, s53
    s_waitcnt vmcnt(22)
TOK_5:
    v_readfirstlane_b32 s58, v16
    v_readfirstlane_b32 s59, v17
    s_nop 1
    s_cmp_lg_u32 s58, 0
    s_cbranch_scc1 TOKOK_6
    global_load_dwordx2 v[16:17], v3, s[20:21] sc1
    s_waitcnt vmcnt(0)
    s_branch TOK_5

TOKOK_6:
    v_cmp_gt_u32 vcc, 16, v1
    v_cmp_gt_u32 s[60:61], 32, v1
    v_cmp_gt_u32 s[62:63], 48, v1
    v_mov_b32 v49, s58
    v_lshrrev_b32 v6, 1, v2
    v_cndmask_b32 v48, v44, v40, s[62:63]
    v_cndmask_b32 v48, v48, v36, s[60:61]
    v_cndmask_b32 v48, v48, v32, vcc
    s_lshl_b32 s27, s25, 11
    s_add_u32 s27, s27, s68

    buffer_store_dwordx2 v[48:49], v6, s[40:43], s27 offen sc1
    v_lshrrev_b32 v81, 4, v1
    v_lshlrev_b32 v81, 10, v81
    v_bfe_u32 v82, v1, 2, 2
    v_lshl_add_u32 v81, v82, 7, v81
    v_and_b32 v82, 3, v1
    v_lshl_add_u32 v81, v82, 3, v81
    s_lshl_b32 s75, s57, 12
    s_add_u32 s75, s75, 147456
    v_add_u32 v81, s75, v81
    s_waitcnt vmcnt(17) lgkmcnt(0)
    s_barrier
    ds_read_b128 v[136:139], v29 offset:32768
    ds_read_b128 v[140:143], v29 offset:34816
    s_waitcnt vmcnt(7)
    ds_read_b64_tr_b16 v[64:65], v81 offset:0
    ds_read_b64_tr_b16 v[66:67], v81 offset:512
    ds_read_b64_tr_b16 v[68:69], v81 offset:32
    ds_read_b64_tr_b16 v[70:71], v81 offset:544
    ds_read_b64_tr_b16 v[72:73], v81 offset:64
    ds_read_b64_tr_b16 v[74:75], v81 offset:576
    ds_read_b64_tr_b16 v[76:77], v81 offset:96
    ds_read_b64_tr_b16 v[78:79], v81 offset:608
    s_add_u32 m0, s55, 16384
    s_nop 0
    buffer_load_dwordx4 v12, s[36:39], s52 offen lds
    s_add_u32 m0, s55, 17408
    s_nop 0
    buffer_load_dwordx4 v13, s[36:39], s52 offen lds
    s_add_u32 m0, s55, 18432
    s_nop 0
    buffer_load_dwordx4 v14, s[36:39], s52 offen lds
    s_add_u32 m0, s55, 19456
    s_nop 0
    buffer_load_dwordx4 v15, s[36:39], s52 offen lds
    s_add_u32 s52, s52, 98304
    s_cmp_ge_u32 s52, 1966080
    s_cselect_b32 s52, 0, s52
    s_add_u32 m0, s55, 98304
    s_nop 0
    buffer_load_dwordx4 v8, s[32:35], s53 offen lds
    s_add_u32 m0, s55, 99328
    s_nop 0
    buffer_load_dwordx4 v9, s[32:35], s53 offen lds
    s_waitcnt vmcnt(17) lgkmcnt(0)
    s_barrier
    ds_read_b128 v[144:147], v28 offset:49152
    ds_read_b128 v[148:151], v28 offset:51200
    s_add_u32 m0, s55, 32768
    s_nop 0
    buffer_load_dwordx4 v12, s[36:39], s52 offen lds
    s_add_u32 m0, s55, 33792
    s_nop 0
    buffer_load_dwordx4 v13, s[36:39], s52 offen lds
    s_add_u32 m0, s55, 34816
    s_nop 0
    buffer_load_dwordx4 v14, s[36:39], s52 offen lds
    s_add_u32 m0, s55, 35840
    s_nop 0
    buffer_load_dwordx4 v15, s[36:39], s52 offen lds
    s_add_u32 s52, s52, 98304
    s_cmp_ge_u32 s52, 1966080
    s_cselect_b32 s52, 0, s52
    s_add_u32 m0, s55, 100352
    s_nop 0
    buffer_load_dwordx4 v10, s[32:35], s53 offen lds
    s_add_u32 m0, s55, 101376
    s_nop 0
    buffer_load_dwordx4 v11, s[32:35], s53 offen lds
    s_add_u32 s53, s53, 128
    s_cmp_ge_u32 s53, 1280
    s_cselect_b32 s53, 0, s53
    buffer_store_dwordx4 v[64:67], v2, s[40:43], s64 offen offset:0 sc1
    buffer_store_dwordx4 v[68:71], v2, s[40:43], s64 offen offset:1024 sc1
    s_waitcnt vmcnt(15) lgkmcnt(0)
    s_barrier
    ds_read_b128 v[152:155], v29 offset:49152
    ds_read_b128 v[156:159], v29 offset:51200
    s_add_u32 m0, s55, 49152
    s_nop 0
    buffer_load_dwordx4 v12, s[36:39], s52 offen lds
    s_add_u32 m0, s55, 50176
    s_nop 0
    buffer_load_dwordx4 v13, s[36:39], s52 offen lds
    s_add_u32 m0, s55, 51200
    s_nop 0
    buffer_load_dwordx4 v14, s[36:39], s52 offen lds
    s_add_u32 m0, s55, 52224
    s_nop 0
    buffer_load_dwordx4 v15, s[36:39], s52 offen lds
    s_add_u32 s52, s52, 98304
    s_cmp_ge_u32 s52, 1966080
    s_cselect_b32 s52, 0, s52
    s_add_u32 m0, s55, 114688
    s_nop 0
    buffer_load_dwordx4 v8, s[32:35], s53 offen lds
    s_add_u32 m0, s55, 115712
    s_nop 0
    buffer_load_dwordx4 v9, s[32:35], s53 offen lds
    buffer_store_dwordx4 v[72:75], v2, s[40:43], s64 offen offset:2048 sc1
    buffer_store_dwordx4 v[76:79], v2, s[40:43], s64 offen offset:3072 sc1
    s_waitcnt vmcnt(18) lgkmcnt(0)
    s_barrier
    ds_read_b128 v[160:163], v28 offset:0
    ds_read_b128 v[164:167], v28 offset:2048
    v_mov_b32 v6, 147456
    v_and_b32 v7, 15, v1
    v_lshl_add_u32 v7, v7, 2, v6
    ds_write_b32 v7, v3 offset:8208
    ds_write_b32 v6, v3 offset:8192
    ds_write_b32 v6, v3 offset:8196
    ds_write_b64 v6, v[16:17] offset:8200

    s_add_u32 m0, s55, 65536
    s_nop 0
    buffer_load_dwordx4 v12, s[36:39], s52 offen lds
    s_add_u32 m0, s55, 66560
    s_nop 0
    buffer_load_dwordx4 v13, s[36:39], s52 offen lds
    s_add_u32 m0, s55, 67584
    s_nop 0
    buffer_load_dwordx4 v14, s[36:39], s52 offen lds
    s_add_u32 m0, s55, 68608
    s_nop 0
    buffer_load_dwordx4 v15, s[36:39], s52 offen lds
    s_add_u32 s52, s52, 98304
    s_cmp_ge_u32 s52, 1966080
    s_cselect_b32 s52, 0, s52
    s_add_u32 m0, s55, 116736
    s_nop 0
    buffer_load_dwordx4 v10, s[32:35], s53 offen lds
    s_add_u32 m0, s55, 117760
    s_nop 0
    buffer_load_dwordx4 v11, s[32:35], s53 offen lds
    s_add_u32 s53, s53, 128
    s_cmp_ge_u32 s53, 1280
    s_cselect_b32 s53, 0, s53
    s_waitcnt vmcnt(16) lgkmcnt(0)
    s_barrier
    ds_read_b128 v[168:171], v29 offset:0
    ds_read_b128 v[172:175], v29 offset:2048
    s_add_u32 m0, s55, 0
    s_nop 0
    buffer_load_dwordx4 v12, s[36:39], s52 offen lds
    s_add_u32 m0, s55, 1024
    s_nop 0
    buffer_load_dwordx4 v13, s[36:39], s52 offen lds
    s_add_u32 m0, s55, 2048
    s_nop 0
    buffer_load_dwordx4 v14, s[36:39], s52 offen lds
    s_add_u32 m0, s55, 3072
    s_nop 0
    buffer_load_dwordx4 v15, s[36:39], s52 offen lds
    s_add_u32 s52, s52, 98304
    s_cmp_ge_u32 s52, 1966080
    s_cselect_b32 s52, 0, s52
    s_add_u32 m0, s55, 131072
    s_nop 0
    buffer_load_dwordx4 v8, s[32:35], s53 offen lds
    s_add_u32 m0, s55, 132096
    s_nop 0
    buffer_load_dwordx4 v9, s[32:35], s53 offen lds
    v_lshrrev_b32 v19, 1, v2
    s_add_u32 s27, s68, 0
    buffer_load_dwordx2 v[64:65], v19, s[40:43], s27 offen sc1
    s_add_u32 s27, s68, 4096
    buffer_load_dwordx2 v[66:67], v19, s[40:43], s27 offen sc1
    s_waitcnt vmcnt(14) lgkmcnt(0)
    s_barrier
    ds_read_b128 v[176:179], v28 offset:16384
    ds_read_b128 v[180:183], v28 offset:18432
    s_add_u32 m0, s55, 16384
    s_nop 0
    buffer_load_dwordx4 v12, s[36:39], s52 offen lds
    s_add_u32 m0, s55, 17408
    s_nop 0
    buffer_load_dwordx4 v13, s[36:39], s52 offen lds
    s_add_u32 m0, s55, 18432
    s_nop 0
    buffer_load_dwordx4 v14, s[36:39], s52 offen lds
    s_add_u32 m0, s55, 19456
    s_nop 0
    buffer_load_dwordx4 v15, s[36:39], s52 offen lds
    s_add_u32 s52, s52, 98304
    s_cmp_ge_u32 s52, 1966080
    s_cselect_b32 s52, 0, s52
    s_add_u32 m0, s55, 133120
    s_nop 0
    buffer_load_dwordx4 v10, s[32:35], s53 offen lds
    s_add_u32 m0, s55, 134144
    s_nop 0
    buffer_load_dwordx4 v11, s[32:35], s53 offen lds
    s_add_u32 s53, s53, 128
    s_cmp_ge_u32 s53, 1280
    s_cselect_b32 s53, 0, s53
    s_cmp_lg_u32 s57, 0
    s_cbranch_scc1 RFS_7
    s_lshl_b32 s62, s25, 3
    s_add_u32 s62, s62, s26
    s_lshl_b32 s62, s62, 3
    s_add_u32 s62, s62, 14974976

    v_mov_b32 v6, s58
    v_mov_b32 v7, s59
    s_mov_b64 exec, 1
    buffer_store_dwordx2 v[6:7], v3, s[40:43], s62 offen sc1
    s_mov_b64 exec, -1

RFS_7:
    s_add_u32 s27, s68, 10240
    buffer_load_dwordx2 v[68:69], v19, s[40:43], s27 offen sc1
    s_add_u32 s27, s68, 20480
    buffer_load_dwordx2 v[70:71], v19, s[40:43], s27 offen sc1
    s_waitcnt vmcnt(16) lgkmcnt(0)
    s_barrier
    ds_read_b128 v[184:187], v29 offset:16384
    ds_read_b128 v[188:191], v29 offset:18432
    s_add_u32 m0, s55, 32768
    s_nop 0
    buffer_load_dwordx4 v12, s[36:39], s52 offen lds
    s_add_u32 m0, s55, 33792
    s_nop 0
    buffer_load_dwordx4 v13, s[36:39], s52 offen lds
    s_add_u32 m0, s55, 34816
    s_nop 0
    buffer_load_dwordx4 v14, s[36:39], s52 offen lds
    s_add_u32 m0, s55, 35840
    s_nop 0
    buffer_load_dwordx4 v15, s[36:39], s52 offen lds
    s_add_u32 s52, s52, 98304
    s_cmp_ge_u32 s52, 1966080
    s_cselect_b32 s52, 0, s52
    s_add_u32 m0, s55, 81920
    s_nop 0
    buffer_load_dwordx4 v8, s[32:35], s53 offen lds
    s_add_u32 m0, s55, 82944
    s_nop 0
    buffer_load_dwordx4 v9, s[32:35], s53 offen lds
    s_add_u32 s27, s68, 26624
    buffer_load_dwordx2 v[72:73], v19, s[40:43], s27 offen sc1
    s_lshl_b32 s27, s25, 11
    s_and_b32 s29, s57, 1
    s_lshl_b32 s29, s29, 10
    s_add_u32 s27, s27, s29
    s_add_u32 s27, s27, 14155776
    buffer_load_dwordx4 v[76:79], v2, s[40:43], s27 offen sc1
    s_waitcnt vmcnt(20) lgkmcnt(0)
    s_barrier
    ds_read_b128 v[192:195], v28 offset:32768
    ds_read_b128 v[196:199], v28 offset:34816
    s_add_u32 m0, s55, 49152
    s_nop 0
    buffer_load_dwordx4 v12, s[36:39], s52 offen lds
    s_add_u32 m0, s55, 50176
    s_nop 0
    buffer_load_dwordx4 v13, s[36:39], s52 offen lds
    s_add_u32 m0, s55, 51200
    s_nop 0
    buffer_load_dwordx4 v14, s[36:39], s52 offen lds
    s_add_u32 m0, s55, 52224
    s_nop 0
    buffer_load_dwordx4 v15, s[36:39], s52 offen lds
    s_add_u32 s52, s52, 98304
    s_cmp_ge_u32 s52, 1966080
    s_cselect_b32 s52, 0, s52
    s_add_u32 m0, s55, 83968
    s_nop 0
    buffer_load_dwordx4 v10, s[32:35], s53 offen lds
    s_add_u32 m0, s55, 84992
    s_nop 0
    buffer_load_dwordx4 v11, s[32:35], s53 offen lds
    s_add_u32 s53, s53, 128
    s_cmp_ge_u32 s53, 1280
    s_cselect_b32 s53, 0, s53
    v_bfe_u32 v18, v1, 2, 3
    v_lshrrev_b32 v6, 5, v1
    v_lshl_add_u32 v18, v6, 4, v18
    v_mul_u32_u24 v18, 128, v18

    v_bfe_u32 v6, v1, 3, 2
    v_lshlrev_b32 v6, 5, v6
    v_and_b32 v7, 3, v1
    s_and_b32 s27, s57, 1
    s_lshl_b32 s27, s27, 6
    v_lshl_add_u32 v7, v7, 3, s27
    v_xor_b32 v7, v7, v6
    s_lshr_b32 s27, s57, 1
    s_lshl_b32 s27, s27, 13
    v_add3_u32 v18, v18, v7, s27

    s_waitcnt vmcnt(16) lgkmcnt(0)
    s_barrier
    ds_read_b128 v[200:203], v29 offset:32768
    ds_read_b128 v[204:207], v29 offset:34816
    s_add_u32 m0, s55, 65536
    s_nop 0
    buffer_load_dwordx4 v12, s[36:39], s52 offen lds
    s_add_u32 m0, s55, 66560
    s_nop 0
    buffer_load_dwordx4 v13, s[36:39], s52 offen lds
    s_add_u32 m0, s55, 67584
    s_nop 0
    buffer_load_dwordx4 v14, s[36:39], s52 offen lds
    s_add_u32 m0, s55, 68608
    s_nop 0
    buffer_load_dwordx4 v15, s[36:39], s52 offen lds
    s_add_u32 s52, s52, 98304
    s_cmp_ge_u32 s52, 1966080
    s_cselect_b32 s52, 0, s52
    s_add_u32 m0, s55, 98304
    s_nop 0
    buffer_load_dwordx4 v8, s[32:35], s53 offen lds
    s_add_u32 m0, s55, 99328
    s_nop 0
    buffer_load_dwordx4 v9, s[32:35], s53 offen lds
    s_waitcnt vmcnt(12)
    v_xor_b32 v6, s58, v65
    v_xor_b32 v7, s58, v67
    v_or_b32 v6, v6, v7
    v_xor_b32 v7, s58, v69
    v_or_b32 v6, v6, v7
    v_xor_b32 v7, s58, v71
    v_or_b32 v6, v6, v7
    v_xor_b32 v7, s58, v73
    v_or_b32 v6, v6, v7
    v_xor_b32 v7, s58, v78
    v_or_b32 v6, v6, v7
    s_mov_b32 s79, 200000
RT_8:
    v_cmp_ne_u32 vcc, 0, v6
    s_nop 1
    s_cmp_eq_u64 vcc, 0
    s_cbranch_scc1 RTOK_9
    s_sub_u32 s79, s79, 1
    s_cbranch_scc1 RTOK_9
    s_sleep 8

    v_lshrrev_b32 v19, 1, v2
    s_add_u32 s27, s68, 0
    buffer_load_dwordx2 v[64:65], v19, s[40:43], s27 offen sc1
    s_add_u32 s27, s68, 4096
    buffer_load_dwordx2 v[66:67], v19, s[40:43], s27 offen sc1
    s_add_u32 s27, s68, 10240
    buffer_load_dwordx2 v[68:69], v19, s[40:43], s27 offen sc1
    s_add_u32 s27, s68, 20480
    buffer_load_dwordx2 v[70:71], v19, s[40:43], s27 offen sc1
    s_add_u32 s27, s68, 26624
    buffer_load_dwordx2 v[72:73], v19, s[40:43], s27 offen sc1
    s_lshl_b32 s27, s25, 11
    s_and_b32 s29, s57, 1
    s_lshl_b32 s29, s29, 10
    s_add_u32 s27, s27, s29
    s_add_u32 s27, s27, 14155776
    buffer_load_dwordx4 v[76:79], v2, s[40:43], s27 offen sc1
    s_waitcnt vmcnt(0)
    v_xor_b32 v6, s58, v65
    v_xor_b32 v7, s58, v67
    v_or_b32 v6, v6, v7
    v_xor_b32 v7, s58, v69
    v_or_b32 v6, v6, v7
    v_xor_b32 v7, s58, v71
    v_or_b32 v6, v6, v7
    v_xor_b32 v7, s58, v73
    v_or_b32 v6, v6, v7
    v_xor_b32 v7, s58, v78
    v_or_b32 v6, v6, v7
    s_branch RT_8
RTOK_9:
    s_waitcnt vmcnt(16) lgkmcnt(0)
    s_barrier
    ds_read_b128 v[208:211], v28 offset:49152
    ds_read_b128 v[212:215], v28 offset:51200
    v_add_f32 v64, v64, v66
    v_add_f32 v64, v64, v68
    v_add_f32 v64, v64, v70
    v_add_f32 v64, v64, v72
    v_mul_f32 v78, v77, v77
    v_mov_b32 v77, v76
    v_mov_b32 v79, v78
    s_lshl_b32 s27, s57, 8
    s_add_u32 s27, s27, 147456
    v_lshl_add_u32 v6, v1, 2, s27
    ds_write_b32 v6, v64 offset:0
    s_and_b32 s27, s57, 1
    s_lshl_b32 s27, s27, 10
    s_add_u32 s27, s27, 147456
    v_add_u32 v6, s27, v2
    ds_write_b128 v6, v[76:79] offset:2048

    s_add_u32 m0, s55, 0
    s_nop 0
    buffer_load_dwordx4 v12, s[36:39], s52 offen lds
    s_add_u32 m0, s55, 1024
    s_nop 0
    buffer_load_dwordx4 v13, s[36:39], s52 offen lds
    s_add_u32 m0, s55, 2048
    s_nop 0
    buffer_load_dwordx4 v14, s[36:39], s52 offen lds
    s_add_u32 m0, s55, 3072
    s_nop 0
    buffer_load_dwordx4 v15, s[36:39], s52 offen lds
    s_add_u32 s52, s52, 98304
    s_cmp_ge_u32 s52, 1966080
    s_cselect_b32 s52, 0, s52
    s_add_u32 m0, s55, 100352
    s_nop 0
    buffer_load_dwordx4 v10, s[32:35], s53 offen lds
    s_add_u32 m0, s55, 101376
    s_nop 0
    buffer_load_dwordx4 v11, s[32:35], s53 offen lds
    s_add_u32 s53, s53, 128
    s_cmp_ge_u32 s53, 1280
    s_cselect_b32 s53, 0, s53
    s_waitcnt vmcnt(12) lgkmcnt(0)
    s_barrier
    ds_read_b128 v[216:219], v29 offset:49152
    ds_read_b128 v[220:223], v29 offset:51200
    s_add_u32 m0, s55, 16384
    s_nop 0
    buffer_load_dwordx4 v12, s[36:39], s52 offen lds
    s_add_u32 m0, s55, 17408
    s_nop 0
    buffer_load_dwordx4 v13, s[36:39], s52 offen lds
    s_add_u32 m0, s55, 18432
    s_nop 0
    buffer_load_dwordx4 v14, s[36:39], s52 offen lds
    s_add_u32 m0, s55, 19456
    s_nop 0
    buffer_load_dwordx4 v15, s[36:39], s52 offen lds
    s_add_u32 s52, s52, 98304
    s_cmp_ge_u32 s52, 1966080
    s_cselect_b32 s52, 0, s52
    s_and_b32 s27, s57, 1
    s_mul_i32 s27, s27, 98304
    s_mul_i32 s29, s26, 384
    s_add_u32 s29, s27, s29
    s_add_u32 s29, s29, 256
    v_lshrrev_b32 v6, 3, v1
    v_and_b32 v7, 6, v6
    v_and_b32 v12, 7, v1
    v_xor_b32 v12, v12, v7
    v_and_b32 v7, 3, v6
    v_lshrrev_b32 v6, 2, v6
    v_lshl_add_u32 v7, v6, 3, v7
    v_mul_u32_u24 v7, 3072, v7
    v_lshl_add_u32 v12, v12, 4, v7
    v_add_u32 v12, s29, v12
    v_add_u32 v13, 12288, v12
    v_add_u32 v14, 49152, v12
    v_add_u32 v15, 61440, v12

    s_add_u32 m0, s55, 114688
    s_nop 0
    buffer_load_dwordx4 v12, s[36:39], s52 offen lds
    s_add_u32 m0, s55, 115712
    s_nop 0
    buffer_load_dwordx4 v13, s[36:39], s52 offen lds
    s_add_u32 m0, s55, 116736
    s_nop 0
    buffer_load_dwordx4 v14, s[36:39], s52 offen lds
    s_add_u32 m0, s55, 117760
    s_nop 0
    buffer_load_dwordx4 v15, s[36:39], s52 offen lds
    s_add_u32 s52, s52, 196608
    s_cmp_ge_u32 s52, 1966080
    s_cselect_b32 s52, 0, s52
    s_waitcnt vmcnt(16) lgkmcnt(0)
    s_barrier
    ds_read_b128 v[224:227], v28 offset:0
    ds_read_b128 v[228:231], v28 offset:2048
    s_add_u32 m0, s55, 32768
    s_nop 0
    buffer_load_dwordx4 v12, s[36:39], s52 offen lds
    s_add_u32 m0, s55, 33792
    s_nop 0
    buffer_load_dwordx4 v13, s[36:39], s52 offen lds
    s_add_u32 m0, s55, 34816
    s_nop 0
    buffer_load_dwordx4 v14, s[36:39], s52 offen lds
    s_add_u32 m0, s55, 35840
    s_nop 0
    buffer_load_dwordx4 v15, s[36:39], s52 offen lds
    s_add_u32 s52, s52, 196608
    s_cmp_ge_u32 s52, 1966080
    s_cselect_b32 s52, 0, s52
    s_add_u32 m0, s55, 131072
    s_nop 0
    buffer_load_dwordx4 v12, s[36:39], s52 offen lds
    s_add_u32 m0, s55, 132096
    s_nop 0
    buffer_load_dwordx4 v13, s[36:39], s52 offen lds
    s_add_u32 m0, s55, 133120
    s_nop 0
    buffer_load_dwordx4 v14, s[36:39], s52 offen lds
    s_add_u32 m0, s55, 134144
    s_nop 0
    buffer_load_dwordx4 v15, s[36:39], s52 offen lds
    s_add_u32 s52, s52, 196608
    s_cmp_ge_u32 s52, 1966080
    s_cselect_b32 s52, 0, s52
    s_cmp_lg_u32 s24, 7
    s_cbranch_scc1 OW_10
    s_mov_b32 s27, 14974976
    buffer_load_dwordx4 v[80:83], v2, s[40:43], s27 offen sc1
    buffer_load_dwordx4 v[84:87], v2, s[40:43], s27 offen offset:1024 sc1
OW_10:
    s_waitcnt vmcnt(8) lgkmcnt(0)
    s_barrier
    ds_read_b128 v[232:235], v29 offset:0
    ds_read_b128 v[236:239], v29 offset:2048
    v_add_u32 v6, 114688, v18
    v_xor_b32 v7, 32, v6
    ds_read_b64_tr_b16 v[48:49], v6 offset:0
    ds_read_b64_tr_b16 v[50:51], v6 offset:1024
    ds_read_b64_tr_b16 v[52:53], v7 offset:0
    ds_read_b64_tr_b16 v[54:55], v7 offset:1024
    ds_read_b64_tr_b16 v[56:57], v6 offset:4096
    ds_read_b64_tr_b16 v[58:59], v6 offset:5120
    ds_read_b64_tr_b16 v[60:61], v7 offset:4096
    ds_read_b64_tr_b16 v[62:63], v7 offset:5120
    s_add_u32 m0, s55, 49152
    s_nop 0
    buffer_load_dwordx4 v12, s[36:39], s52 offen lds
    s_add_u32 m0, s55, 50176
    s_nop 0
    buffer_load_dwordx4 v13, s[36:39], s52 offen lds
    s_add_u32 m0, s55, 51200
    s_nop 0
    buffer_load_dwordx4 v14, s[36:39], s52 offen lds
    s_add_u32 m0, s55, 52224
    s_nop 0
    buffer_load_dwordx4 v15, s[36:39], s52 offen lds
    s_add_u32 s52, s52, 196608
    s_cmp_ge_u32 s52, 1966080
    s_cselect_b32 s52, 0, s52
    s_waitcnt lgkmcnt(0)
    v_mfma_f32_16x16x32_bf16 v[32:35], v[20:23], v[48:51], 0
    v_mfma_f32_16x16x32_bf16 v[36:39], v[20:23], v[52:55], 0
    v_mfma_f32_16x16x32_bf16 v[32:35], v[20:23], v[56:59], v[32:35]
    v_mfma_f32_16x16x32_bf16 v[36:39], v[20:23], v[60:63], v[36:39]
    s_waitcnt vmcnt(8) lgkmcnt(0)
    s_barrier
    ds_read_b128 v[240:243], v28 offset:16384
    ds_read_b128 v[244:247], v28 offset:18432
    ds_read_b128 v[248:251], v29 offset:16384
    ds_read_b128 v[252:255], v29 offset:18432
    v_add_u32 v6, 32768, v18
    v_xor_b32 v7, 32, v6
    ds_read_b64_tr_b16 v[48:49], v6 offset:0
    ds_read_b64_tr_b16 v[50:51], v6 offset:1024
    ds_read_b64_tr_b16 v[52:53], v7 offset:0
    ds_read_b64_tr_b16 v[54:55], v7 offset:1024
    ds_read_b64_tr_b16 v[56:57], v6 offset:4096
    ds_read_b64_tr_b16 v[58:59], v6 offset:5120
    ds_read_b64_tr_b16 v[60:61], v7 offset:4096
    ds_read_b64_tr_b16 v[62:63], v7 offset:5120
    s_add_u32 m0, s55, 65536
    s_nop 0
    buffer_load_dwordx4 v12, s[36:39], s52 offen lds
    s_add_u32 m0, s55, 66560
    s_nop 0
    buffer_load_dwordx4 v13, s[36:39], s52 offen lds
    s_add_u32 m0, s55, 67584
    s_nop 0
    buffer_load_dwordx4 v14, s[36:39], s52 offen lds
    s_add_u32 m0, s55, 68608
    s_nop 0
    buffer_load_dwordx4 v15, s[36:39], s52 offen lds
    s_add_u32 s52, s52, 196608
    s_cmp_ge_u32 s52, 1966080
    s_cselect_b32 s52, 0, s52
    s_add_u32 m0, s55, 81920
    s_nop 0
    buffer_load_dwordx4 v12, s[36:39], s52 offen lds
    s_add_u32 m0, s55, 82944
    s_nop 0
    buffer_load_dwordx4 v13, s[36:39], s52 offen lds
    s_add_u32 m0, s55, 83968
    s_nop 0
    buffer_load_dwordx4 v14, s[36:39], s52 offen lds
    s_add_u32 m0, s55, 84992
    s_nop 0
    buffer_load_dwordx4 v15, s[36:39], s52 offen lds
    s_add_u32 s52, s52, 196608
    s_cmp_ge_u32 s52, 1966080
    s_cselect_b32 s52, 0, s52
    s_waitcnt lgkmcnt(0)
    v_mfma_f32_16x16x32_bf16 v[32:35], v[20:23], v[48:51], v[32:35]
    v_mfma_f32_16x16x32_bf16 v[36:39], v[20:23], v[52:55], v[36:39]
    v_mfma_f32_16x16x32_bf16 v[32:35], v[20:23], v[56:59], v[32:35]
    v_mfma_f32_16x16x32_bf16 v[36:39], v[20:23], v[60:63], v[36:39]
    s_cmp_lg_u32 s24, 7
    s_cbranch_scc1 OW_11
    s_waitcnt vmcnt(12)
    s_mov_b32 s79, 200000
RF_12:
    v_cmp_ne_u64 vcc, s[58:59], v[80:81]
    v_cmp_ne_u64 s[60:61], s[58:59], v[82:83]
    v_cmp_ne_u64 s[62:63], s[58:59], v[84:85]
    s_or_b64 s[60:61], s[60:61], vcc
    v_cmp_ne_u64 vcc, s[58:59], v[86:87]
    s_or_b64 s[60:61], s[60:61], s[62:63]
    s_nop 0
    s_or_b64 s[60:61], s[60:61], vcc
    s_cbranch_scc0 RFOK_13
    s_sub_u32 s79, s79, 1
    s_cbranch_scc1 RFOK_13
    s_sleep 16

    s_mov_b32 s27, 14974976
    buffer_load_dwordx4 v[80:83], v2, s[40:43], s27 offen sc1
    buffer_load_dwordx4 v[84:87], v2, s[40:43], s27 offen offset:1024 sc1
    s_waitcnt vmcnt(0)
    s_branch RF_12
RFOK_13:
OW_11:
    s_nop 7
    v_cmp_gt_u32 vcc, 16, v1
    v_mov_b32 v49, s58
    v_lshrrev_b32 v6, 1, v2
    s_lshl_b32 s27, s26, 14
    s_lshl_b32 s29, s25, 10
    s_add_u32 s27, s27, s29
    s_lshl_b32 s29, s57, 8
    s_add_u32 s27, s27, s29
    s_add_u32 s27, s27, 13893632
    v_cndmask_b32 v48, v36, v32, vcc
    s_mov_b32 exec_hi, 0

    buffer_store_dwordx2 v[48:49], v6, s[40:43], s27 offen sc1
    s_mov_b64 exec, -1
    s_waitcnt vmcnt(9) lgkmcnt(0)
    s_barrier
    v_mov_b32 v30, 147456
    v_mov_b32 v31, 1
    s_setprio 2
    v_bfe_u32 v8, v1, 2, 3
    v_lshrrev_b32 v6, 5, v1
    v_lshl_add_u32 v8, v6, 4, v8
    v_mul_u32_u24 v8, 128, v8

    v_bfe_u32 v6, v1, 3, 2
    v_lshlrev_b32 v6, 5, v6
    v_and_b32 v7, 3, v1
    v_lshl_add_u32 v6, v7, 3, v6
    v_add_u32 v8, v8, v6

    v_xor_b32 v9, 32, v8
    v_xor_b32 v10, 64, v8
    v_xor_b32 v11, 96, v8
    v_add_u32 v8, 65536, v8
    v_add_u32 v9, 65536, v9
    v_add_u32 v10, 65536, v10
    v_add_u32 v11, 65536, v11
    ds_read_b64_tr_b16 v[16:17], v8 offset:49152
    ds_read_b64_tr_b16 v[18:19], v8 offset:50176
    ds_read_b64_tr_b16 v[20:21], v9 offset:49152
    ds_read_b64_tr_b16 v[22:23], v9 offset:50176
    ds_read_b64_tr_b16 v[24:25], v10 offset:49152
    ds_read_b64_tr_b16 v[26:27], v10 offset:50176
    s_waitcnt lgkmcnt(4)
    v_mfma_f32_16x16x32_bf16 v[32:35], v[16:19], v[96:99], 0
    v_mfma_f32_16x16x32_bf16 v[36:39], v[16:19], v[100:103], 0
    ds_read_b64_tr_b16 v[16:17], v11 offset:49152
    ds_read_b64_tr_b16 v[18:19], v11 offset:50176
    s_waitcnt lgkmcnt(4)
    v_mfma_f32_16x16x32_bf16 v[40:43], v[20:23], v[96:99], 0
    v_mfma_f32_16x16x32_bf16 v[44:47], v[20:23], v[100:103], 0
    s_add_u32 m0, s55, 0
    s_nop 0
    buffer_load_dwordx4 v12, s[36:39], s52 offen lds
    ds_read_b64_tr_b16 v[20:21], v8 offset:57344
    ds_read_b64_tr_b16 v[22:23], v8 offset:58368
    s_waitcnt lgkmcnt(4)
    v_mfma_f32_16x16x32_bf16 v[48:51], v[24:27], v[96:99], 0
    v_mfma_f32_16x16x32_bf16 v[52:55], v[24:27], v[100:103], 0
    ds_read_b64_tr_b16 v[24:25], v9 offset:57344
    ds_read_b64_tr_b16 v[26:27], v9 offset:58368
    s_waitcnt lgkmcnt(4)
    v_mfma_f32_16x16x32_bf16 v[56:59], v[16:19], v[96:99], 0
    v_mfma_f32_16x16x32_bf16 v[60:63], v[16:19], v[100:103], 0
    s_add_u32 m0, s55, 1024
    s_nop 0
    buffer_load_dwordx4 v13, s[36:39], s52 offen lds
    ds_read_b64_tr_b16 v[16:17], v10 offset:57344
    ds_read_b64_tr_b16 v[18:19], v10 offset:58368
    s_waitcnt lgkmcnt(4)
    v_mfma_f32_16x16x32_bf16 v[64:67], v[20:23], v[96:99], 0
    v_mfma_f32_16x16x32_bf16 v[68:71], v[20:23], v[100:103], 0
    ds_read_b64_tr_b16 v[20:21], v11 offset:57344
    ds_read_b64_tr_b16 v[22:23], v11 offset:58368
    s_waitcnt lgkmcnt(4)
    v_mfma_f32_16x16x32_bf16 v[72:75], v[24:27], v[96:99], 0
    v_mfma_f32_16x16x32_bf16 v[76:79], v[24:27], v[100:103], 0
    s_add_u32 m0, s55, 2048
    s_nop 0
    buffer_load_dwordx4 v14, s[36:39], s52 offen lds
    ds_read_b64_tr_b16 v[24:25], v8 offset:53248
    ds_read_b64_tr_b16 v[26:27], v8 offset:54272
    s_waitcnt lgkmcnt(4)
    v_mfma_f32_16x16x32_bf16 v[80:83], v[16:19], v[96:99], 0
    v_mfma_f32_16x16x32_bf16 v[84:87], v[16:19], v[100:103], 0
    ds_read_b64_tr_b16 v[16:17], v9 offset:53248
    ds_read_b64_tr_b16 v[18:19], v9 offset:54272
    s_waitcnt lgkmcnt(4)
    v_mfma_f32_16x16x32_bf16 v[88:91], v[20:23], v[96:99], 0
    v_mfma_f32_16x16x32_bf16 v[92:95], v[20:23], v[100:103], 0
    s_add_u32 m0, s55, 3072
    s_nop 0
    buffer_load_dwordx4 v15, s[36:39], s52 offen lds
    s_add_u32 s52, s52, 196608
    s_cmp_ge_u32 s52, 1966080
    s_cselect_b32 s52, 0, s52
    ds_read_b64_tr_b16 v[20:21], v10 offset:53248
    ds_read_b64_tr_b16 v[22:23], v10 offset:54272
    ds_read_b64_tr_b16 v[96:97], v11 offset:53248
    ds_read_b64_tr_b16 v[98:99], v11 offset:54272
    ds_read_b64_tr_b16 v[100:101], v8 offset:61440
    ds_read_b64_tr_b16 v[102:103], v8 offset:62464
    s_waitcnt lgkmcnt(8)
    v_mfma_f32_16x16x32_bf16 v[32:35], v[24:27], v[104:107], v[32:35]
    v_mfma_f32_16x16x32_bf16 v[36:39], v[24:27], v[108:111], v[36:39]
    ds_read_b64_tr_b16 v[24:25], v9 offset:61440
    ds_read_b64_tr_b16 v[26:27], v9 offset:62464
    s_waitcnt lgkmcnt(8)
    v_mfma_f32_16x16x32_bf16 v[40:43], v[16:19], v[104:107], v[40:43]
    v_mfma_f32_16x16x32_bf16 v[44:47], v[16:19], v[108:111], v[44:47]
    ds_read_b64_tr_b16 v[16:17], v10 offset:61440
    ds_read_b64_tr_b16 v[18:19], v10 offset:62464
    s_waitcnt lgkmcnt(8)
    v_mfma_f32_16x16x32_bf16 v[48:51], v[20:23], v[104:107], v[48:51]
    v_mfma_f32_16x16x32_bf16 v[52:55], v[20:23], v[108:111], v[52:55]
    ds_read_b64_tr_b16 v[20:21], v11 offset:61440
    ds_read_b64_tr_b16 v[22:23], v11 offset:62464
    s_waitcnt lgkmcnt(8)
    v_mfma_f32_16x16x32_bf16 v[56:59], v[96:99], v[104:107], v[56:59]
    v_mfma_f32_16x16x32_bf16 v[60:63], v[96:99], v[108:111], v[60:63]
    v_add_u32 v8, 4294901760, v8
    v_add_u32 v9, 4294901760, v9
    v_add_u32 v10, 4294901760, v10
    v_add_u32 v11, 4294901760, v11
    ds_read_b64_tr_b16 v[96:97], v8 offset:32768
    ds_read_b64_tr_b16 v[98:99], v8 offset:33792
    s_waitcnt lgkmcnt(8)
    v_mfma_f32_16x16x32_bf16 v[64:67], v[100:103], v[104:107], v[64:67]
    v_mfma_f32_16x16x32_bf16 v[68:71], v[100:103], v[108:111], v[68:71]
    ds_read_b64_tr_b16 v[100:101], v9 offset:32768
    ds_read_b64_tr_b16 v[102:103], v9 offset:33792
    s_waitcnt lgkmcnt(8)
    v_mfma_f32_16x16x32_bf16 v[72:75], v[24:27], v[104:107], v[72:75]
    v_mfma_f32_16x16x32_bf16 v[76:79], v[24:27], v[108:111], v[76:79]
    ds_read_b64_tr_b16 v[24:25], v10 offset:32768
    ds_read_b64_tr_b16 v[26:27], v10 offset:33792
    s_waitcnt lgkmcnt(8)
    v_mfma_f32_16x16x32_bf16 v[80:83], v[16:19], v[104:107], v[80:83]
    v_mfma_f32_16x16x32_bf16 v[84:87], v[16:19], v[108:111], v[84:87]
    ds_read_b64_tr_b16 v[16:17], v11 offset:32768
    ds_read_b64_tr_b16 v[18:19], v11 offset:33792
    s_waitcnt lgkmcnt(8)
    v_mfma_f32_16x16x32_bf16 v[88:91], v[20:23], v[104:107], v[88:91]
    v_mfma_f32_16x16x32_bf16 v[92:95], v[20:23], v[108:111], v[92:95]
    ds_read_b64_tr_b16 v[20:21], v8 offset:40960
    ds_read_b64_tr_b16 v[22:23], v8 offset:41984
    ds_read_b64_tr_b16 v[104:105], v9 offset:40960
    ds_read_b64_tr_b16 v[106:107], v9 offset:41984
    ds_read_b64_tr_b16 v[108:109], v10 offset:40960
    ds_read_b64_tr_b16 v[110:111], v10 offset:41984
    s_waitcnt lgkmcnt(10)
    v_mfma_f32_16x16x32_bf16 v[32:35], v[96:99], v[112:115], v[32:35]
    v_mfma_f32_16x16x32_bf16 v[36:39], v[96:99], v[116:119], v[36:39]
LS_14:
    ds_read_b32 v6, v30 offset:8224
    s_waitcnt lgkmcnt(0)
    v_readfirstlane_b32 s27, v6
    s_nop 1
    s_cmp_ge_u32 s27, 4
    s_cbranch_scc1 LS_14_D
    s_sleep 2
    s_branch LS_14

LS_14_D:
    ds_read_b64_tr_b16 v[96:97], v11 offset:40960
    ds_read_b64_tr_b16 v[98:99], v11 offset:41984
    v_mfma_f32_16x16x32_bf16 v[40:43], v[100:103], v[112:115], v[40:43]
    v_mfma_f32_16x16x32_bf16 v[44:47], v[100:103], v[116:119], v[44:47]
    s_add_u32 m0, s55, 16384
    s_nop 0
    buffer_load_dwordx4 v12, s[36:39], s52 offen lds
    ds_read_b64_tr_b16 v[100:101], v8 offset:36864
    ds_read_b64_tr_b16 v[102:103], v8 offset:37888
    v_mfma_f32_16x16x32_bf16 v[48:51], v[24:27], v[112:115], v[48:51]
    v_mfma_f32_16x16x32_bf16 v[52:55], v[24:27], v[116:119], v[52:55]
    ds_read_b64_tr_b16 v[24:25], v9 offset:36864
    ds_read_b64_tr_b16 v[26:27], v9 offset:37888
    v_mfma_f32_16x16x32_bf16 v[56:59], v[16:19], v[112:115], v[56:59]
    v_mfma_f32_16x16x32_bf16 v[60:63], v[16:19], v[116:119], v[60:63]
    s_add_u32 m0, s55, 17408
    s_nop 0
    buffer_load_dwordx4 v13, s[36:39], s52 offen lds
    ds_read_b64_tr_b16 v[16:17], v10 offset:36864
    ds_read_b64_tr_b16 v[18:19], v10 offset:37888
    v_mfma_f32_16x16x32_bf16 v[64:67], v[20:23], v[112:115], v[64:67]
    v_mfma_f32_16x16x32_bf16 v[68:71], v[20:23], v[116:119], v[68:71]
    ds_read_b64_tr_b16 v[20:21], v11 offset:36864
    ds_read_b64_tr_b16 v[22:23], v11 offset:37888
    v_mfma_f32_16x16x32_bf16 v[72:75], v[104:107], v[112:115], v[72:75]
    v_mfma_f32_16x16x32_bf16 v[76:79], v[104:107], v[116:119], v[76:79]
    s_add_u32 m0, s55, 18432
    s_nop 0
    buffer_load_dwordx4 v14, s[36:39], s52 offen lds
    ds_read_b64_tr_b16 v[104:105], v8 offset:45056
    ds_read_b64_tr_b16 v[106:107], v8 offset:46080
    v_mfma_f32_16x16x32_bf16 v[80:83], v[108:111], v[112:115], v[80:83]
    v_mfma_f32_16x16x32_bf16 v[84:87], v[108:111], v[116:119], v[84:87]
    ds_read_b64_tr_b16 v[108:109], v9 offset:45056
    ds_read_b64_tr_b16 v[110:111], v9 offset:46080
    s_waitcnt lgkmcnt(12)
    v_mfma_f32_16x16x32_bf16 v[88:91], v[96:99], v[112:115], v[88:91]
    v_mfma_f32_16x16x32_bf16 v[92:95], v[96:99], v[116:119], v[92:95]
    s_mov_b64 exec, 1
    ds_add_u32 v30, v31 offset:8220
    s_mov_b64 exec, -1
    s_add_u32 m0, s55, 19456
    s_nop 0
    buffer_load_dwordx4 v15, s[36:39], s52 offen lds
    s_add_u32 s52, s52, 196608
    s_cmp_ge_u32 s52, 1966080
    s_cselect_b32 s52, 0, s52
    ds_read_b64_tr_b16 v[96:97], v10 offset:45056
    ds_read_b64_tr_b16 v[98:99], v10 offset:46080
    ds_read_b64_tr_b16 v[112:113], v11 offset:45056
    ds_read_b64_tr_b16 v[114:115], v11 offset:46080
    s_waitcnt lgkmcnt(13)
    v_mfma_f32_16x16x32_bf16 v[32:35], v[100:103], v[120:123], v[32:35]
    v_mfma_f32_16x16x32_bf16 v[36:39], v[100:103], v[124:127], v[36:39]
    v_add_u32 v8, 131072, v8
    v_add_u32 v9, 131072, v9
    v_add_u32 v10, 131072, v10
    v_add_u32 v11, 131072, v11
    ds_read_b64_tr_b16 v[116:117], v8 offset:0
    ds_read_b64_tr_b16 v[118:119], v8 offset:1024
    v_mfma_f32_16x16x32_bf16 v[40:43], v[24:27], v[120:123], v[40:43]
    v_mfma_f32_16x16x32_bf16 v[44:47], v[24:27], v[124:127], v[44:47]
    s_add_u32 m0, s55, 98304
    s_nop 0
    buffer_load_dwordx4 v12, s[36:39], s52 offen lds
    ds_read_b64_tr_b16 v[100:101], v9 offset:0
    ds_read_b64_tr_b16 v[102:103], v9 offset:1024
    s_waitcnt lgkmcnt(13)
    v_mfma_f32_16x16x32_bf16 v[48:51], v[16:19], v[120:123], v[48:51]
    v_mfma_f32_16x16x32_bf16 v[52:55], v[16:19], v[124:127], v[52:55]
    ds_read_b64_tr_b16 v[24:25], v10 offset:0
    ds_read_b64_tr_b16 v[26:27], v10 offset:1024
    v_mfma_f32_16x16x32_bf16 v[56:59], v[20:23], v[120:123], v[56:59]
    v_mfma_f32_16x16x32_bf16 v[60:63], v[20:23], v[124:127], v[60:63]
    s_add_u32 m0, s55, 99328
    s_nop 0
    buffer_load_dwordx4 v13, s[36:39], s52 offen lds
    ds_read_b64_tr_b16 v[16:17], v11 offset:0
    ds_read_b64_tr_b16 v[18:19], v11 offset:1024
    s_waitcnt lgkmcnt(13)
    v_mfma_f32_16x16x32_bf16 v[64:67], v[104:107], v[120:123], v[64:67]
    v_mfma_f32_16x16x32_bf16 v[68:71], v[104:107], v[124:127], v[68:71]
    ds_read_b64_tr_b16 v[20:21], v8 offset:8192
    ds_read_b64_tr_b16 v[22:23], v8 offset:9216
    v_mfma_f32_16x16x32_bf16 v[72:75], v[108:111], v[120:123], v[72:75]
    v_mfma_f32_16x16x32_bf16 v[76:79], v[108:111], v[124:127], v[76:79]
    s_add_u32 m0, s55, 100352
    s_nop 0
    buffer_load_dwordx4 v14, s[36:39], s52 offen lds
    ds_read_b64_tr_b16 v[104:105], v9 offset:8192
    ds_read_b64_tr_b16 v[106:107], v9 offset:9216
    s_waitcnt lgkmcnt(12)
    v_mfma_f32_16x16x32_bf16 v[80:83], v[96:99], v[120:123], v[80:83]
    v_mfma_f32_16x16x32_bf16 v[84:87], v[96:99], v[124:127], v[84:87]
    ds_read_b64_tr_b16 v[108:109], v10 offset:8192
    ds_read_b64_tr_b16 v[110:111], v10 offset:9216
    v_mfma_f32_16x16x32_bf16 v[88:91], v[112:115], v[120:123], v[88:91]
    v_mfma_f32_16x16x32_bf16 v[92:95], v[112:115], v[124:127], v[92:95]
    s_add_u32 m0, s55, 101376
    s_nop 0
    buffer_load_dwordx4 v15, s[36:39], s52 offen lds
    s_add_u32 s52, s52, 196608
    s_cmp_ge_u32 s52, 1966080
    s_cselect_b32 s52, 0, s52
    ds_read_b64_tr_b16 v[96:97], v11 offset:8192
    ds_read_b64_tr_b16 v[98:99], v11 offset:9216
    s_waitcnt lgkmcnt(12)
    v_mfma_f32_16x16x32_bf16 v[32:35], v[116:119], v[128:131], v[32:35]
    v_mfma_f32_16x16x32_bf16 v[36:39], v[116:119], v[132:135], v[36:39]
    ds_read_b64_tr_b16 v[112:113], v8 offset:4096
    ds_read_b64_tr_b16 v[114:115], v8 offset:5120
    v_mfma_f32_16x16x32_bf16 v[40:43], v[100:103], v[128:131], v[40:43]
    v_mfma_f32_16x16x32_bf16 v[44:47], v[100:103], v[132:135], v[44:47]
    ds_read_b64_tr_b16 v[116:117], v9 offset:4096
    ds_read_b64_tr_b16 v[118:119], v9 offset:5120
    s_waitcnt lgkmcnt(12)
    v_mfma_f32_16x16x32_bf16 v[48:51], v[24:27], v[128:131], v[48:51]
    v_mfma_f32_16x16x32_bf16 v[52:55], v[24:27], v[132:135], v[52:55]
    ds_read_b64_tr_b16 v[100:101], v10 offset:4096
    ds_read_b64_tr_b16 v[102:103], v10 offset:5120
    v_mfma_f32_16x16x32_bf16 v[56:59], v[16:19], v[128:131], v[56:59]
    v_mfma_f32_16x16x32_bf16 v[60:63], v[16:19], v[132:135], v[60:63]
    ds_read_b64_tr_b16 v[24:25], v11 offset:4096
    ds_read_b64_tr_b16 v[26:27], v11 offset:5120
    s_waitcnt lgkmcnt(12)
    v_mfma_f32_16x16x32_bf16 v[64:67], v[20:23], v[128:131], v[64:67]
    v_mfma_f32_16x16x32_bf16 v[68:71], v[20:23], v[132:135], v[68:71]
    ds_read_b64_tr_b16 v[16:17], v8 offset:12288
    ds_read_b64_tr_b16 v[18:19], v8 offset:13312
    v_mfma_f32_16x16x32_bf16 v[72:75], v[104:107], v[128:131], v[72:75]
    v_mfma_f32_16x16x32_bf16 v[76:79], v[104:107], v[132:135], v[76:79]
    ds_read_b64_tr_b16 v[20:21], v9 offset:12288
    ds_read_b64_tr_b16 v[22:23], v9 offset:13312
    s_waitcnt lgkmcnt(12)
    v_mfma_f32_16x16x32_bf16 v[80:83], v[108:111], v[128:131], v[80:83]
    v_mfma_f32_16x16x32_bf16 v[84:87], v[108:111], v[132:135], v[84:87]
    ds_read_b64_tr_b16 v[104:105], v10 offset:12288
    ds_read_b64_tr_b16 v[106:107], v10 offset:13312
    v_mfma_f32_16x16x32_bf16 v[88:91], v[96:99], v[128:131], v[88:91]
    v_mfma_f32_16x16x32_bf16 v[92:95], v[96:99], v[132:135], v[92:95]
    ds_read_b64_tr_b16 v[108:109], v11 offset:12288
    ds_read_b64_tr_b16 v[110:111], v11 offset:13312
    s_waitcnt lgkmcnt(12)
    v_mfma_f32_16x16x32_bf16 v[32:35], v[112:115], v[136:139], v[32:35]
    v_mfma_f32_16x16x32_bf16 v[36:39], v[112:115], v[140:143], v[36:39]
LS_15:
    ds_read_b32 v6, v30 offset:8220
    s_waitcnt lgkmcnt(0)
    v_readfirstlane_b32 s27, v6
    s_nop 1
    s_cmp_ge_u32 s27, 4
    s_cbranch_scc1 LS_15_D
    s_sleep 2
    s_branch LS_15

LS_15_D:
    v_add_u32 v8, 4294836224, v8
    v_add_u32 v9, 4294836224, v9
    v_add_u32 v10, 4294836224, v10
    v_add_u32 v11, 4294836224, v11
    ds_read_b64_tr_b16 v[96:97], v8 offset:49152
    ds_read_b64_tr_b16 v[98:99], v8 offset:50176
    v_mfma_f32_16x16x32_bf16 v[40:43], v[116:119], v[136:139], v[40:43]
    v_mfma_f32_16x16x32_bf16 v[44:47], v[116:119], v[140:143], v[44:47]
    s_add_u32 m0, s55, 114688
    s_nop 0
    buffer_load_dwordx4 v12, s[36:39], s52 offen lds
    ds_read_b64_tr_b16 v[112:113], v9 offset:49152
    ds_read_b64_tr_b16 v[114:115], v9 offset:50176
    v_mfma_f32_16x16x32_bf16 v[48:51], v[100:103], v[136:139], v[48:51]
    v_mfma_f32_16x16x32_bf16 v[52:55], v[100:103], v[140:143], v[52:55]
    ds_read_b64_tr_b16 v[116:117], v10 offset:49152
    ds_read_b64_tr_b16 v[118:119], v10 offset:50176
    v_mfma_f32_16x16x32_bf16 v[56:59], v[24:27], v[136:139], v[56:59]
    v_mfma_f32_16x16x32_bf16 v[60:63], v[24:27], v[140:143], v[60:63]
    s_add_u32 m0, s55, 115712
    s_nop 0
    buffer_load_dwordx4 v13, s[36:39], s52 offen lds
    ds_read_b64_tr_b16 v[100:101], v11 offset:49152
    ds_read_b64_tr_b16 v[102:103], v11 offset:50176
    v_mfma_f32_16x16x32_bf16 v[64:67], v[16:19], v[136:139], v[64:67]
    v_mfma_f32_16x16x32_bf16 v[68:71], v[16:19], v[140:143], v[68:71]
    ds_read_b64_tr_b16 v[24:25], v8 offset:57344
    ds_read_b64_tr_b16 v[26:27], v8 offset:58368
    v_mfma_f32_16x16x32_bf16 v[72:75], v[20:23], v[136:139], v[72:75]
    v_mfma_f32_16x16x32_bf16 v[76:79], v[20:23], v[140:143], v[76:79]
    s_add_u32 m0, s55, 116736
    s_nop 0
    buffer_load_dwordx4 v14, s[36:39], s52 offen lds
    ds_read_b64_tr_b16 v[16:17], v9 offset:57344
    ds_read_b64_tr_b16 v[18:19], v9 offset:58368
    v_mfma_f32_16x16x32_bf16 v[80:83], v[104:107], v[136:139], v[80:83]
    v_mfma_f32_16x16x32_bf16 v[84:87], v[104:107], v[140:143], v[84:87]
    ds_read_b64_tr_b16 v[20:21], v10 offset:57344
    ds_read_b64_tr_b16 v[22:23], v10 offset:58368
    v_mfma_f32_16x16x32_bf16 v[88:91], v[108:111], v[136:139], v[88:91]
    v_mfma_f32_16x16x32_bf16 v[92:95], v[108:111], v[140:143], v[92:95]
    s_add_u32 m0, s55, 117760
    s_nop 0
    buffer_load_dwordx4 v15, s[36:39], s52 offen lds
    s_add_u32 s52, s52, 196608
    s_cmp_ge_u32 s52, 1966080
    s_cselect_b32 s52, 0, s52
    ds_read_b64_tr_b16 v[104:105], v11 offset:57344
    ds_read_b64_tr_b16 v[106:107], v11 offset:58368
    s_waitcnt lgkmcnt(12)
    v_mfma_f32_16x16x32_bf16 v[32:35], v[96:99], v[144:147], v[32:35]
    v_mfma_f32_16x16x32_bf16 v[36:39], v[96:99], v[148:151], v[36:39]
    s_add_u32 s65, s72, 163840
    s_mul_i32 s67, s83, 81920
    s_add_u32 s67, s67, s82
    s_add_u32 s67, s67, 1966080
    s_and_b32 s69, s83, 3
    s_mul_i32 s69, s69, 40960
    s_add_u32 s69, s69, s82
    s_add_u32 s69, s69, 2621440

    s_waitcnt vmcnt(12)
    s_mov_b64 exec, 1
    ds_add_u32 v30, v31 offset:8208
    s_mov_b64 exec, -1
    ds_read_b64_tr_b16 v[108:109], v8 offset:53248
    ds_read_b64_tr_b16 v[110:111], v8 offset:54272
    v_mfma_f32_16x16x32_bf16 v[40:43], v[112:115], v[144:147], v[40:43]
    v_mfma_f32_16x16x32_bf16 v[44:47], v[112:115], v[148:151], v[44:47]
    ds_read_b64_tr_b16 v[96:97], v9 offset:53248
    ds_read_b64_tr_b16 v[98:99], v9 offset:54272
    s_waitcnt lgkmcnt(13)
    v_mfma_f32_16x16x32_bf16 v[48:51], v[116:119], v[144:147], v[48:51]
    v_mfma_f32_16x16x32_bf16 v[52:55], v[116:119], v[148:151], v[52:55]
    ds_read_b64_tr_b16 v[112:113], v10 offset:53248
    ds_read_b64_tr_b16 v[114:115], v10 offset:54272
    v_mfma_f32_16x16x32_bf16 v[56:59], v[100:103], v[144:147], v[56:59]
    v_mfma_f32_16x16x32_bf16 v[60:63], v[100:103], v[148:151], v[60:63]
    s_add_u32 s27, s67, 1024
    buffer_load_dwordx4 v[120:123], v2, s[40:43], s27 offen sc1
    ds_read_b64_tr_b16 v[116:117], v11 offset:53248
    ds_read_b64_tr_b16 v[118:119], v11 offset:54272
    s_waitcnt lgkmcnt(13)
    v_mfma_f32_16x16x32_bf16 v[64:67], v[24:27], v[144:147], v[64:67]
    v_mfma_f32_16x16x32_bf16 v[68:71], v[24:27], v[148:151], v[68:71]
    ds_read_b64_tr_b16 v[100:101], v8 offset:61440
    ds_read_b64_tr_b16 v[102:103], v8 offset:62464
    v_mfma_f32_16x16x32_bf16 v[72:75], v[16:19], v[144:147], v[72:75]
    v_mfma_f32_16x16x32_bf16 v[76:79], v[16:19], v[148:151], v[76:79]
    ds_read_b64_tr_b16 v[24:25], v9 offset:61440
    ds_read_b64_tr_b16 v[26:27], v9 offset:62464
    s_waitcnt lgkmcnt(13)
    v_mfma_f32_16x16x32_bf16 v[80:83], v[20:23], v[144:147], v[80:83]
    v_mfma_f32_16x16x32_bf16 v[84:87], v[20:23], v[148:151], v[84:87]
    ds_read_b64_tr_b16 v[16:17], v10 offset:61440
    ds_read_b64_tr_b16 v[18:19], v10 offset:62464
    v_mfma_f32_16x16x32_bf16 v[88:91], v[104:107], v[144:147], v[88:91]
    v_mfma_f32_16x16x32_bf16 v[92:95], v[104:107], v[148:151], v[92:95]
    ds_read_b64_tr_b16 v[20:21], v11 offset:61440
    ds_read_b64_tr_b16 v[22:23], v11 offset:62464
    s_waitcnt lgkmcnt(12)
    v_mfma_f32_16x16x32_bf16 v[32:35], v[108:111], v[152:155], v[32:35]
    v_mfma_f32_16x16x32_bf16 v[36:39], v[108:111], v[156:159], v[36:39]
LS_16:
    ds_read_b32 v6, v30 offset:8208
    s_waitcnt lgkmcnt(0)
    v_readfirstlane_b32 s27, v6
    s_nop 1
    s_cmp_ge_u32 s27, 4
    s_cbranch_scc1 LS_16_D
    s_sleep 2
    s_branch LS_16

LS_16_D:
    v_add_u32 v8, 65536, v8
    v_add_u32 v9, 65536, v9
    v_add_u32 v10, 65536, v10
    v_add_u32 v11, 65536, v11
    ds_read_b64_tr_b16 v[104:105], v8 offset:0
    ds_read_b64_tr_b16 v[106:107], v8 offset:1024
    v_mfma_f32_16x16x32_bf16 v[40:43], v[96:99], v[152:155], v[40:43]
    v_mfma_f32_16x16x32_bf16 v[44:47], v[96:99], v[156:159], v[44:47]
    ds_read_b64_tr_b16 v[108:109], v9 offset:0
    ds_read_b64_tr_b16 v[110:111], v9 offset:1024
    v_mfma_f32_16x16x32_bf16 v[48:51], v[112:115], v[152:155], v[48:51]
    v_mfma_f32_16x16x32_bf16 v[52:55], v[112:115], v[156:159], v[52:55]
    ds_read_b64_tr_b16 v[96:97], v10 offset:0
    ds_read_b64_tr_b16 v[98:99], v10 offset:1024
    v_mfma_f32_16x16x32_bf16 v[56:59], v[116:119], v[152:155], v[56:59]
    v_mfma_f32_16x16x32_bf16 v[60:63], v[116:119], v[156:159], v[60:63]
    s_add_u32 s27, s67, 2048
    buffer_load_dwordx4 v[124:127], v2, s[40:43], s27 offen sc1
    ds_read_b64_tr_b16 v[112:113], v11 offset:0
    ds_read_b64_tr_b16 v[114:115], v11 offset:1024
    v_mfma_f32_16x16x32_bf16 v[64:67], v[100:103], v[152:155], v[64:67]
    v_mfma_f32_16x16x32_bf16 v[68:71], v[100:103], v[156:159], v[68:71]
    ds_read_b64_tr_b16 v[116:117], v8 offset:8192
    ds_read_b64_tr_b16 v[118:119], v8 offset:9216
    v_mfma_f32_16x16x32_bf16 v[72:75], v[24:27], v[152:155], v[72:75]
    v_mfma_f32_16x16x32_bf16 v[76:79], v[24:27], v[156:159], v[76:79]
    ds_read_b64_tr_b16 v[100:101], v9 offset:8192
    ds_read_b64_tr_b16 v[102:103], v9 offset:9216
    v_mfma_f32_16x16x32_bf16 v[80:83], v[16:19], v[152:155], v[80:83]
    v_mfma_f32_16x16x32_bf16 v[84:87], v[16:19], v[156:159], v[84:87]
    ds_read_b64_tr_b16 v[24:25], v10 offset:8192
    ds_read_b64_tr_b16 v[26:27], v10 offset:9216
    v_mfma_f32_16x16x32_bf16 v[88:91], v[20:23], v[152:155], v[88:91]
    v_mfma_f32_16x16x32_bf16 v[92:95], v[20:23], v[156:159], v[92:95]
    ds_read_b64_tr_b16 v[16:17], v11 offset:8192
    ds_read_b64_tr_b16 v[18:19], v11 offset:9216
    s_waitcnt lgkmcnt(12)
    v_mfma_f32_16x16x32_bf16 v[32:35], v[104:107], v[160:163], v[32:35]
    v_mfma_f32_16x16x32_bf16 v[36:39], v[104:107], v[164:167], v[36:39]
    ds_read_b64_tr_b16 v[20:21], v8 offset:4096
    ds_read_b64_tr_b16 v[22:23], v8 offset:5120
    v_mfma_f32_16x16x32_bf16 v[40:43], v[108:111], v[160:163], v[40:43]
    v_mfma_f32_16x16x32_bf16 v[44:47], v[108:111], v[164:167], v[44:47]
    ds_read_b64_tr_b16 v[104:105], v9 offset:4096
    ds_read_b64_tr_b16 v[106:107], v9 offset:5120
    s_waitcnt lgkmcnt(12)
    v_mfma_f32_16x16x32_bf16 v[48:51], v[96:99], v[160:163], v[48:51]
    v_mfma_f32_16x16x32_bf16 v[52:55], v[96:99], v[164:167], v[52:55]
    ds_read_b64_tr_b16 v[108:109], v10 offset:4096
    ds_read_b64_tr_b16 v[110:111], v10 offset:5120
    v_mfma_f32_16x16x32_bf16 v[56:59], v[112:115], v[160:163], v[56:59]
    v_mfma_f32_16x16x32_bf16 v[60:63], v[112:115], v[164:167], v[60:63]
    s_add_u32 s27, s67, 3072
    buffer_load_dwordx4 v[128:131], v2, s[40:43], s27 offen sc1
    ds_read_b64_tr_b16 v[96:97], v11 offset:4096
    ds_read_b64_tr_b16 v[98:99], v11 offset:5120
    s_waitcnt lgkmcnt(12)
    v_mfma_f32_16x16x32_bf16 v[64:67], v[116:119], v[160:163], v[64:67]
    v_mfma_f32_16x16x32_bf16 v[68:71], v[116:119], v[164:167], v[68:71]
    ds_read_b64_tr_b16 v[112:113], v8 offset:12288
    ds_read_b64_tr_b16 v[114:115], v8 offset:13312
    v_mfma_f32_16x16x32_bf16 v[72:75], v[100:103], v[160:163], v[72:75]
    v_mfma_f32_16x16x32_bf16 v[76:79], v[100:103], v[164:167], v[76:79]
    ds_read_b64_tr_b16 v[116:117], v9 offset:12288
    ds_read_b64_tr_b16 v[118:119], v9 offset:13312
    s_waitcnt lgkmcnt(12)
    v_mfma_f32_16x16x32_bf16 v[80:83], v[24:27], v[160:163], v[80:83]
    v_mfma_f32_16x16x32_bf16 v[84:87], v[24:27], v[164:167], v[84:87]
    ds_read_b64_tr_b16 v[100:101], v10 offset:12288
    ds_read_b64_tr_b16 v[102:103], v10 offset:13312
    v_mfma_f32_16x16x32_bf16 v[88:91], v[16:19], v[160:163], v[88:91]
    v_mfma_f32_16x16x32_bf16 v[92:95], v[16:19], v[164:167], v[92:95]
    ds_read_b64_tr_b16 v[24:25], v11 offset:12288
    ds_read_b64_tr_b16 v[26:27], v11 offset:13312
    s_waitcnt lgkmcnt(12)
    v_mfma_f32_16x16x32_bf16 v[32:35], v[20:23], v[168:171], v[32:35]
    v_mfma_f32_16x16x32_bf16 v[36:39], v[20:23], v[172:175], v[36:39]
    ds_read_b64_tr_b16 v[16:17], v8 offset:16384
    ds_read_b64_tr_b16 v[18:19], v8 offset:17408
    v_mfma_f32_16x16x32_bf16 v[40:43], v[104:107], v[168:171], v[40:43]
    v_mfma_f32_16x16x32_bf16 v[44:47], v[104:107], v[172:175], v[44:47]
    ds_read_b64_tr_b16 v[20:21], v9 offset:16384
    ds_read_b64_tr_b16 v[22:23], v9 offset:17408
    s_waitcnt lgkmcnt(12)
    v_mfma_f32_16x16x32_bf16 v[48:51], v[108:111], v[168:171], v[48:51]
    v_mfma_f32_16x16x32_bf16 v[52:55], v[108:111], v[172:175], v[52:55]
    ds_read_b64_tr_b16 v[104:105], v10 offset:16384
    ds_read_b64_tr_b16 v[106:107], v10 offset:17408
    v_mfma_f32_16x16x32_bf16 v[56:59], v[96:99], v[168:171], v[56:59]
    v_mfma_f32_16x16x32_bf16 v[60:63], v[96:99], v[172:175], v[60:63]
    s_add_u32 s27, s67, 4096
    buffer_load_dwordx4 v[132:135], v2, s[40:43], s27 offen sc1
    ds_read_b64_tr_b16 v[108:109], v11 offset:16384
    ds_read_b64_tr_b16 v[110:111], v11 offset:17408
    s_waitcnt lgkmcnt(12)
    v_mfma_f32_16x16x32_bf16 v[64:67], v[112:115], v[168:171], v[64:67]
    v_mfma_f32_16x16x32_bf16 v[68:71], v[112:115], v[172:175], v[68:71]
    ds_read_b64_tr_b16 v[96:97], v8 offset:24576
    ds_read_b64_tr_b16 v[98:99], v8 offset:25600
    v_mfma_f32_16x16x32_bf16 v[72:75], v[116:119], v[168:171], v[72:75]
    v_mfma_f32_16x16x32_bf16 v[76:79], v[116:119], v[172:175], v[76:79]
    ds_read_b64_tr_b16 v[112:113], v9 offset:24576
    ds_read_b64_tr_b16 v[114:115], v9 offset:25600
    s_waitcnt lgkmcnt(12)
    v_mfma_f32_16x16x32_bf16 v[80:83], v[100:103], v[168:171], v[80:83]
    v_mfma_f32_16x16x32_bf16 v[84:87], v[100:103], v[172:175], v[84:87]
    ds_read_b64_tr_b16 v[116:117], v10 offset:24576
    ds_read_b64_tr_b16 v[118:119], v10 offset:25600
    v_mfma_f32_16x16x32_bf16 v[88:91], v[24:27], v[168:171], v[88:91]
    v_mfma_f32_16x16x32_bf16 v[92:95], v[24:27], v[172:175], v[92:95]
    ds_read_b64_tr_b16 v[100:101], v11 offset:24576
    ds_read_b64_tr_b16 v[102:103], v11 offset:25600
    s_waitcnt lgkmcnt(12)
    v_mfma_f32_16x16x32_bf16 v[32:35], v[16:19], v[176:179], v[32:35]
    v_mfma_f32_16x16x32_bf16 v[36:39], v[16:19], v[180:183], v[36:39]
    ds_read_b64_tr_b16 v[24:25], v8 offset:20480
    ds_read_b64_tr_b16 v[26:27], v8 offset:21504
    v_mfma_f32_16x16x32_bf16 v[40:43], v[20:23], v[176:179], v[40:43]
    v_mfma_f32_16x16x32_bf16 v[44:47], v[20:23], v[180:183], v[44:47]
    ds_read_b64_tr_b16 v[16:17], v9 offset:20480
    ds_read_b64_tr_b16 v[18:19], v9 offset:21504
    s_waitcnt lgkmcnt(12)
    v_mfma_f32_16x16x32_bf16 v[48:51], v[104:107], v[176:179], v[48:51]
    v_mfma_f32_16x16x32_bf16 v[52:55], v[104:107], v[180:183], v[52:55]
    ds_read_b64_tr_b16 v[20:21], v10 offset:20480
    ds_read_b64_tr_b16 v[22:23], v10 offset:21504
    v_mfma_f32_16x16x32_bf16 v[56:59], v[108:111], v[176:179], v[56:59]
    v_mfma_f32_16x16x32_bf16 v[60:63], v[108:111], v[180:183], v[60:63]
    s_add_u32 s27, s67, 40960
    buffer_load_dwordx4 v[136:139], v2, s[40:43], s27 offen sc1
    ds_read_b64_tr_b16 v[104:105], v11 offset:20480
    ds_read_b64_tr_b16 v[106:107], v11 offset:21504
    s_waitcnt lgkmcnt(12)
    v_mfma_f32_16x16x32_bf16 v[64:67], v[96:99], v[176:179], v[64:67]
    v_mfma_f32_16x16x32_bf16 v[68:71], v[96:99], v[180:183], v[68:71]
    ds_read_b64_tr_b16 v[108:109], v8 offset:28672
    ds_read_b64_tr_b16 v[110:111], v8 offset:29696
    v_mfma_f32_16x16x32_bf16 v[72:75], v[112:115], v[176:179], v[72:75]
    v_mfma_f32_16x16x32_bf16 v[76:79], v[112:115], v[180:183], v[76:79]
    ds_read_b64_tr_b16 v[96:97], v9 offset:28672
    ds_read_b64_tr_b16 v[98:99], v9 offset:29696
    s_waitcnt lgkmcnt(12)
    v_mfma_f32_16x16x32_bf16 v[80:83], v[116:119], v[176:179], v[80:83]
    v_mfma_f32_16x16x32_bf16 v[84:87], v[116:119], v[180:183], v[84:87]
    ds_read_b64_tr_b16 v[112:113], v10 offset:28672
    ds_read_b64_tr_b16 v[114:115], v10 offset:29696
    v_mfma_f32_16x16x32_bf16 v[88:91], v[100:103], v[176:179], v[88:91]
    v_mfma_f32_16x16x32_bf16 v[92:95], v[100:103], v[180:183], v[92:95]
    ds_read_b64_tr_b16 v[116:117], v11 offset:28672
    ds_read_b64_tr_b16 v[118:119], v11 offset:29696
    s_waitcnt lgkmcnt(12)
    v_mfma_f32_16x16x32_bf16 v[32:35], v[24:27], v[184:187], v[32:35]
    v_mfma_f32_16x16x32_bf16 v[36:39], v[24:27], v[188:191], v[36:39]
    v_add_u32 v8, 4294901760, v8
    v_add_u32 v9, 4294901760, v9
    v_add_u32 v10, 4294901760, v10
    v_add_u32 v11, 4294901760, v11
    ds_read_b64_tr_b16 v[100:101], v8 offset:0
    ds_read_b64_tr_b16 v[102:103], v8 offset:1024
    v_mfma_f32_16x16x32_bf16 v[40:43], v[16:19], v[184:187], v[40:43]
    v_mfma_f32_16x16x32_bf16 v[44:47], v[16:19], v[188:191], v[44:47]
    ds_read_b64_tr_b16 v[24:25], v9 offset:0
    ds_read_b64_tr_b16 v[26:27], v9 offset:1024
    s_waitcnt lgkmcnt(12)
    v_mfma_f32_16x16x32_bf16 v[48:51], v[20:23], v[184:187], v[48:51]
    v_mfma_f32_16x16x32_bf16 v[52:55], v[20:23], v[188:191], v[52:55]
    ds_read_b64_tr_b16 v[16:17], v10 offset:0
    ds_read_b64_tr_b16 v[18:19], v10 offset:1024
    v_mfma_f32_16x16x32_bf16 v[56:59], v[104:107], v[184:187], v[56:59]
    v_mfma_f32_16x16x32_bf16 v[60:63], v[104:107], v[188:191], v[60:63]
    s_add_u32 s27, s67, 41984
    buffer_load_dwordx4 v[140:143], v2, s[40:43], s27 offen sc1
    ds_read_b64_tr_b16 v[20:21], v11 offset:0
    ds_read_b64_tr_b16 v[22:23], v11 offset:1024
    s_waitcnt lgkmcnt(12)
    v_mfma_f32_16x16x32_bf16 v[64:67], v[108:111], v[184:187], v[64:67]
    v_mfma_f32_16x16x32_bf16 v[68:71], v[108:111], v[188:191], v[68:71]
    ds_read_b64_tr_b16 v[104:105], v8 offset:8192
    ds_read_b64_tr_b16 v[106:107], v8 offset:9216
    v_mfma_f32_16x16x32_bf16 v[72:75], v[96:99], v[184:187], v[72:75]
    v_mfma_f32_16x16x32_bf16 v[76:79], v[96:99], v[188:191], v[76:79]
    ds_read_b64_tr_b16 v[108:109], v9 offset:8192
    ds_read_b64_tr_b16 v[110:111], v9 offset:9216
    s_waitcnt lgkmcnt(12)
    v_mfma_f32_16x16x32_bf16 v[80:83], v[112:115], v[184:187], v[80:83]
    v_mfma_f32_16x16x32_bf16 v[84:87], v[112:115], v[188:191], v[84:87]
    ds_read_b64_tr_b16 v[96:97], v10 offset:8192
    ds_read_b64_tr_b16 v[98:99], v10 offset:9216
    v_mfma_f32_16x16x32_bf16 v[88:91], v[116:119], v[184:187], v[88:91]
    v_mfma_f32_16x16x32_bf16 v[92:95], v[116:119], v[188:191], v[92:95]
    ds_read_b64_tr_b16 v[112:113], v11 offset:8192
    ds_read_b64_tr_b16 v[114:115], v11 offset:9216
    s_waitcnt lgkmcnt(12)
    v_mfma_f32_16x16x32_bf16 v[32:35], v[100:103], v[192:195], v[32:35]
    v_mfma_f32_16x16x32_bf16 v[36:39], v[100:103], v[196:199], v[36:39]
    s_waitcnt vmcnt(10)
    s_mov_b64 exec, 1
    ds_add_u32 v30, v31 offset:8208
    s_mov_b64 exec, -1
    ds_read_b64_tr_b16 v[116:117], v8 offset:4096
    ds_read_b64_tr_b16 v[118:119], v8 offset:5120
    v_mfma_f32_16x16x32_bf16 v[40:43], v[24:27], v[192:195], v[40:43]
    v_mfma_f32_16x16x32_bf16 v[44:47], v[24:27], v[196:199], v[44:47]
    ds_read_b64_tr_b16 v[100:101], v9 offset:4096
    ds_read_b64_tr_b16 v[102:103], v9 offset:5120
    s_waitcnt lgkmcnt(13)
    v_mfma_f32_16x16x32_bf16 v[48:51], v[16:19], v[192:195], v[48:51]
    v_mfma_f32_16x16x32_bf16 v[52:55], v[16:19], v[196:199], v[52:55]
    ds_read_b64_tr_b16 v[24:25], v10 offset:4096
    ds_read_b64_tr_b16 v[26:27], v10 offset:5120
    v_mfma_f32_16x16x32_bf16 v[56:59], v[20:23], v[192:195], v[56:59]
    v_mfma_f32_16x16x32_bf16 v[60:63], v[20:23], v[196:199], v[60:63]
    s_add_u32 s27, s67, 43008
    buffer_load_dwordx4 v[144:147], v2, s[40:43], s27 offen sc1
    ds_read_b64_tr_b16 v[16:17], v11 offset:4096
    ds_read_b64_tr_b16 v[18:19], v11 offset:5120
    s_waitcnt lgkmcnt(13)
    v_mfma_f32_16x16x32_bf16 v[64:67], v[104:107], v[192:195], v[64:67]
    v_mfma_f32_16x16x32_bf16 v[68:71], v[104:107], v[196:199], v[68:71]
    ds_read_b64_tr_b16 v[20:21], v8 offset:12288
    ds_read_b64_tr_b16 v[22:23], v8 offset:13312
    v_mfma_f32_16x16x32_bf16 v[72:75], v[108:111], v[192:195], v[72:75]
    v_mfma_f32_16x16x32_bf16 v[76:79], v[108:111], v[196:199], v[76:79]
    ds_read_b64_tr_b16 v[104:105], v9 offset:12288
    ds_read_b64_tr_b16 v[106:107], v9 offset:13312
    s_waitcnt lgkmcnt(13)
    v_mfma_f32_16x16x32_bf16 v[80:83], v[96:99], v[192:195], v[80:83]
    v_mfma_f32_16x16x32_bf16 v[84:87], v[96:99], v[196:199], v[84:87]
    ds_read_b64_tr_b16 v[108:109], v10 offset:12288
    ds_read_b64_tr_b16 v[110:111], v10 offset:13312
    v_mfma_f32_16x16x32_bf16 v[88:91], v[112:115], v[192:195], v[88:91]
    v_mfma_f32_16x16x32_bf16 v[92:95], v[112:115], v[196:199], v[92:95]
    ds_read_b64_tr_b16 v[96:97], v11 offset:12288
    ds_read_b64_tr_b16 v[98:99], v11 offset:13312
    s_waitcnt lgkmcnt(12)
    v_mfma_f32_16x16x32_bf16 v[32:35], v[116:119], v[200:203], v[32:35]
    v_mfma_f32_16x16x32_bf16 v[36:39], v[116:119], v[204:207], v[36:39]
LS_17:
    ds_read_b32 v6, v30 offset:8208
    s_waitcnt lgkmcnt(0)
    v_readfirstlane_b32 s27, v6
    s_nop 1
    s_cmp_ge_u32 s27, 8
    s_cbranch_scc1 LS_17_D
    s_sleep 2
    s_branch LS_17

LS_17_D:
    ds_read_b64_tr_b16 v[112:113], v8 offset:16384
    ds_read_b64_tr_b16 v[114:115], v8 offset:17408
    v_mfma_f32_16x16x32_bf16 v[40:43], v[100:103], v[200:203], v[40:43]
    v_mfma_f32_16x16x32_bf16 v[44:47], v[100:103], v[204:207], v[44:47]
    ds_read_b64_tr_b16 v[116:117], v9 offset:16384
    ds_read_b64_tr_b16 v[118:119], v9 offset:17408
    v_mfma_f32_16x16x32_bf16 v[48:51], v[24:27], v[200:203], v[48:51]
    v_mfma_f32_16x16x32_bf16 v[52:55], v[24:27], v[204:207], v[52:55]
    ds_read_b64_tr_b16 v[100:101], v10 offset:16384
    ds_read_b64_tr_b16 v[102:103], v10 offset:17408
    v_mfma_f32_16x16x32_bf16 v[56:59], v[16:19], v[200:203], v[56:59]
    v_mfma_f32_16x16x32_bf16 v[60:63], v[16:19], v[204:207], v[60:63]
    s_add_u32 s27, s67, 44032
    buffer_load_dwordx4 v[148:151], v2, s[40:43], s27 offen sc1
    ds_read_b64_tr_b16 v[24:25], v11 offset:16384
    ds_read_b64_tr_b16 v[26:27], v11 offset:17408
    v_mfma_f32_16x16x32_bf16 v[64:67], v[20:23], v[200:203], v[64:67]
    v_mfma_f32_16x16x32_bf16 v[68:71], v[20:23], v[204:207], v[68:71]
    ds_read_b64_tr_b16 v[16:17], v8 offset:24576
    ds_read_b64_tr_b16 v[18:19], v8 offset:25600
    v_mfma_f32_16x16x32_bf16 v[72:75], v[104:107], v[200:203], v[72:75]
    v_mfma_f32_16x16x32_bf16 v[76:79], v[104:107], v[204:207], v[76:79]
    ds_read_b64_tr_b16 v[20:21], v9 offset:24576
    ds_read_b64_tr_b16 v[22:23], v9 offset:25600
    v_mfma_f32_16x16x32_bf16 v[80:83], v[108:111], v[200:203], v[80:83]
    v_mfma_f32_16x16x32_bf16 v[84:87], v[108:111], v[204:207], v[84:87]
    ds_read_b64_tr_b16 v[104:105], v10 offset:24576
    ds_read_b64_tr_b16 v[106:107], v10 offset:25600
    v_mfma_f32_16x16x32_bf16 v[88:91], v[96:99], v[200:203], v[88:91]
    v_mfma_f32_16x16x32_bf16 v[92:95], v[96:99], v[204:207], v[92:95]
    ds_read_b64_tr_b16 v[108:109], v11 offset:24576
    ds_read_b64_tr_b16 v[110:111], v11 offset:25600
    s_waitcnt lgkmcnt(12)
    v_mfma_f32_16x16x32_bf16 v[32:35], v[112:115], v[208:211], v[32:35]
    v_mfma_f32_16x16x32_bf16 v[36:39], v[112:115], v[212:215], v[36:39]
    ds_read_b64_tr_b16 v[96:97], v8 offset:20480
    ds_read_b64_tr_b16 v[98:99], v8 offset:21504
    v_mfma_f32_16x16x32_bf16 v[40:43], v[116:119], v[208:211], v[40:43]
    v_mfma_f32_16x16x32_bf16 v[44:47], v[116:119], v[212:215], v[44:47]
    ds_read_b64_tr_b16 v[112:113], v9 offset:20480
    ds_read_b64_tr_b16 v[114:115], v9 offset:21504
    s_waitcnt lgkmcnt(12)
    v_mfma_f32_16x16x32_bf16 v[48:51], v[100:103], v[208:211], v[48:51]
    v_mfma_f32_16x16x32_bf16 v[52:55], v[100:103], v[212:215], v[52:55]
    ds_read_b64_tr_b16 v[116:117], v10 offset:20480
    ds_read_b64_tr_b16 v[118:119], v10 offset:21504
    v_mfma_f32_16x16x32_bf16 v[56:59], v[24:27], v[208:211], v[56:59]
    v_mfma_f32_16x16x32_bf16 v[60:63], v[24:27], v[212:215], v[60:63]
    s_add_u32 s27, s67, 45056
    buffer_load_dwordx4 v[152:155], v2, s[40:43], s27 offen sc1
    ds_read_b64_tr_b16 v[100:101], v11 offset:20480
    ds_read_b64_tr_b16 v[102:103], v11 offset:21504
    s_waitcnt lgkmcnt(12)
    v_mfma_f32_16x16x32_bf16 v[64:67], v[16:19], v[208:211], v[64:67]
    v_mfma_f32_16x16x32_bf16 v[68:71], v[16:19], v[212:215], v[68:71]
    ds_read_b64_tr_b16 v[24:25], v8 offset:28672
    ds_read_b64_tr_b16 v[26:27], v8 offset:29696
    v_mfma_f32_16x16x32_bf16 v[72:75], v[20:23], v[208:211], v[72:75]
    v_mfma_f32_16x16x32_bf16 v[76:79], v[20:23], v[212:215], v[76:79]
    ds_read_b64_tr_b16 v[16:17], v9 offset:28672
    ds_read_b64_tr_b16 v[18:19], v9 offset:29696
    s_waitcnt lgkmcnt(12)
    v_mfma_f32_16x16x32_bf16 v[80:83], v[104:107], v[208:211], v[80:83]
    v_mfma_f32_16x16x32_bf16 v[84:87], v[104:107], v[212:215], v[84:87]
    ds_read_b64_tr_b16 v[20:21], v10 offset:28672
    ds_read_b64_tr_b16 v[22:23], v10 offset:29696
    v_mfma_f32_16x16x32_bf16 v[88:91], v[108:111], v[208:211], v[88:91]
    v_mfma_f32_16x16x32_bf16 v[92:95], v[108:111], v[212:215], v[92:95]
    ds_read_b64_tr_b16 v[104:105], v11 offset:28672
    ds_read_b64_tr_b16 v[106:107], v11 offset:29696
    s_waitcnt lgkmcnt(12)
    v_mfma_f32_16x16x32_bf16 v[32:35], v[96:99], v[216:219], v[32:35]
    v_mfma_f32_16x16x32_bf16 v[36:39], v[96:99], v[220:223], v[36:39]
    v_add_u32 v8, 65536, v8
    v_add_u32 v9, 65536, v9
    v_add_u32 v10, 65536, v10
    v_add_u32 v11, 65536, v11
    ds_read_b64_tr_b16 v[108:109], v8 offset:32768
    ds_read_b64_tr_b16 v[110:111], v8 offset:33792
    v_mfma_f32_16x16x32_bf16 v[40:43], v[112:115], v[216:219], v[40:43]
    v_mfma_f32_16x16x32_bf16 v[44:47], v[112:115], v[220:223], v[44:47]
    ds_read_b64_tr_b16 v[96:97], v9 offset:32768
    ds_read_b64_tr_b16 v[98:99], v9 offset:33792
    s_waitcnt lgkmcnt(12)
    v_mfma_f32_16x16x32_bf16 v[48:51], v[116:119], v[216:219], v[48:51]
    v_mfma_f32_16x16x32_bf16 v[52:55], v[116:119], v[220:223], v[52:55]
    ds_read_b64_tr_b16 v[112:113], v10 offset:32768
    ds_read_b64_tr_b16 v[114:115], v10 offset:33792
    v_mfma_f32_16x16x32_bf16 v[56:59], v[100:103], v[216:219], v[56:59]
    v_mfma_f32_16x16x32_bf16 v[60:63], v[100:103], v[220:223], v[60:63]
    ds_read_b64_tr_b16 v[116:117], v11 offset:32768
    ds_read_b64_tr_b16 v[118:119], v11 offset:33792
    s_waitcnt lgkmcnt(12)
    v_mfma_f32_16x16x32_bf16 v[64:67], v[24:27], v[216:219], v[64:67]
    v_mfma_f32_16x16x32_bf16 v[68:71], v[24:27], v[220:223], v[68:71]
    ds_read_b64_tr_b16 v[100:101], v8 offset:40960
    ds_read_b64_tr_b16 v[102:103], v8 offset:41984
    v_mfma_f32_16x16x32_bf16 v[72:75], v[16:19], v[216:219], v[72:75]
    v_mfma_f32_16x16x32_bf16 v[76:79], v[16:19], v[220:223], v[76:79]
    ds_read_b64_tr_b16 v[24:25], v9 offset:40960
    ds_read_b64_tr_b16 v[26:27], v9 offset:41984
    s_waitcnt lgkmcnt(12)
    v_mfma_f32_16x16x32_bf16 v[80:83], v[20:23], v[216:219], v[80:83]
    v_mfma_f32_16x16x32_bf16 v[84:87], v[20:23], v[220:223], v[84:87]
    ds_read_b64_tr_b16 v[16:17], v10 offset:40960
    ds_read_b64_tr_b16 v[18:19], v10 offset:41984
    v_mfma_f32_16x16x32_bf16 v[88:91], v[104:107], v[216:219], v[88:91]
    v_mfma_f32_16x16x32_bf16 v[92:95], v[104:107], v[220:223], v[92:95]
    ds_read_b64_tr_b16 v[20:21], v11 offset:40960
    ds_read_b64_tr_b16 v[22:23], v11 offset:41984
    s_waitcnt lgkmcnt(12)
    v_mfma_f32_16x16x32_bf16 v[32:35], v[108:111], v[224:227], v[32:35]
    v_mfma_f32_16x16x32_bf16 v[36:39], v[108:111], v[228:231], v[36:39]
    s_waitcnt vmcnt(9)
    s_mov_b64 exec, 1
    ds_add_u32 v30, v31 offset:8208
    s_mov_b64 exec, -1
    ds_read_b64_tr_b16 v[104:105], v8 offset:36864
    ds_read_b64_tr_b16 v[106:107], v8 offset:37888
    v_mfma_f32_16x16x32_bf16 v[40:43], v[96:99], v[224:227], v[40:43]
    v_mfma_f32_16x16x32_bf16 v[44:47], v[96:99], v[228:231], v[44:47]
    ds_read_b64_tr_b16 v[108:109], v9 offset:36864
    ds_read_b64_tr_b16 v[110:111], v9 offset:37888
    s_waitcnt lgkmcnt(13)
    v_mfma_f32_16x16x32_bf16 v[48:51], v[112:115], v[224:227], v[48:51]
    v_mfma_f32_16x16x32_bf16 v[52:55], v[112:115], v[228:231], v[52:55]
    ds_read_b64_tr_b16 v[96:97], v10 offset:36864
    ds_read_b64_tr_b16 v[98:99], v10 offset:37888
    v_mfma_f32_16x16x32_bf16 v[56:59], v[116:119], v[224:227], v[56:59]
    v_mfma_f32_16x16x32_bf16 v[60:63], v[116:119], v[228:231], v[60:63]
    ds_read_b64_tr_b16 v[112:113], v11 offset:36864
    ds_read_b64_tr_b16 v[114:115], v11 offset:37888
    s_waitcnt lgkmcnt(13)
    v_mfma_f32_16x16x32_bf16 v[64:67], v[100:103], v[224:227], v[64:67]
    v_mfma_f32_16x16x32_bf16 v[68:71], v[100:103], v[228:231], v[68:71]
    ds_read_b64_tr_b16 v[116:117], v8 offset:45056
    ds_read_b64_tr_b16 v[118:119], v8 offset:46080
    v_mfma_f32_16x16x32_bf16 v[72:75], v[24:27], v[224:227], v[72:75]
    v_mfma_f32_16x16x32_bf16 v[76:79], v[24:27], v[228:231], v[76:79]
    ds_read_b64_tr_b16 v[100:101], v9 offset:45056
    ds_read_b64_tr_b16 v[102:103], v9 offset:46080
    s_waitcnt lgkmcnt(13)
    v_mfma_f32_16x16x32_bf16 v[80:83], v[16:19], v[224:227], v[80:83]
    v_mfma_f32_16x16x32_bf16 v[84:87], v[16:19], v[228:231], v[84:87]
    ds_read_b64_tr_b16 v[24:25], v10 offset:45056
    ds_read_b64_tr_b16 v[26:27], v10 offset:46080
    v_mfma_f32_16x16x32_bf16 v[88:91], v[20:23], v[224:227], v[88:91]
    v_mfma_f32_16x16x32_bf16 v[92:95], v[20:23], v[228:231], v[92:95]
    ds_read_b64_tr_b16 v[16:17], v11 offset:45056
    ds_read_b64_tr_b16 v[18:19], v11 offset:46080
    s_waitcnt lgkmcnt(12)
    v_mfma_f32_16x16x32_bf16 v[32:35], v[104:107], v[232:235], v[32:35]
    v_mfma_f32_16x16x32_bf16 v[36:39], v[104:107], v[236:239], v[36:39]
LS_18:
    ds_read_b32 v6, v30 offset:8208
    s_waitcnt lgkmcnt(0)
    v_readfirstlane_b32 s27, v6
    s_nop 1
    s_cmp_ge_u32 s27, 12
    s_cbranch_scc1 LS_18_D
    s_sleep 2
    s_branch LS_18

LS_18_D:
    ds_read_b64_tr_b16 v[20:21], v8 offset:49152
    ds_read_b64_tr_b16 v[22:23], v8 offset:50176
    v_mfma_f32_16x16x32_bf16 v[40:43], v[108:111], v[232:235], v[40:43]
    v_mfma_f32_16x16x32_bf16 v[44:47], v[108:111], v[236:239], v[44:47]
    ds_read_b64_tr_b16 v[104:105], v9 offset:49152
    ds_read_b64_tr_b16 v[106:107], v9 offset:50176
    v_mfma_f32_16x16x32_bf16 v[48:51], v[96:99], v[232:235], v[48:51]
    v_mfma_f32_16x16x32_bf16 v[52:55], v[96:99], v[236:239], v[52:55]
    ds_read_b64_tr_b16 v[108:109], v10 offset:49152
    ds_read_b64_tr_b16 v[110:111], v10 offset:50176
    v_mfma_f32_16x16x32_bf16 v[56:59], v[112:115], v[232:235], v[56:59]
    v_mfma_f32_16x16x32_bf16 v[60:63], v[112:115], v[236:239], v[60:63]
    ds_read_b64_tr_b16 v[96:97], v11 offset:49152
    ds_read_b64_tr_b16 v[98:99], v11 offset:50176
    v_mfma_f32_16x16x32_bf16 v[64:67], v[116:119], v[232:235], v[64:67]
    v_mfma_f32_16x16x32_bf16 v[68:71], v[116:119], v[236:239], v[68:71]
    ds_read_b64_tr_b16 v[112:113], v8 offset:57344
    ds_read_b64_tr_b16 v[114:115], v8 offset:58368
    v_mfma_f32_16x16x32_bf16 v[72:75], v[100:103], v[232:235], v[72:75]
    v_mfma_f32_16x16x32_bf16 v[76:79], v[100:103], v[236:239], v[76:79]
    ds_read_b64_tr_b16 v[116:117], v9 offset:57344
    ds_read_b64_tr_b16 v[118:119], v9 offset:58368
    v_mfma_f32_16x16x32_bf16 v[80:83], v[24:27], v[232:235], v[80:83]
    v_mfma_f32_16x16x32_bf16 v[84:87], v[24:27], v[236:239], v[84:87]
    ds_read_b64_tr_b16 v[100:101], v10 offset:57344
    ds_read_b64_tr_b16 v[102:103], v10 offset:58368
    v_mfma_f32_16x16x32_bf16 v[88:91], v[16:19], v[232:235], v[88:91]
    v_mfma_f32_16x16x32_bf16 v[92:95], v[16:19], v[236:239], v[92:95]
    ds_read_b64_tr_b16 v[24:25], v11 offset:57344
    ds_read_b64_tr_b16 v[26:27], v11 offset:58368
    s_waitcnt lgkmcnt(12)
    v_mfma_f32_16x16x32_bf16 v[32:35], v[20:23], v[240:243], v[32:35]
    v_mfma_f32_16x16x32_bf16 v[36:39], v[20:23], v[244:247], v[36:39]
    ds_read_b64_tr_b16 v[16:17], v8 offset:53248
    ds_read_b64_tr_b16 v[18:19], v8 offset:54272
    v_mfma_f32_16x16x32_bf16 v[40:43], v[104:107], v[240:243], v[40:43]
    v_mfma_f32_16x16x32_bf16 v[44:47], v[104:107], v[244:247], v[44:47]
    ds_read_b64_tr_b16 v[20:21], v9 offset:53248
    ds_read_b64_tr_b16 v[22:23], v9 offset:54272
    s_waitcnt lgkmcnt(12)
    v_mfma_f32_16x16x32_bf16 v[48:51], v[108:111], v[240:243], v[48:51]
    v_mfma_f32_16x16x32_bf16 v[52:55], v[108:111], v[244:247], v[52:55]
    ds_read_b64_tr_b16 v[104:105], v10 offset:53248
    ds_read_b64_tr_b16 v[106:107], v10 offset:54272
    v_mfma_f32_16x16x32_bf16 v[56:59], v[96:99], v[240:243], v[56:59]
    v_mfma_f32_16x16x32_bf16 v[60:63], v[96:99], v[244:247], v[60:63]
    ds_read_b64_tr_b16 v[108:109], v11 offset:53248
    ds_read_b64_tr_b16 v[110:111], v11 offset:54272
    s_waitcnt lgkmcnt(12)
    v_mfma_f32_16x16x32_bf16 v[64:67], v[112:115], v[240:243], v[64:67]
    v_mfma_f32_16x16x32_bf16 v[68:71], v[112:115], v[244:247], v[68:71]
    ds_read_b64_tr_b16 v[96:97], v8 offset:61440
    ds_read_b64_tr_b16 v[98:99], v8 offset:62464
    v_mfma_f32_16x16x32_bf16 v[72:75], v[116:119], v[240:243], v[72:75]
    v_mfma_f32_16x16x32_bf16 v[76:79], v[116:119], v[244:247], v[76:79]
    ds_read_b64_tr_b16 v[112:113], v9 offset:61440
    ds_read_b64_tr_b16 v[114:115], v9 offset:62464
    s_waitcnt lgkmcnt(12)
    v_mfma_f32_16x16x32_bf16 v[80:83], v[100:103], v[240:243], v[80:83]
    v_mfma_f32_16x16x32_bf16 v[84:87], v[100:103], v[244:247], v[84:87]
    ds_read_b64_tr_b16 v[116:117], v10 offset:61440
    ds_read_b64_tr_b16 v[118:119], v10 offset:62464
    v_mfma_f32_16x16x32_bf16 v[88:91], v[24:27], v[240:243], v[88:91]
    v_mfma_f32_16x16x32_bf16 v[92:95], v[24:27], v[244:247], v[92:95]
    ds_read_b64_tr_b16 v[100:101], v11 offset:61440
    ds_read_b64_tr_b16 v[102:103], v11 offset:62464
    s_waitcnt lgkmcnt(12)
    v_mfma_f32_16x16x32_bf16 v[32:35], v[16:19], v[248:251], v[32:35]
    v_mfma_f32_16x16x32_bf16 v[36:39], v[16:19], v[252:255], v[36:39]
    v_mfma_f32_16x16x32_bf16 v[40:43], v[20:23], v[248:251], v[40:43]
    v_mfma_f32_16x16x32_bf16 v[44:47], v[20:23], v[252:255], v[44:47]
    s_waitcnt lgkmcnt(8)
    v_mfma_f32_16x16x32_bf16 v[48:51], v[104:107], v[248:251], v[48:51]
    v_mfma_f32_16x16x32_bf16 v[52:55], v[104:107], v[252:255], v[52:55]
    v_mfma_f32_16x16x32_bf16 v[56:59], v[108:111], v[248:251], v[56:59]
    v_mfma_f32_16x16x32_bf16 v[60:63], v[108:111], v[252:255], v[60:63]
    s_waitcnt lgkmcnt(4)
    v_mfma_f32_16x16x32_bf16 v[64:67], v[96:99], v[248:251], v[64:67]
    v_mfma_f32_16x16x32_bf16 v[68:71], v[96:99], v[252:255], v[68:71]
    v_mfma_f32_16x16x32_bf16 v[72:75], v[112:115], v[248:251], v[72:75]
    v_mfma_f32_16x16x32_bf16 v[76:79], v[112:115], v[252:255], v[76:79]
    s_waitcnt lgkmcnt(0)
    v_mfma_f32_16x16x32_bf16 v[80:83], v[116:119], v[248:251], v[80:83]
    v_mfma_f32_16x16x32_bf16 v[84:87], v[116:119], v[252:255], v[84:87]
    v_mfma_f32_16x16x32_bf16 v[88:91], v[100:103], v[248:251], v[88:91]
    v_mfma_f32_16x16x32_bf16 v[92:95], v[100:103], v[252:255], v[92:95]
LS_19:
    ds_read_b32 v6, v30 offset:8216
    s_waitcnt lgkmcnt(0)
    v_readfirstlane_b32 s27, v6
    s_nop 1
    s_cmp_ge_u32 s27, 1
    s_cbranch_scc1 LS_19_D
    s_sleep 2
    s_branch LS_19

LS_19_D:
    v_and_b32 v6, 0x30, v1
    v_add_u32 v6, v6, v30
    v_and_b32 v7, 0xf0, v2
    s_lshl_b32 s27, s57, 9
    v_add3_u32 v7, v7, v30, s27

    ds_read_b128 v[224:227], v7 offset:2048
    ds_read_b128 v[228:231], v7 offset:2304
    ds_read_b128 v[192:195], v6 offset:1024
    ds_read_b128 v[196:199], v6 offset:1088
    ds_read_b128 v[200:203], v6 offset:1152
    ds_read_b128 v[204:207], v6 offset:1216
    ds_read_b128 v[208:211], v6 offset:1280
    ds_read_b128 v[212:215], v6 offset:1344
    ds_read_b128 v[216:219], v6 offset:1408
    ds_read_b128 v[220:223], v6 offset:1472
    s_setprio 3
    s_mul_i32 s71, s26, 6
    s_add_u32 s71, s71, 4
    s_lshl_b32 s71, s71, 7
    s_lshl_b32 s29, s25, 3
    s_add_u32 s71, s71, s29
    s_lshl_b32 s29, s57, 1
    s_add_u32 s71, s71, s29
    s_lshl_b32 s71, s71, 10
    s_waitcnt lgkmcnt(0)

    v_fma_f32 v32, -v224, v192, v32
    v_fma_f32 v64, -v224, v208, v64
    v_fma_f32 v33, -v224, v193, v33
    v_fma_f32 v65, -v224, v209, v65
    v_fma_f32 v34, -v224, v194, v34
    v_fma_f32 v66, -v224, v210, v66
    v_fma_f32 v35, -v224, v195, v35
    v_fma_f32 v67, -v224, v211, v67
    v_mul_f32 v32, v32, v226
    v_mul_f32 v33, v33, v226
    v_mul_f32 v34, v34, v226
    v_mul_f32 v35, v35, v226
    v_mul_f32 v32, v32, v64
    v_mul_f32 v33, v33, v65
    v_mul_f32 v34, v34, v66
    v_mul_f32 v35, v35, v67
    v_cvt_pk_bf16_f32 v176, v32, v33
    v_cvt_pk_bf16_f32 v177, v34, v35
    v_fma_f32 v40, -v224, v196, v40
    v_fma_f32 v72, -v224, v212, v72
    v_fma_f32 v41, -v224, v197, v41
    v_fma_f32 v73, -v224, v213, v73
    v_fma_f32 v42, -v224, v198, v42
    v_fma_f32 v74, -v224, v214, v74
    v_fma_f32 v43, -v224, v199, v43
    v_fma_f32 v75, -v224, v215, v75
    v_mul_f32 v40, v40, v226
    v_mul_f32 v41, v41, v226
    v_mul_f32 v42, v42, v226
    v_mul_f32 v43, v43, v226
    v_mul_f32 v40, v40, v72
    v_mul_f32 v41, v41, v73
    v_mul_f32 v42, v42, v74
    v_mul_f32 v43, v43, v75
    v_cvt_pk_bf16_f32 v178, v40, v41
    v_cvt_pk_bf16_f32 v179, v42, v43
    buffer_store_dwordx4 v[176:179], v2, s[40:43], s71 offen offset:0 sc1
    v_fma_f32 v36, -v228, v192, v36
    v_fma_f32 v68, -v228, v208, v68
    v_fma_f32 v37, -v228, v193, v37
    v_fma_f32 v69, -v228, v209, v69
    v_fma_f32 v38, -v228, v194, v38
    v_fma_f32 v70, -v228, v210, v70
    v_fma_f32 v39, -v228, v195, v39
    v_fma_f32 v71, -v228, v211, v71
    v_mul_f32 v36, v36, v230
    v_mul_f32 v37, v37, v230
    v_mul_f32 v38, v38, v230
    v_mul_f32 v39, v39, v230
    v_mul_f32 v36, v36, v68
    v_mul_f32 v37, v37, v69
    v_mul_f32 v38, v38, v70
    v_mul_f32 v39, v39, v71
    v_cvt_pk_bf16_f32 v180, v36, v37
    v_cvt_pk_bf16_f32 v181, v38, v39
    v_fma_f32 v44, -v228, v196, v44
    v_fma_f32 v76, -v228, v212, v76
    v_fma_f32 v45, -v228, v197, v45
    v_fma_f32 v77, -v228, v213, v77
    v_fma_f32 v46, -v228, v198, v46
    v_fma_f32 v78, -v228, v214, v78
    v_fma_f32 v47, -v228, v199, v47
    v_fma_f32 v79, -v228, v215, v79
    v_mul_f32 v44, v44, v230
    v_mul_f32 v45, v45, v230
    v_mul_f32 v46, v46, v230
    v_mul_f32 v47, v47, v230
    v_mul_f32 v44, v44, v76
    v_mul_f32 v45, v45, v77
    v_mul_f32 v46, v46, v78
    v_mul_f32 v47, v47, v79
    v_cvt_pk_bf16_f32 v182, v44, v45
    v_cvt_pk_bf16_f32 v183, v46, v47
    buffer_store_dwordx4 v[180:183], v2, s[40:43], s71 offen offset:1024 sc1
    s_add_u32 s71, s71, 131072
    v_fma_f32 v48, -v224, v200, v48
    v_fma_f32 v80, -v224, v216, v80
    v_fma_f32 v49, -v224, v201, v49
    v_fma_f32 v81, -v224, v217, v81
    v_fma_f32 v50, -v224, v202, v50
    v_fma_f32 v82, -v224, v218, v82
    v_fma_f32 v51, -v224, v203, v51
    v_fma_f32 v83, -v224, v219, v83
    v_mul_f32 v48, v48, v226
    v_mul_f32 v49, v49, v226
    v_mul_f32 v50, v50, v226
    v_mul_f32 v51, v51, v226
    v_mul_f32 v48, v48, v80
    v_mul_f32 v49, v49, v81
    v_mul_f32 v50, v50, v82
    v_mul_f32 v51, v51, v83
    v_cvt_pk_bf16_f32 v184, v48, v49
    v_cvt_pk_bf16_f32 v185, v50, v51
    v_fma_f32 v56, -v224, v204, v56
    v_fma_f32 v88, -v224, v220, v88
    v_fma_f32 v57, -v224, v205, v57
    v_fma_f32 v89, -v224, v221, v89
    v_fma_f32 v58, -v224, v206, v58
    v_fma_f32 v90, -v224, v222, v90
    v_fma_f32 v59, -v224, v207, v59
    v_fma_f32 v91, -v224, v223, v91
    v_mul_f32 v56, v56, v226
    v_mul_f32 v57, v57, v226
    v_mul_f32 v58, v58, v226
    v_mul_f32 v59, v59, v226
    v_mul_f32 v56, v56, v88
    v_mul_f32 v57, v57, v89
    v_mul_f32 v58, v58, v90
    v_mul_f32 v59, v59, v91
    v_cvt_pk_bf16_f32 v186, v56, v57
    v_cvt_pk_bf16_f32 v187, v58, v59
    buffer_store_dwordx4 v[184:187], v2, s[40:43], s71 offen offset:0 sc1
    v_fma_f32 v52, -v228, v200, v52
    v_fma_f32 v84, -v228, v216, v84
    v_fma_f32 v53, -v228, v201, v53
    v_fma_f32 v85, -v228, v217, v85
    v_fma_f32 v54, -v228, v202, v54
    v_fma_f32 v86, -v228, v218, v86
    v_fma_f32 v55, -v228, v203, v55
    v_fma_f32 v87, -v228, v219, v87
    v_mul_f32 v52, v52, v230
    v_mul_f32 v53, v53, v230
    v_mul_f32 v54, v54, v230
    v_mul_f32 v55, v55, v230
    v_mul_f32 v52, v52, v84
    v_mul_f32 v53, v53, v85
    v_mul_f32 v54, v54, v86
    v_mul_f32 v55, v55, v87
    v_cvt_pk_bf16_f32 v188, v52, v53
    v_cvt_pk_bf16_f32 v189, v54, v55
    v_fma_f32 v60, -v228, v204, v60
    v_fma_f32 v92, -v228, v220, v92
    v_fma_f32 v61, -v228, v205, v61
    v_fma_f32 v93, -v228, v221, v93
    v_fma_f32 v62, -v228, v206, v62
    v_fma_f32 v94, -v228, v222, v94
    v_fma_f32 v63, -v228, v207, v63
    v_fma_f32 v95, -v228, v223, v95
    v_mul_f32 v60, v60, v230
    v_mul_f32 v61, v61, v230
    v_mul_f32 v62, v62, v230
    v_mul_f32 v63, v63, v230
    v_mul_f32 v60, v60, v92
    v_mul_f32 v61, v61, v93
    v_mul_f32 v62, v62, v94
    v_mul_f32 v63, v63, v95
    v_cvt_pk_bf16_f32 v190, v60, v61
    v_cvt_pk_bf16_f32 v191, v62, v63
    buffer_store_dwordx4 v[188:191], v2, s[40:43], s71 offen offset:1024 sc1
    s_add_u32 s71, s71, 131072
    v_mov_b32 v10, 1
    s_waitcnt vmcnt(0)
    s_mov_b64 exec, 1
    ds_add_rtn_u32 v10, v30, v10 offset:8196
    s_mov_b64 exec, -1
    s_waitcnt lgkmcnt(0)
    v_readfirstlane_b32 s27, v10
    s_nop 1
    s_cmp_lg_u32 s27, 3
    s_cbranch_scc1 GL_NF

    s_lshl_b32 s62, s25, 3
    s_add_u32 s62, s62, s26
    s_lshl_b32 s62, s62, 9
    s_add_u32 s62, s62, 14680192
    v_mov_b32 v10, s58
    v_mov_b32 v11, s59
    s_mov_b64 exec, 1
    buffer_store_dwordx2 v[10:11], v3, s[40:43], s62 offen sc1
    s_mov_b64 exec, -1

GL_NF:
    s_setprio 0
    s_mov_b32 s75, 155652
    s_mov_b32 s71, 155668
    s_branch P2_L
GC_LOOP:
    s_barrier
    ds_read_b128 v[64:67], v8 offset:0
    ds_read_b128 v[68:71], v8 offset:2048
    ds_read_b128 v[72:75], v8 offset:4096
    ds_read_b128 v[76:79], v8 offset:6144
    ds_read_b64_tr_b16 v[96:97], v12 offset:32768
    ds_read_b64_tr_b16 v[98:99], v12 offset:34816
    ds_read_b64_tr_b16 v[100:101], v13 offset:32768
    ds_read_b64_tr_b16 v[102:103], v13 offset:34816
    ds_read_b64_tr_b16 v[104:105], v14 offset:32768
    ds_read_b64_tr_b16 v[106:107], v14 offset:34816
    ds_read_b64_tr_b16 v[108:109], v15 offset:32768
    ds_read_b64_tr_b16 v[110:111], v15 offset:34816
    ds_read_b64_tr_b16 v[112:113], v12 offset:40960
    ds_read_b64_tr_b16 v[114:115], v12 offset:43008
    ds_read_b64_tr_b16 v[116:117], v13 offset:40960
    ds_read_b64_tr_b16 v[118:119], v13 offset:43008
    ds_read_b64_tr_b16 v[120:121], v14 offset:40960
    ds_read_b64_tr_b16 v[122:123], v14 offset:43008
    ds_read_b64_tr_b16 v[124:125], v15 offset:40960
    ds_read_b64_tr_b16 v[126:127], v15 offset:43008
    s_waitcnt lgkmcnt(12)
    v_mfma_f32_16x16x32_bf16 v[128:131], v[96:99], v[64:67], 0
    v_mfma_f32_16x16x32_bf16 v[132:135], v[96:99], v[68:71], 0
    ds_read_b128 v[80:83], v9 offset:0
    v_mfma_f32_16x16x32_bf16 v[136:139], v[96:99], v[72:75], 0
    v_mfma_f32_16x16x32_bf16 v[140:143], v[96:99], v[76:79], 0
    ds_read_b64_tr_b16 v[96:97], v16 offset:0
    ds_read_b64_tr_b16 v[98:99], v16 offset:2048
    v_mfma_f32_16x16x32_bf16 v[144:147], v[100:103], v[64:67], 0
    v_mfma_f32_16x16x32_bf16 v[148:151], v[100:103], v[68:71], 0
    ds_read_b128 v[84:87], v9 offset:2048
    v_mfma_f32_16x16x32_bf16 v[152:155], v[100:103], v[72:75], 0
    v_mfma_f32_16x16x32_bf16 v[156:159], v[100:103], v[76:79], 0
    ds_read_b64_tr_b16 v[100:101], v17 offset:0
    ds_read_b64_tr_b16 v[102:103], v17 offset:2048
    s_waitcnt lgkmcnt(14)
    v_mfma_f32_16x16x32_bf16 v[160:163], v[104:107], v[64:67], 0
    v_mfma_f32_16x16x32_bf16 v[164:167], v[104:107], v[68:71], 0
    ds_read_b128 v[88:91], v9 offset:4096
    v_mfma_f32_16x16x32_bf16 v[168:171], v[104:107], v[72:75], 0
    v_mfma_f32_16x16x32_bf16 v[172:175], v[104:107], v[76:79], 0
    ds_read_b64_tr_b16 v[104:105], v18 offset:0
    ds_read_b64_tr_b16 v[106:107], v18 offset:2048
    v_mfma_f32_16x16x32_bf16 v[176:179], v[108:111], v[64:67], 0
    v_mfma_f32_16x16x32_bf16 v[180:183], v[108:111], v[68:71], 0
    ds_read_b128 v[92:95], v9 offset:6144
    v_mfma_f32_16x16x32_bf16 v[184:187], v[108:111], v[72:75], 0
    v_mfma_f32_16x16x32_bf16 v[188:191], v[108:111], v[76:79], 0
    ds_read_b64_tr_b16 v[108:109], v19 offset:0
    ds_read_b64_tr_b16 v[110:111], v19 offset:2048
    s_waitcnt lgkmcnt(15)
    v_mfma_f32_16x16x32_bf16 v[192:195], v[112:115], v[64:67], 0
    v_mfma_f32_16x16x32_bf16 v[196:199], v[112:115], v[68:71], 0
    v_mfma_f32_16x16x32_bf16 v[200:203], v[112:115], v[72:75], 0
    v_mfma_f32_16x16x32_bf16 v[204:207], v[112:115], v[76:79], 0
    ds_read_b64_tr_b16 v[112:113], v16 offset:8192
    ds_read_b64_tr_b16 v[114:115], v16 offset:10240
    v_mfma_f32_16x16x32_bf16 v[208:211], v[116:119], v[64:67], 0
    v_mfma_f32_16x16x32_bf16 v[212:215], v[116:119], v[68:71], 0
    v_mfma_f32_16x16x32_bf16 v[216:219], v[116:119], v[72:75], 0
    v_mfma_f32_16x16x32_bf16 v[220:223], v[116:119], v[76:79], 0
    ds_read_b64_tr_b16 v[116:117], v17 offset:8192
    ds_read_b64_tr_b16 v[118:119], v17 offset:10240
    s_waitcnt lgkmcnt(15)
    v_mfma_f32_16x16x32_bf16 v[224:227], v[120:123], v[64:67], 0
    v_mfma_f32_16x16x32_bf16 v[228:231], v[120:123], v[68:71], 0
    v_mfma_f32_16x16x32_bf16 v[232:235], v[120:123], v[72:75], 0
    v_mfma_f32_16x16x32_bf16 v[236:239], v[120:123], v[76:79], 0
    ds_read_b64_tr_b16 v[120:121], v18 offset:8192
    ds_read_b64_tr_b16 v[122:123], v18 offset:10240
    v_mfma_f32_16x16x32_bf16 v[240:243], v[124:127], v[64:67], 0
    v_mfma_f32_16x16x32_bf16 v[244:247], v[124:127], v[68:71], 0
    v_mfma_f32_16x16x32_bf16 v[248:251], v[124:127], v[72:75], 0
    v_mfma_f32_16x16x32_bf16 v[252:255], v[124:127], v[76:79], 0
    ds_read_b64_tr_b16 v[124:125], v19 offset:8192
    ds_read_b64_tr_b16 v[126:127], v19 offset:10240
    s_barrier
    s_waitcnt lgkmcnt(10)
    v_mfma_f32_16x16x32_bf16 v[128:131], v[96:99], v[80:83], v[128:131]
    v_mfma_f32_16x16x32_bf16 v[132:135], v[96:99], v[84:87], v[132:135]
    ds_read_b128 v[64:67], v8 offset:16384
    v_mfma_f32_16x16x32_bf16 v[136:139], v[96:99], v[88:91], v[136:139]
    v_mfma_f32_16x16x32_bf16 v[140:143], v[96:99], v[92:95], v[140:143]
    ds_read_b64_tr_b16 v[96:97], v16 offset:16384
    ds_read_b64_tr_b16 v[98:99], v16 offset:18432
    v_mfma_f32_16x16x32_bf16 v[144:147], v[100:103], v[80:83], v[144:147]
    v_mfma_f32_16x16x32_bf16 v[148:151], v[100:103], v[84:87], v[148:151]
    ds_read_b128 v[68:71], v8 offset:18432
    v_mfma_f32_16x16x32_bf16 v[152:155], v[100:103], v[88:91], v[152:155]
    v_mfma_f32_16x16x32_bf16 v[156:159], v[100:103], v[92:95], v[156:159]
    ds_read_b64_tr_b16 v[100:101], v17 offset:16384
    ds_read_b64_tr_b16 v[102:103], v17 offset:18432
    s_waitcnt lgkmcnt(14)
    v_mfma_f32_16x16x32_bf16 v[160:163], v[104:107], v[80:83], v[160:163]
    v_mfma_f32_16x16x32_bf16 v[164:167], v[104:107], v[84:87], v[164:167]
    ds_read_b128 v[72:75], v8 offset:20480
    v_mfma_f32_16x16x32_bf16 v[168:171], v[104:107], v[88:91], v[168:171]
    v_mfma_f32_16x16x32_bf16 v[172:175], v[104:107], v[92:95], v[172:175]
    ds_read_b64_tr_b16 v[104:105], v18 offset:16384
    ds_read_b64_tr_b16 v[106:107], v18 offset:18432
    v_mfma_f32_16x16x32_bf16 v[176:179], v[108:111], v[80:83], v[176:179]
    v_mfma_f32_16x16x32_bf16 v[180:183], v[108:111], v[84:87], v[180:183]
    ds_read_b128 v[76:79], v8 offset:22528
    v_mfma_f32_16x16x32_bf16 v[184:187], v[108:111], v[88:91], v[184:187]
    v_mfma_f32_16x16x32_bf16 v[188:191], v[108:111], v[92:95], v[188:191]
    ds_read_b64_tr_b16 v[108:109], v19 offset:16384
    ds_read_b64_tr_b16 v[110:111], v19 offset:18432
    s_waitcnt lgkmcnt(15)
    v_mfma_f32_16x16x32_bf16 v[192:195], v[112:115], v[80:83], v[192:195]
    v_mfma_f32_16x16x32_bf16 v[196:199], v[112:115], v[84:87], v[196:199]
    v_mfma_f32_16x16x32_bf16 v[200:203], v[112:115], v[88:91], v[200:203]
    v_mfma_f32_16x16x32_bf16 v[204:207], v[112:115], v[92:95], v[204:207]
    ds_read_b64_tr_b16 v[112:113], v16 offset:24576
    ds_read_b64_tr_b16 v[114:115], v16 offset:26624
    v_mfma_f32_16x16x32_bf16 v[208:211], v[116:119], v[80:83], v[208:211]
    v_mfma_f32_16x16x32_bf16 v[212:215], v[116:119], v[84:87], v[212:215]
    v_mfma_f32_16x16x32_bf16 v[216:219], v[116:119], v[88:91], v[216:219]
    v_mfma_f32_16x16x32_bf16 v[220:223], v[116:119], v[92:95], v[220:223]
    ds_read_b64_tr_b16 v[116:117], v17 offset:24576
    ds_read_b64_tr_b16 v[118:119], v17 offset:26624
    s_waitcnt lgkmcnt(15)
    v_mfma_f32_16x16x32_bf16 v[224:227], v[120:123], v[80:83], v[224:227]
    v_mfma_f32_16x16x32_bf16 v[228:231], v[120:123], v[84:87], v[228:231]
    v_mfma_f32_16x16x32_bf16 v[232:235], v[120:123], v[88:91], v[232:235]
    v_mfma_f32_16x16x32_bf16 v[236:239], v[120:123], v[92:95], v[236:239]
    ds_read_b64_tr_b16 v[120:121], v18 offset:24576
    ds_read_b64_tr_b16 v[122:123], v18 offset:26624
    v_mfma_f32_16x16x32_bf16 v[240:243], v[124:127], v[80:83], v[240:243]
    v_mfma_f32_16x16x32_bf16 v[244:247], v[124:127], v[84:87], v[244:247]
    v_mfma_f32_16x16x32_bf16 v[248:251], v[124:127], v[88:91], v[248:251]
    v_mfma_f32_16x16x32_bf16 v[252:255], v[124:127], v[92:95], v[252:255]
    ds_read_b64_tr_b16 v[124:125], v19 offset:24576
    ds_read_b64_tr_b16 v[126:127], v19 offset:26624
    s_barrier
    s_waitcnt lgkmcnt(10)
    v_mfma_f32_16x16x32_bf16 v[128:131], v[96:99], v[64:67], v[128:131]
    v_mfma_f32_16x16x32_bf16 v[132:135], v[96:99], v[68:71], v[132:135]
    ds_read_b128 v[80:83], v9 offset:16384
    v_mfma_f32_16x16x32_bf16 v[136:139], v[96:99], v[72:75], v[136:139]
    v_mfma_f32_16x16x32_bf16 v[140:143], v[96:99], v[76:79], v[140:143]
    ds_read_b64_tr_b16 v[96:97], v12 offset:0
    ds_read_b64_tr_b16 v[98:99], v12 offset:2048
    v_mfma_f32_16x16x32_bf16 v[144:147], v[100:103], v[64:67], v[144:147]
    v_mfma_f32_16x16x32_bf16 v[148:151], v[100:103], v[68:71], v[148:151]
    ds_read_b128 v[84:87], v9 offset:18432
    v_mfma_f32_16x16x32_bf16 v[152:155], v[100:103], v[72:75], v[152:155]
    v_mfma_f32_16x16x32_bf16 v[156:159], v[100:103], v[76:79], v[156:159]
    ds_read_b64_tr_b16 v[100:101], v13 offset:0
    ds_read_b64_tr_b16 v[102:103], v13 offset:2048
    s_waitcnt lgkmcnt(14)
    v_mfma_f32_16x16x32_bf16 v[160:163], v[104:107], v[64:67], v[160:163]
    v_mfma_f32_16x16x32_bf16 v[164:167], v[104:107], v[68:71], v[164:167]
    ds_read_b128 v[88:91], v9 offset:20480
    v_mfma_f32_16x16x32_bf16 v[168:171], v[104:107], v[72:75], v[168:171]
    v_mfma_f32_16x16x32_bf16 v[172:175], v[104:107], v[76:79], v[172:175]
    ds_read_b64_tr_b16 v[104:105], v14 offset:0
    ds_read_b64_tr_b16 v[106:107], v14 offset:2048
    v_mfma_f32_16x16x32_bf16 v[176:179], v[108:111], v[64:67], v[176:179]
    v_mfma_f32_16x16x32_bf16 v[180:183], v[108:111], v[68:71], v[180:183]
    ds_read_b128 v[92:95], v9 offset:22528
    v_mfma_f32_16x16x32_bf16 v[184:187], v[108:111], v[72:75], v[184:187]
    v_mfma_f32_16x16x32_bf16 v[188:191], v[108:111], v[76:79], v[188:191]
    ds_read_b64_tr_b16 v[108:109], v15 offset:0
    ds_read_b64_tr_b16 v[110:111], v15 offset:2048
    s_waitcnt lgkmcnt(15)
    v_mfma_f32_16x16x32_bf16 v[192:195], v[112:115], v[64:67], v[192:195]
    v_mfma_f32_16x16x32_bf16 v[196:199], v[112:115], v[68:71], v[196:199]
    v_mfma_f32_16x16x32_bf16 v[200:203], v[112:115], v[72:75], v[200:203]
    v_mfma_f32_16x16x32_bf16 v[204:207], v[112:115], v[76:79], v[204:207]
    ds_read_b64_tr_b16 v[112:113], v12 offset:8192
    ds_read_b64_tr_b16 v[114:115], v12 offset:10240
    v_mfma_f32_16x16x32_bf16 v[208:211], v[116:119], v[64:67], v[208:211]
    v_mfma_f32_16x16x32_bf16 v[212:215], v[116:119], v[68:71], v[212:215]
    v_mfma_f32_16x16x32_bf16 v[216:219], v[116:119], v[72:75], v[216:219]
    v_mfma_f32_16x16x32_bf16 v[220:223], v[116:119], v[76:79], v[220:223]
    ds_read_b64_tr_b16 v[116:117], v13 offset:8192
    ds_read_b64_tr_b16 v[118:119], v13 offset:10240
    s_waitcnt lgkmcnt(15)
    v_mfma_f32_16x16x32_bf16 v[224:227], v[120:123], v[64:67], v[224:227]
    v_mfma_f32_16x16x32_bf16 v[228:231], v[120:123], v[68:71], v[228:231]
    v_mfma_f32_16x16x32_bf16 v[232:235], v[120:123], v[72:75], v[232:235]
    v_mfma_f32_16x16x32_bf16 v[236:239], v[120:123], v[76:79], v[236:239]
    ds_read_b64_tr_b16 v[120:121], v14 offset:8192
    ds_read_b64_tr_b16 v[122:123], v14 offset:10240
    v_mfma_f32_16x16x32_bf16 v[240:243], v[124:127], v[64:67], v[240:243]
    v_mfma_f32_16x16x32_bf16 v[244:247], v[124:127], v[68:71], v[244:247]
    v_mfma_f32_16x16x32_bf16 v[248:251], v[124:127], v[72:75], v[248:251]
    v_mfma_f32_16x16x32_bf16 v[252:255], v[124:127], v[76:79], v[252:255]
    ds_read_b64_tr_b16 v[124:125], v15 offset:8192
    ds_read_b64_tr_b16 v[126:127], v15 offset:10240
    s_barrier
    s_waitcnt lgkmcnt(10)
    v_mfma_f32_16x16x32_bf16 v[128:131], v[96:99], v[80:83], v[128:131]
    v_mfma_f32_16x16x32_bf16 v[132:135], v[96:99], v[84:87], v[132:135]
    ds_read_b128 v[64:67], v8 offset:32768
    v_mfma_f32_16x16x32_bf16 v[136:139], v[96:99], v[88:91], v[136:139]
    v_mfma_f32_16x16x32_bf16 v[140:143], v[96:99], v[92:95], v[140:143]
    ds_read_b64_tr_b16 v[96:97], v12 offset:16384
    ds_read_b64_tr_b16 v[98:99], v12 offset:18432
    v_mfma_f32_16x16x32_bf16 v[144:147], v[100:103], v[80:83], v[144:147]
    v_mfma_f32_16x16x32_bf16 v[148:151], v[100:103], v[84:87], v[148:151]
    ds_read_b128 v[68:71], v8 offset:34816
    v_mfma_f32_16x16x32_bf16 v[152:155], v[100:103], v[88:91], v[152:155]
    v_mfma_f32_16x16x32_bf16 v[156:159], v[100:103], v[92:95], v[156:159]
    ds_read_b64_tr_b16 v[100:101], v13 offset:16384
    ds_read_b64_tr_b16 v[102:103], v13 offset:18432
    s_waitcnt lgkmcnt(14)
    v_mfma_f32_16x16x32_bf16 v[160:163], v[104:107], v[80:83], v[160:163]
    v_mfma_f32_16x16x32_bf16 v[164:167], v[104:107], v[84:87], v[164:167]
    ds_read_b128 v[72:75], v8 offset:36864
    v_mfma_f32_16x16x32_bf16 v[168:171], v[104:107], v[88:91], v[168:171]
    v_mfma_f32_16x16x32_bf16 v[172:175], v[104:107], v[92:95], v[172:175]
    ds_read_b64_tr_b16 v[104:105], v14 offset:16384
    ds_read_b64_tr_b16 v[106:107], v14 offset:18432
    v_mfma_f32_16x16x32_bf16 v[176:179], v[108:111], v[80:83], v[176:179]
    v_mfma_f32_16x16x32_bf16 v[180:183], v[108:111], v[84:87], v[180:183]
    ds_read_b128 v[76:79], v8 offset:38912
    v_mfma_f32_16x16x32_bf16 v[184:187], v[108:111], v[88:91], v[184:187]
    v_mfma_f32_16x16x32_bf16 v[188:191], v[108:111], v[92:95], v[188:191]
    ds_read_b64_tr_b16 v[108:109], v15 offset:16384
    ds_read_b64_tr_b16 v[110:111], v15 offset:18432
    s_waitcnt lgkmcnt(15)
    v_mfma_f32_16x16x32_bf16 v[192:195], v[112:115], v[80:83], v[192:195]
    v_mfma_f32_16x16x32_bf16 v[196:199], v[112:115], v[84:87], v[196:199]
    v_mfma_f32_16x16x32_bf16 v[200:203], v[112:115], v[88:91], v[200:203]
    v_mfma_f32_16x16x32_bf16 v[204:207], v[112:115], v[92:95], v[204:207]
    ds_read_b64_tr_b16 v[112:113], v12 offset:24576
    ds_read_b64_tr_b16 v[114:115], v12 offset:26624
    v_mfma_f32_16x16x32_bf16 v[208:211], v[116:119], v[80:83], v[208:211]
    v_mfma_f32_16x16x32_bf16 v[212:215], v[116:119], v[84:87], v[212:215]
    v_mfma_f32_16x16x32_bf16 v[216:219], v[116:119], v[88:91], v[216:219]
    v_mfma_f32_16x16x32_bf16 v[220:223], v[116:119], v[92:95], v[220:223]
    ds_read_b64_tr_b16 v[116:117], v13 offset:24576
    ds_read_b64_tr_b16 v[118:119], v13 offset:26624
    s_waitcnt lgkmcnt(15)
    v_mfma_f32_16x16x32_bf16 v[224:227], v[120:123], v[80:83], v[224:227]
    v_mfma_f32_16x16x32_bf16 v[228:231], v[120:123], v[84:87], v[228:231]
    v_mfma_f32_16x16x32_bf16 v[232:235], v[120:123], v[88:91], v[232:235]
    v_mfma_f32_16x16x32_bf16 v[236:239], v[120:123], v[92:95], v[236:239]
    ds_read_b64_tr_b16 v[120:121], v14 offset:24576
    ds_read_b64_tr_b16 v[122:123], v14 offset:26624
    v_mfma_f32_16x16x32_bf16 v[240:243], v[124:127], v[80:83], v[240:243]
    v_mfma_f32_16x16x32_bf16 v[244:247], v[124:127], v[84:87], v[244:247]
    v_mfma_f32_16x16x32_bf16 v[248:251], v[124:127], v[88:91], v[248:251]
    v_mfma_f32_16x16x32_bf16 v[252:255], v[124:127], v[92:95], v[252:255]
    ds_read_b64_tr_b16 v[124:125], v15 offset:24576
    ds_read_b64_tr_b16 v[126:127], v15 offset:26624
    s_barrier
    s_waitcnt lgkmcnt(10)
    v_mfma_f32_16x16x32_bf16 v[128:131], v[96:99], v[64:67], v[128:131]
    v_mfma_f32_16x16x32_bf16 v[132:135], v[96:99], v[68:71], v[132:135]
    ds_read_b128 v[80:83], v9 offset:32768
    v_mfma_f32_16x16x32_bf16 v[136:139], v[96:99], v[72:75], v[136:139]
    v_mfma_f32_16x16x32_bf16 v[140:143], v[96:99], v[76:79], v[140:143]
    ds_read_b64_tr_b16 v[96:97], v12 offset:32768
    ds_read_b64_tr_b16 v[98:99], v12 offset:34816
    v_mfma_f32_16x16x32_bf16 v[144:147], v[100:103], v[64:67], v[144:147]
    v_mfma_f32_16x16x32_bf16 v[148:151], v[100:103], v[68:71], v[148:151]
    ds_read_b128 v[84:87], v9 offset:34816
    v_mfma_f32_16x16x32_bf16 v[152:155], v[100:103], v[72:75], v[152:155]
    v_mfma_f32_16x16x32_bf16 v[156:159], v[100:103], v[76:79], v[156:159]
    ds_read_b64_tr_b16 v[100:101], v13 offset:32768
    ds_read_b64_tr_b16 v[102:103], v13 offset:34816
    s_waitcnt lgkmcnt(14)
    v_mfma_f32_16x16x32_bf16 v[160:163], v[104:107], v[64:67], v[160:163]
    v_mfma_f32_16x16x32_bf16 v[164:167], v[104:107], v[68:71], v[164:167]
    ds_read_b128 v[88:91], v9 offset:36864
    v_mfma_f32_16x16x32_bf16 v[168:171], v[104:107], v[72:75], v[168:171]
    v_mfma_f32_16x16x32_bf16 v[172:175], v[104:107], v[76:79], v[172:175]
    ds_read_b64_tr_b16 v[104:105], v14 offset:32768
    ds_read_b64_tr_b16 v[106:107], v14 offset:34816
    v_mfma_f32_16x16x32_bf16 v[176:179], v[108:111], v[64:67], v[176:179]
    v_mfma_f32_16x16x32_bf16 v[180:183], v[108:111], v[68:71], v[180:183]
    ds_read_b128 v[92:95], v9 offset:38912
    v_mfma_f32_16x16x32_bf16 v[184:187], v[108:111], v[72:75], v[184:187]
    v_mfma_f32_16x16x32_bf16 v[188:191], v[108:111], v[76:79], v[188:191]
    ds_read_b64_tr_b16 v[108:109], v15 offset:32768
    ds_read_b64_tr_b16 v[110:111], v15 offset:34816
    s_waitcnt lgkmcnt(15)
    v_mfma_f32_16x16x32_bf16 v[192:195], v[112:115], v[64:67], v[192:195]
    v_mfma_f32_16x16x32_bf16 v[196:199], v[112:115], v[68:71], v[196:199]
    v_mfma_f32_16x16x32_bf16 v[200:203], v[112:115], v[72:75], v[200:203]
    v_mfma_f32_16x16x32_bf16 v[204:207], v[112:115], v[76:79], v[204:207]
    ds_read_b64_tr_b16 v[112:113], v12 offset:40960
    ds_read_b64_tr_b16 v[114:115], v12 offset:43008
    v_mfma_f32_16x16x32_bf16 v[208:211], v[116:119], v[64:67], v[208:211]
    v_mfma_f32_16x16x32_bf16 v[212:215], v[116:119], v[68:71], v[212:215]
    v_mfma_f32_16x16x32_bf16 v[216:219], v[116:119], v[72:75], v[216:219]
    v_mfma_f32_16x16x32_bf16 v[220:223], v[116:119], v[76:79], v[220:223]
    ds_read_b64_tr_b16 v[116:117], v13 offset:40960
    ds_read_b64_tr_b16 v[118:119], v13 offset:43008
    s_waitcnt lgkmcnt(15)
    v_mfma_f32_16x16x32_bf16 v[224:227], v[120:123], v[64:67], v[224:227]
    v_mfma_f32_16x16x32_bf16 v[228:231], v[120:123], v[68:71], v[228:231]
    v_mfma_f32_16x16x32_bf16 v[232:235], v[120:123], v[72:75], v[232:235]
    v_mfma_f32_16x16x32_bf16 v[236:239], v[120:123], v[76:79], v[236:239]
    ds_read_b64_tr_b16 v[120:121], v14 offset:40960
    ds_read_b64_tr_b16 v[122:123], v14 offset:43008
    v_mfma_f32_16x16x32_bf16 v[240:243], v[124:127], v[64:67], v[240:243]
    v_mfma_f32_16x16x32_bf16 v[244:247], v[124:127], v[68:71], v[244:247]
    v_mfma_f32_16x16x32_bf16 v[248:251], v[124:127], v[72:75], v[248:251]
    v_mfma_f32_16x16x32_bf16 v[252:255], v[124:127], v[76:79], v[252:255]
    ds_read_b64_tr_b16 v[124:125], v15 offset:40960
    ds_read_b64_tr_b16 v[126:127], v15 offset:43008
    s_barrier
    s_waitcnt lgkmcnt(10)
    v_mfma_f32_16x16x32_bf16 v[128:131], v[96:99], v[80:83], v[128:131]
    v_mfma_f32_16x16x32_bf16 v[132:135], v[96:99], v[84:87], v[132:135]
    ds_read_b128 v[64:67], v8 offset:49152
    v_mfma_f32_16x16x32_bf16 v[136:139], v[96:99], v[88:91], v[136:139]
    v_mfma_f32_16x16x32_bf16 v[140:143], v[96:99], v[92:95], v[140:143]
    ds_read_b64_tr_b16 v[96:97], v16 offset:0
    ds_read_b64_tr_b16 v[98:99], v16 offset:2048
    v_mfma_f32_16x16x32_bf16 v[144:147], v[100:103], v[80:83], v[144:147]
    v_mfma_f32_16x16x32_bf16 v[148:151], v[100:103], v[84:87], v[148:151]
    ds_read_b128 v[68:71], v8 offset:51200
    v_mfma_f32_16x16x32_bf16 v[152:155], v[100:103], v[88:91], v[152:155]
    v_mfma_f32_16x16x32_bf16 v[156:159], v[100:103], v[92:95], v[156:159]
    ds_read_b64_tr_b16 v[100:101], v17 offset:0
    ds_read_b64_tr_b16 v[102:103], v17 offset:2048
    s_waitcnt lgkmcnt(14)
    v_mfma_f32_16x16x32_bf16 v[160:163], v[104:107], v[80:83], v[160:163]
    v_mfma_f32_16x16x32_bf16 v[164:167], v[104:107], v[84:87], v[164:167]
    ds_read_b128 v[72:75], v8 offset:53248
    v_mfma_f32_16x16x32_bf16 v[168:171], v[104:107], v[88:91], v[168:171]
    v_mfma_f32_16x16x32_bf16 v[172:175], v[104:107], v[92:95], v[172:175]
    ds_read_b64_tr_b16 v[104:105], v18 offset:0
    ds_read_b64_tr_b16 v[106:107], v18 offset:2048
    v_mfma_f32_16x16x32_bf16 v[176:179], v[108:111], v[80:83], v[176:179]
    v_mfma_f32_16x16x32_bf16 v[180:183], v[108:111], v[84:87], v[180:183]
    ds_read_b128 v[76:79], v8 offset:55296
    v_mfma_f32_16x16x32_bf16 v[184:187], v[108:111], v[88:91], v[184:187]
    v_mfma_f32_16x16x32_bf16 v[188:191], v[108:111], v[92:95], v[188:191]
    ds_read_b64_tr_b16 v[108:109], v19 offset:0
    ds_read_b64_tr_b16 v[110:111], v19 offset:2048
    s_waitcnt lgkmcnt(15)
    v_mfma_f32_16x16x32_bf16 v[192:195], v[112:115], v[80:83], v[192:195]
    v_mfma_f32_16x16x32_bf16 v[196:199], v[112:115], v[84:87], v[196:199]
    v_mfma_f32_16x16x32_bf16 v[200:203], v[112:115], v[88:91], v[200:203]
    v_mfma_f32_16x16x32_bf16 v[204:207], v[112:115], v[92:95], v[204:207]
    ds_read_b64_tr_b16 v[112:113], v16 offset:8192
    ds_read_b64_tr_b16 v[114:115], v16 offset:10240
    v_mfma_f32_16x16x32_bf16 v[208:211], v[116:119], v[80:83], v[208:211]
    v_mfma_f32_16x16x32_bf16 v[212:215], v[116:119], v[84:87], v[212:215]
    v_mfma_f32_16x16x32_bf16 v[216:219], v[116:119], v[88:91], v[216:219]
    v_mfma_f32_16x16x32_bf16 v[220:223], v[116:119], v[92:95], v[220:223]
    ds_read_b64_tr_b16 v[116:117], v17 offset:8192
    ds_read_b64_tr_b16 v[118:119], v17 offset:10240
    s_waitcnt lgkmcnt(15)
    v_mfma_f32_16x16x32_bf16 v[224:227], v[120:123], v[80:83], v[224:227]
    v_mfma_f32_16x16x32_bf16 v[228:231], v[120:123], v[84:87], v[228:231]
    v_mfma_f32_16x16x32_bf16 v[232:235], v[120:123], v[88:91], v[232:235]
    v_mfma_f32_16x16x32_bf16 v[236:239], v[120:123], v[92:95], v[236:239]
    ds_read_b64_tr_b16 v[120:121], v18 offset:8192
    ds_read_b64_tr_b16 v[122:123], v18 offset:10240
    v_mfma_f32_16x16x32_bf16 v[240:243], v[124:127], v[80:83], v[240:243]
    v_mfma_f32_16x16x32_bf16 v[244:247], v[124:127], v[84:87], v[244:247]
    v_mfma_f32_16x16x32_bf16 v[248:251], v[124:127], v[88:91], v[248:251]
    v_mfma_f32_16x16x32_bf16 v[252:255], v[124:127], v[92:95], v[252:255]
    ds_read_b64_tr_b16 v[124:125], v19 offset:8192
    ds_read_b64_tr_b16 v[126:127], v19 offset:10240
    s_barrier
    s_waitcnt lgkmcnt(10)
    v_mfma_f32_16x16x32_bf16 v[128:131], v[96:99], v[64:67], v[128:131]
    v_mfma_f32_16x16x32_bf16 v[132:135], v[96:99], v[68:71], v[132:135]
    ds_read_b128 v[80:83], v9 offset:49152
    v_mfma_f32_16x16x32_bf16 v[136:139], v[96:99], v[72:75], v[136:139]
    v_mfma_f32_16x16x32_bf16 v[140:143], v[96:99], v[76:79], v[140:143]
    ds_read_b64_tr_b16 v[96:97], v16 offset:16384
    ds_read_b64_tr_b16 v[98:99], v16 offset:18432
    v_mfma_f32_16x16x32_bf16 v[144:147], v[100:103], v[64:67], v[144:147]
    v_mfma_f32_16x16x32_bf16 v[148:151], v[100:103], v[68:71], v[148:151]
    ds_read_b128 v[84:87], v9 offset:51200
    v_mfma_f32_16x16x32_bf16 v[152:155], v[100:103], v[72:75], v[152:155]
    v_mfma_f32_16x16x32_bf16 v[156:159], v[100:103], v[76:79], v[156:159]
    ds_read_b64_tr_b16 v[100:101], v17 offset:16384
    ds_read_b64_tr_b16 v[102:103], v17 offset:18432
    s_waitcnt lgkmcnt(14)
    v_mfma_f32_16x16x32_bf16 v[160:163], v[104:107], v[64:67], v[160:163]
    v_mfma_f32_16x16x32_bf16 v[164:167], v[104:107], v[68:71], v[164:167]
    ds_read_b128 v[88:91], v9 offset:53248
    v_mfma_f32_16x16x32_bf16 v[168:171], v[104:107], v[72:75], v[168:171]
    v_mfma_f32_16x16x32_bf16 v[172:175], v[104:107], v[76:79], v[172:175]
    ds_read_b64_tr_b16 v[104:105], v18 offset:16384
    ds_read_b64_tr_b16 v[106:107], v18 offset:18432
    v_mfma_f32_16x16x32_bf16 v[176:179], v[108:111], v[64:67], v[176:179]
    v_mfma_f32_16x16x32_bf16 v[180:183], v[108:111], v[68:71], v[180:183]
    ds_read_b128 v[92:95], v9 offset:55296
    v_mfma_f32_16x16x32_bf16 v[184:187], v[108:111], v[72:75], v[184:187]
    v_mfma_f32_16x16x32_bf16 v[188:191], v[108:111], v[76:79], v[188:191]
    ds_read_b64_tr_b16 v[108:109], v19 offset:16384
    ds_read_b64_tr_b16 v[110:111], v19 offset:18432
    s_waitcnt lgkmcnt(15)
    v_mfma_f32_16x16x32_bf16 v[192:195], v[112:115], v[64:67], v[192:195]
    v_mfma_f32_16x16x32_bf16 v[196:199], v[112:115], v[68:71], v[196:199]
    v_mfma_f32_16x16x32_bf16 v[200:203], v[112:115], v[72:75], v[200:203]
    v_mfma_f32_16x16x32_bf16 v[204:207], v[112:115], v[76:79], v[204:207]
    ds_read_b64_tr_b16 v[112:113], v16 offset:24576
    ds_read_b64_tr_b16 v[114:115], v16 offset:26624
    v_mfma_f32_16x16x32_bf16 v[208:211], v[116:119], v[64:67], v[208:211]
    v_mfma_f32_16x16x32_bf16 v[212:215], v[116:119], v[68:71], v[212:215]
    v_mfma_f32_16x16x32_bf16 v[216:219], v[116:119], v[72:75], v[216:219]
    v_mfma_f32_16x16x32_bf16 v[220:223], v[116:119], v[76:79], v[220:223]
    ds_read_b64_tr_b16 v[116:117], v17 offset:24576
    ds_read_b64_tr_b16 v[118:119], v17 offset:26624
    s_waitcnt lgkmcnt(15)
    v_mfma_f32_16x16x32_bf16 v[224:227], v[120:123], v[64:67], v[224:227]
    v_mfma_f32_16x16x32_bf16 v[228:231], v[120:123], v[68:71], v[228:231]
    v_mfma_f32_16x16x32_bf16 v[232:235], v[120:123], v[72:75], v[232:235]
    v_mfma_f32_16x16x32_bf16 v[236:239], v[120:123], v[76:79], v[236:239]
    ds_read_b64_tr_b16 v[120:121], v18 offset:24576
    ds_read_b64_tr_b16 v[122:123], v18 offset:26624
    v_mfma_f32_16x16x32_bf16 v[240:243], v[124:127], v[64:67], v[240:243]
    v_mfma_f32_16x16x32_bf16 v[244:247], v[124:127], v[68:71], v[244:247]
    v_mfma_f32_16x16x32_bf16 v[248:251], v[124:127], v[72:75], v[248:251]
    v_mfma_f32_16x16x32_bf16 v[252:255], v[124:127], v[76:79], v[252:255]
    ds_read_b64_tr_b16 v[124:125], v19 offset:24576
    ds_read_b64_tr_b16 v[126:127], v19 offset:26624
    s_barrier
    s_waitcnt lgkmcnt(10)
    v_mfma_f32_16x16x32_bf16 v[128:131], v[96:99], v[80:83], v[128:131]
    v_mfma_f32_16x16x32_bf16 v[132:135], v[96:99], v[84:87], v[132:135]
    ds_read_b128 v[64:67], v8 offset:0
    v_mfma_f32_16x16x32_bf16 v[136:139], v[96:99], v[88:91], v[136:139]
    v_mfma_f32_16x16x32_bf16 v[140:143], v[96:99], v[92:95], v[140:143]
    ds_read_b64_tr_b16 v[96:97], v12 offset:0
    ds_read_b64_tr_b16 v[98:99], v12 offset:2048
    v_mfma_f32_16x16x32_bf16 v[144:147], v[100:103], v[80:83], v[144:147]
    v_mfma_f32_16x16x32_bf16 v[148:151], v[100:103], v[84:87], v[148:151]
    ds_read_b128 v[68:71], v8 offset:2048
    v_mfma_f32_16x16x32_bf16 v[152:155], v[100:103], v[88:91], v[152:155]
    v_mfma_f32_16x16x32_bf16 v[156:159], v[100:103], v[92:95], v[156:159]
    ds_read_b64_tr_b16 v[100:101], v13 offset:0
    ds_read_b64_tr_b16 v[102:103], v13 offset:2048
    s_waitcnt lgkmcnt(14)
    v_mfma_f32_16x16x32_bf16 v[160:163], v[104:107], v[80:83], v[160:163]
    v_mfma_f32_16x16x32_bf16 v[164:167], v[104:107], v[84:87], v[164:167]
    ds_read_b128 v[72:75], v8 offset:4096
    v_mfma_f32_16x16x32_bf16 v[168:171], v[104:107], v[88:91], v[168:171]
    v_mfma_f32_16x16x32_bf16 v[172:175], v[104:107], v[92:95], v[172:175]
    ds_read_b64_tr_b16 v[104:105], v14 offset:0
    ds_read_b64_tr_b16 v[106:107], v14 offset:2048
    v_mfma_f32_16x16x32_bf16 v[176:179], v[108:111], v[80:83], v[176:179]
    v_mfma_f32_16x16x32_bf16 v[180:183], v[108:111], v[84:87], v[180:183]
    ds_read_b128 v[76:79], v8 offset:6144
    v_mfma_f32_16x16x32_bf16 v[184:187], v[108:111], v[88:91], v[184:187]
    v_mfma_f32_16x16x32_bf16 v[188:191], v[108:111], v[92:95], v[188:191]
    ds_read_b64_tr_b16 v[108:109], v15 offset:0
    ds_read_b64_tr_b16 v[110:111], v15 offset:2048
    s_waitcnt lgkmcnt(15)
    v_mfma_f32_16x16x32_bf16 v[192:195], v[112:115], v[80:83], v[192:195]
    v_mfma_f32_16x16x32_bf16 v[196:199], v[112:115], v[84:87], v[196:199]
    v_mfma_f32_16x16x32_bf16 v[200:203], v[112:115], v[88:91], v[200:203]
    v_mfma_f32_16x16x32_bf16 v[204:207], v[112:115], v[92:95], v[204:207]
    ds_read_b64_tr_b16 v[112:113], v12 offset:8192
    ds_read_b64_tr_b16 v[114:115], v12 offset:10240
    v_mfma_f32_16x16x32_bf16 v[208:211], v[116:119], v[80:83], v[208:211]
    v_mfma_f32_16x16x32_bf16 v[212:215], v[116:119], v[84:87], v[212:215]
    v_mfma_f32_16x16x32_bf16 v[216:219], v[116:119], v[88:91], v[216:219]
    v_mfma_f32_16x16x32_bf16 v[220:223], v[116:119], v[92:95], v[220:223]
    ds_read_b64_tr_b16 v[116:117], v13 offset:8192
    ds_read_b64_tr_b16 v[118:119], v13 offset:10240
    s_waitcnt lgkmcnt(15)
    v_mfma_f32_16x16x32_bf16 v[224:227], v[120:123], v[80:83], v[224:227]
    v_mfma_f32_16x16x32_bf16 v[228:231], v[120:123], v[84:87], v[228:231]
    v_mfma_f32_16x16x32_bf16 v[232:235], v[120:123], v[88:91], v[232:235]
    v_mfma_f32_16x16x32_bf16 v[236:239], v[120:123], v[92:95], v[236:239]
    ds_read_b64_tr_b16 v[120:121], v14 offset:8192
    ds_read_b64_tr_b16 v[122:123], v14 offset:10240
    v_mfma_f32_16x16x32_bf16 v[240:243], v[124:127], v[80:83], v[240:243]
    v_mfma_f32_16x16x32_bf16 v[244:247], v[124:127], v[84:87], v[244:247]
    v_mfma_f32_16x16x32_bf16 v[248:251], v[124:127], v[88:91], v[248:251]
    v_mfma_f32_16x16x32_bf16 v[252:255], v[124:127], v[92:95], v[252:255]
    ds_read_b64_tr_b16 v[124:125], v15 offset:8192
    ds_read_b64_tr_b16 v[126:127], v15 offset:10240
    s_barrier
    s_waitcnt lgkmcnt(10)
    v_mfma_f32_16x16x32_bf16 v[128:131], v[96:99], v[64:67], v[128:131]
    v_mfma_f32_16x16x32_bf16 v[132:135], v[96:99], v[68:71], v[132:135]
    ds_read_b128 v[80:83], v9 offset:0
    v_mfma_f32_16x16x32_bf16 v[136:139], v[96:99], v[72:75], v[136:139]
    v_mfma_f32_16x16x32_bf16 v[140:143], v[96:99], v[76:79], v[140:143]
    ds_read_b64_tr_b16 v[96:97], v12 offset:16384
    ds_read_b64_tr_b16 v[98:99], v12 offset:18432
    v_mfma_f32_16x16x32_bf16 v[144:147], v[100:103], v[64:67], v[144:147]
    v_mfma_f32_16x16x32_bf16 v[148:151], v[100:103], v[68:71], v[148:151]
    ds_read_b128 v[84:87], v9 offset:2048
    v_mfma_f32_16x16x32_bf16 v[152:155], v[100:103], v[72:75], v[152:155]
    v_mfma_f32_16x16x32_bf16 v[156:159], v[100:103], v[76:79], v[156:159]
    ds_read_b64_tr_b16 v[100:101], v13 offset:16384
    ds_read_b64_tr_b16 v[102:103], v13 offset:18432
    s_waitcnt lgkmcnt(14)
    v_mfma_f32_16x16x32_bf16 v[160:163], v[104:107], v[64:67], v[160:163]
    v_mfma_f32_16x16x32_bf16 v[164:167], v[104:107], v[68:71], v[164:167]
    ds_read_b128 v[88:91], v9 offset:4096
    v_mfma_f32_16x16x32_bf16 v[168:171], v[104:107], v[72:75], v[168:171]
    v_mfma_f32_16x16x32_bf16 v[172:175], v[104:107], v[76:79], v[172:175]
    ds_read_b64_tr_b16 v[104:105], v14 offset:16384
    ds_read_b64_tr_b16 v[106:107], v14 offset:18432
    v_mfma_f32_16x16x32_bf16 v[176:179], v[108:111], v[64:67], v[176:179]
    v_mfma_f32_16x16x32_bf16 v[180:183], v[108:111], v[68:71], v[180:183]
    ds_read_b128 v[92:95], v9 offset:6144
    v_mfma_f32_16x16x32_bf16 v[184:187], v[108:111], v[72:75], v[184:187]
    v_mfma_f32_16x16x32_bf16 v[188:191], v[108:111], v[76:79], v[188:191]
    ds_read_b64_tr_b16 v[108:109], v15 offset:16384
    ds_read_b64_tr_b16 v[110:111], v15 offset:18432
    s_waitcnt lgkmcnt(15)
    v_mfma_f32_16x16x32_bf16 v[192:195], v[112:115], v[64:67], v[192:195]
    v_mfma_f32_16x16x32_bf16 v[196:199], v[112:115], v[68:71], v[196:199]
    v_mfma_f32_16x16x32_bf16 v[200:203], v[112:115], v[72:75], v[200:203]
    v_mfma_f32_16x16x32_bf16 v[204:207], v[112:115], v[76:79], v[204:207]
    ds_read_b64_tr_b16 v[112:113], v12 offset:24576
    ds_read_b64_tr_b16 v[114:115], v12 offset:26624
    v_mfma_f32_16x16x32_bf16 v[208:211], v[116:119], v[64:67], v[208:211]
    v_mfma_f32_16x16x32_bf16 v[212:215], v[116:119], v[68:71], v[212:215]
    v_mfma_f32_16x16x32_bf16 v[216:219], v[116:119], v[72:75], v[216:219]
    v_mfma_f32_16x16x32_bf16 v[220:223], v[116:119], v[76:79], v[220:223]
    ds_read_b64_tr_b16 v[116:117], v13 offset:24576
    ds_read_b64_tr_b16 v[118:119], v13 offset:26624
    s_waitcnt lgkmcnt(15)
    v_mfma_f32_16x16x32_bf16 v[224:227], v[120:123], v[64:67], v[224:227]
    v_mfma_f32_16x16x32_bf16 v[228:231], v[120:123], v[68:71], v[228:231]
    v_mfma_f32_16x16x32_bf16 v[232:235], v[120:123], v[72:75], v[232:235]
    v_mfma_f32_16x16x32_bf16 v[236:239], v[120:123], v[76:79], v[236:239]
    ds_read_b64_tr_b16 v[120:121], v14 offset:24576
    ds_read_b64_tr_b16 v[122:123], v14 offset:26624
    v_mfma_f32_16x16x32_bf16 v[240:243], v[124:127], v[64:67], v[240:243]
    v_mfma_f32_16x16x32_bf16 v[244:247], v[124:127], v[68:71], v[244:247]
    v_mfma_f32_16x16x32_bf16 v[248:251], v[124:127], v[72:75], v[248:251]
    v_mfma_f32_16x16x32_bf16 v[252:255], v[124:127], v[76:79], v[252:255]
    ds_read_b64_tr_b16 v[124:125], v15 offset:24576
    ds_read_b64_tr_b16 v[126:127], v15 offset:26624
    s_barrier
    s_waitcnt lgkmcnt(10)
    v_mfma_f32_16x16x32_bf16 v[128:131], v[96:99], v[80:83], v[128:131]
    v_mfma_f32_16x16x32_bf16 v[132:135], v[96:99], v[84:87], v[132:135]
    ds_read_b128 v[64:67], v8 offset:16384
    v_mfma_f32_16x16x32_bf16 v[136:139], v[96:99], v[88:91], v[136:139]
    v_mfma_f32_16x16x32_bf16 v[140:143], v[96:99], v[92:95], v[140:143]
    ds_read_b64_tr_b16 v[96:97], v12 offset:32768
    ds_read_b64_tr_b16 v[98:99], v12 offset:34816
    v_mfma_f32_16x16x32_bf16 v[144:147], v[100:103], v[80:83], v[144:147]
    v_mfma_f32_16x16x32_bf16 v[148:151], v[100:103], v[84:87], v[148:151]
    ds_read_b128 v[68:71], v8 offset:18432
    v_mfma_f32_16x16x32_bf16 v[152:155], v[100:103], v[88:91], v[152:155]
    v_mfma_f32_16x16x32_bf16 v[156:159], v[100:103], v[92:95], v[156:159]
    ds_read_b64_tr_b16 v[100:101], v13 offset:32768
    ds_read_b64_tr_b16 v[102:103], v13 offset:34816
    s_waitcnt lgkmcnt(14)
    v_mfma_f32_16x16x32_bf16 v[160:163], v[104:107], v[80:83], v[160:163]
    v_mfma_f32_16x16x32_bf16 v[164:167], v[104:107], v[84:87], v[164:167]
    ds_read_b128 v[72:75], v8 offset:20480
    v_mfma_f32_16x16x32_bf16 v[168:171], v[104:107], v[88:91], v[168:171]
    v_mfma_f32_16x16x32_bf16 v[172:175], v[104:107], v[92:95], v[172:175]
    ds_read_b64_tr_b16 v[104:105], v14 offset:32768
    ds_read_b64_tr_b16 v[106:107], v14 offset:34816
    v_mfma_f32_16x16x32_bf16 v[176:179], v[108:111], v[80:83], v[176:179]
    v_mfma_f32_16x16x32_bf16 v[180:183], v[108:111], v[84:87], v[180:183]
    ds_read_b128 v[76:79], v8 offset:22528
    v_mfma_f32_16x16x32_bf16 v[184:187], v[108:111], v[88:91], v[184:187]
    v_mfma_f32_16x16x32_bf16 v[188:191], v[108:111], v[92:95], v[188:191]
    ds_read_b64_tr_b16 v[108:109], v15 offset:32768
    ds_read_b64_tr_b16 v[110:111], v15 offset:34816
    s_waitcnt lgkmcnt(15)
    v_mfma_f32_16x16x32_bf16 v[192:195], v[112:115], v[80:83], v[192:195]
    v_mfma_f32_16x16x32_bf16 v[196:199], v[112:115], v[84:87], v[196:199]
    v_mfma_f32_16x16x32_bf16 v[200:203], v[112:115], v[88:91], v[200:203]
    v_mfma_f32_16x16x32_bf16 v[204:207], v[112:115], v[92:95], v[204:207]
    ds_read_b64_tr_b16 v[112:113], v12 offset:40960
    ds_read_b64_tr_b16 v[114:115], v12 offset:43008
    v_mfma_f32_16x16x32_bf16 v[208:211], v[116:119], v[80:83], v[208:211]
    v_mfma_f32_16x16x32_bf16 v[212:215], v[116:119], v[84:87], v[212:215]
    v_mfma_f32_16x16x32_bf16 v[216:219], v[116:119], v[88:91], v[216:219]
    v_mfma_f32_16x16x32_bf16 v[220:223], v[116:119], v[92:95], v[220:223]
    ds_read_b64_tr_b16 v[116:117], v13 offset:40960
    ds_read_b64_tr_b16 v[118:119], v13 offset:43008
    s_waitcnt lgkmcnt(15)
    v_mfma_f32_16x16x32_bf16 v[224:227], v[120:123], v[80:83], v[224:227]
    v_mfma_f32_16x16x32_bf16 v[228:231], v[120:123], v[84:87], v[228:231]
    v_mfma_f32_16x16x32_bf16 v[232:235], v[120:123], v[88:91], v[232:235]
    v_mfma_f32_16x16x32_bf16 v[236:239], v[120:123], v[92:95], v[236:239]
    ds_read_b64_tr_b16 v[120:121], v14 offset:40960
    ds_read_b64_tr_b16 v[122:123], v14 offset:43008
    v_mfma_f32_16x16x32_bf16 v[240:243], v[124:127], v[80:83], v[240:243]
    v_mfma_f32_16x16x32_bf16 v[244:247], v[124:127], v[84:87], v[244:247]
    v_mfma_f32_16x16x32_bf16 v[248:251], v[124:127], v[88:91], v[248:251]
    v_mfma_f32_16x16x32_bf16 v[252:255], v[124:127], v[92:95], v[252:255]
    ds_read_b64_tr_b16 v[124:125], v15 offset:40960
    ds_read_b64_tr_b16 v[126:127], v15 offset:43008
    s_barrier
    s_waitcnt lgkmcnt(10)
    v_mfma_f32_16x16x32_bf16 v[128:131], v[96:99], v[64:67], v[128:131]
    v_mfma_f32_16x16x32_bf16 v[132:135], v[96:99], v[68:71], v[132:135]
    ds_read_b128 v[80:83], v9 offset:16384
    v_mfma_f32_16x16x32_bf16 v[136:139], v[96:99], v[72:75], v[136:139]
    v_mfma_f32_16x16x32_bf16 v[140:143], v[96:99], v[76:79], v[140:143]
    ds_read_b64_tr_b16 v[96:97], v16 offset:0
    ds_read_b64_tr_b16 v[98:99], v16 offset:2048
    v_mfma_f32_16x16x32_bf16 v[144:147], v[100:103], v[64:67], v[144:147]
    v_mfma_f32_16x16x32_bf16 v[148:151], v[100:103], v[68:71], v[148:151]
    ds_read_b128 v[84:87], v9 offset:18432
    v_mfma_f32_16x16x32_bf16 v[152:155], v[100:103], v[72:75], v[152:155]
    v_mfma_f32_16x16x32_bf16 v[156:159], v[100:103], v[76:79], v[156:159]
    ds_read_b64_tr_b16 v[100:101], v17 offset:0
    ds_read_b64_tr_b16 v[102:103], v17 offset:2048
    s_waitcnt lgkmcnt(14)
    v_mfma_f32_16x16x32_bf16 v[160:163], v[104:107], v[64:67], v[160:163]
    v_mfma_f32_16x16x32_bf16 v[164:167], v[104:107], v[68:71], v[164:167]
    ds_read_b128 v[88:91], v9 offset:20480
    v_mfma_f32_16x16x32_bf16 v[168:171], v[104:107], v[72:75], v[168:171]
    v_mfma_f32_16x16x32_bf16 v[172:175], v[104:107], v[76:79], v[172:175]
    ds_read_b64_tr_b16 v[104:105], v18 offset:0
    ds_read_b64_tr_b16 v[106:107], v18 offset:2048
    v_mfma_f32_16x16x32_bf16 v[176:179], v[108:111], v[64:67], v[176:179]
    v_mfma_f32_16x16x32_bf16 v[180:183], v[108:111], v[68:71], v[180:183]
    ds_read_b128 v[92:95], v9 offset:22528
    v_mfma_f32_16x16x32_bf16 v[184:187], v[108:111], v[72:75], v[184:187]
    v_mfma_f32_16x16x32_bf16 v[188:191], v[108:111], v[76:79], v[188:191]
    ds_read_b64_tr_b16 v[108:109], v19 offset:0
    ds_read_b64_tr_b16 v[110:111], v19 offset:2048
    s_waitcnt lgkmcnt(15)
    v_mfma_f32_16x16x32_bf16 v[192:195], v[112:115], v[64:67], v[192:195]
    v_mfma_f32_16x16x32_bf16 v[196:199], v[112:115], v[68:71], v[196:199]
    v_mfma_f32_16x16x32_bf16 v[200:203], v[112:115], v[72:75], v[200:203]
    v_mfma_f32_16x16x32_bf16 v[204:207], v[112:115], v[76:79], v[204:207]
    ds_read_b64_tr_b16 v[112:113], v16 offset:8192
    ds_read_b64_tr_b16 v[114:115], v16 offset:10240
    v_mfma_f32_16x16x32_bf16 v[208:211], v[116:119], v[64:67], v[208:211]
    v_mfma_f32_16x16x32_bf16 v[212:215], v[116:119], v[68:71], v[212:215]
    v_mfma_f32_16x16x32_bf16 v[216:219], v[116:119], v[72:75], v[216:219]
    v_mfma_f32_16x16x32_bf16 v[220:223], v[116:119], v[76:79], v[220:223]
    ds_read_b64_tr_b16 v[116:117], v17 offset:8192
    ds_read_b64_tr_b16 v[118:119], v17 offset:10240
    s_waitcnt lgkmcnt(15)
    v_mfma_f32_16x16x32_bf16 v[224:227], v[120:123], v[64:67], v[224:227]
    v_mfma_f32_16x16x32_bf16 v[228:231], v[120:123], v[68:71], v[228:231]
    v_mfma_f32_16x16x32_bf16 v[232:235], v[120:123], v[72:75], v[232:235]
    v_mfma_f32_16x16x32_bf16 v[236:239], v[120:123], v[76:79], v[236:239]
    ds_read_b64_tr_b16 v[120:121], v18 offset:8192
    ds_read_b64_tr_b16 v[122:123], v18 offset:10240
    v_mfma_f32_16x16x32_bf16 v[240:243], v[124:127], v[64:67], v[240:243]
    v_mfma_f32_16x16x32_bf16 v[244:247], v[124:127], v[68:71], v[244:247]
    v_mfma_f32_16x16x32_bf16 v[248:251], v[124:127], v[72:75], v[248:251]
    v_mfma_f32_16x16x32_bf16 v[252:255], v[124:127], v[76:79], v[252:255]
    ds_read_b64_tr_b16 v[124:125], v19 offset:8192
    ds_read_b64_tr_b16 v[126:127], v19 offset:10240
    s_barrier
    s_waitcnt lgkmcnt(10)
    v_mfma_f32_16x16x32_bf16 v[128:131], v[96:99], v[80:83], v[128:131]
    v_mfma_f32_16x16x32_bf16 v[132:135], v[96:99], v[84:87], v[132:135]
    ds_read_b128 v[64:67], v8 offset:32768
    v_mfma_f32_16x16x32_bf16 v[136:139], v[96:99], v[88:91], v[136:139]
    v_mfma_f32_16x16x32_bf16 v[140:143], v[96:99], v[92:95], v[140:143]
    ds_read_b64_tr_b16 v[96:97], v16 offset:16384
    ds_read_b64_tr_b16 v[98:99], v16 offset:18432
    v_mfma_f32_16x16x32_bf16 v[144:147], v[100:103], v[80:83], v[144:147]
    v_mfma_f32_16x16x32_bf16 v[148:151], v[100:103], v[84:87], v[148:151]
    ds_read_b128 v[68:71], v8 offset:34816
    v_mfma_f32_16x16x32_bf16 v[152:155], v[100:103], v[88:91], v[152:155]
    v_mfma_f32_16x16x32_bf16 v[156:159], v[100:103], v[92:95], v[156:159]
    ds_read_b64_tr_b16 v[100:101], v17 offset:16384
    ds_read_b64_tr_b16 v[102:103], v17 offset:18432
    s_waitcnt lgkmcnt(14)
    v_mfma_f32_16x16x32_bf16 v[160:163], v[104:107], v[80:83], v[160:163]
    v_mfma_f32_16x16x32_bf16 v[164:167], v[104:107], v[84:87], v[164:167]
    ds_read_b128 v[72:75], v8 offset:36864
    v_mfma_f32_16x16x32_bf16 v[168:171], v[104:107], v[88:91], v[168:171]
    v_mfma_f32_16x16x32_bf16 v[172:175], v[104:107], v[92:95], v[172:175]
    ds_read_b64_tr_b16 v[104:105], v18 offset:16384
    ds_read_b64_tr_b16 v[106:107], v18 offset:18432
    v_mfma_f32_16x16x32_bf16 v[176:179], v[108:111], v[80:83], v[176:179]
    v_mfma_f32_16x16x32_bf16 v[180:183], v[108:111], v[84:87], v[180:183]
    ds_read_b128 v[76:79], v8 offset:38912
    v_mfma_f32_16x16x32_bf16 v[184:187], v[108:111], v[88:91], v[184:187]
    v_mfma_f32_16x16x32_bf16 v[188:191], v[108:111], v[92:95], v[188:191]
    ds_read_b64_tr_b16 v[108:109], v19 offset:16384
    ds_read_b64_tr_b16 v[110:111], v19 offset:18432
    s_waitcnt lgkmcnt(15)
    v_mfma_f32_16x16x32_bf16 v[192:195], v[112:115], v[80:83], v[192:195]
    v_mfma_f32_16x16x32_bf16 v[196:199], v[112:115], v[84:87], v[196:199]
    v_mfma_f32_16x16x32_bf16 v[200:203], v[112:115], v[88:91], v[200:203]
    v_mfma_f32_16x16x32_bf16 v[204:207], v[112:115], v[92:95], v[204:207]
    ds_read_b64_tr_b16 v[112:113], v16 offset:24576
    ds_read_b64_tr_b16 v[114:115], v16 offset:26624
    v_mfma_f32_16x16x32_bf16 v[208:211], v[116:119], v[80:83], v[208:211]
    v_mfma_f32_16x16x32_bf16 v[212:215], v[116:119], v[84:87], v[212:215]
    v_mfma_f32_16x16x32_bf16 v[216:219], v[116:119], v[88:91], v[216:219]
    v_mfma_f32_16x16x32_bf16 v[220:223], v[116:119], v[92:95], v[220:223]
    ds_read_b64_tr_b16 v[116:117], v17 offset:24576
    ds_read_b64_tr_b16 v[118:119], v17 offset:26624
    s_waitcnt lgkmcnt(15)
    v_mfma_f32_16x16x32_bf16 v[224:227], v[120:123], v[80:83], v[224:227]
    v_mfma_f32_16x16x32_bf16 v[228:231], v[120:123], v[84:87], v[228:231]
    v_mfma_f32_16x16x32_bf16 v[232:235], v[120:123], v[88:91], v[232:235]
    v_mfma_f32_16x16x32_bf16 v[236:239], v[120:123], v[92:95], v[236:239]
    ds_read_b64_tr_b16 v[120:121], v18 offset:24576
    ds_read_b64_tr_b16 v[122:123], v18 offset:26624
    v_mfma_f32_16x16x32_bf16 v[240:243], v[124:127], v[80:83], v[240:243]
    v_mfma_f32_16x16x32_bf16 v[244:247], v[124:127], v[84:87], v[244:247]
    v_mfma_f32_16x16x32_bf16 v[248:251], v[124:127], v[88:91], v[248:251]
    v_mfma_f32_16x16x32_bf16 v[252:255], v[124:127], v[92:95], v[252:255]
    ds_read_b64_tr_b16 v[124:125], v19 offset:24576
    ds_read_b64_tr_b16 v[126:127], v19 offset:26624
    s_barrier
    s_waitcnt lgkmcnt(10)
    v_mfma_f32_16x16x32_bf16 v[128:131], v[96:99], v[64:67], v[128:131]
    v_mfma_f32_16x16x32_bf16 v[132:135], v[96:99], v[68:71], v[132:135]
    ds_read_b128 v[80:83], v9 offset:32768
    v_mfma_f32_16x16x32_bf16 v[136:139], v[96:99], v[72:75], v[136:139]
    v_mfma_f32_16x16x32_bf16 v[140:143], v[96:99], v[76:79], v[140:143]
    ds_read_b64_tr_b16 v[96:97], v12 offset:0
    ds_read_b64_tr_b16 v[98:99], v12 offset:2048
    v_mfma_f32_16x16x32_bf16 v[144:147], v[100:103], v[64:67], v[144:147]
    v_mfma_f32_16x16x32_bf16 v[148:151], v[100:103], v[68:71], v[148:151]
    ds_read_b128 v[84:87], v9 offset:34816
    v_mfma_f32_16x16x32_bf16 v[152:155], v[100:103], v[72:75], v[152:155]
    v_mfma_f32_16x16x32_bf16 v[156:159], v[100:103], v[76:79], v[156:159]
    ds_read_b64_tr_b16 v[100:101], v13 offset:0
    ds_read_b64_tr_b16 v[102:103], v13 offset:2048
    s_waitcnt lgkmcnt(14)
    v_mfma_f32_16x16x32_bf16 v[160:163], v[104:107], v[64:67], v[160:163]
    v_mfma_f32_16x16x32_bf16 v[164:167], v[104:107], v[68:71], v[164:167]
    ds_read_b128 v[88:91], v9 offset:36864
    v_mfma_f32_16x16x32_bf16 v[168:171], v[104:107], v[72:75], v[168:171]
    v_mfma_f32_16x16x32_bf16 v[172:175], v[104:107], v[76:79], v[172:175]
    ds_read_b64_tr_b16 v[104:105], v14 offset:0
    ds_read_b64_tr_b16 v[106:107], v14 offset:2048
    v_mfma_f32_16x16x32_bf16 v[176:179], v[108:111], v[64:67], v[176:179]
    v_mfma_f32_16x16x32_bf16 v[180:183], v[108:111], v[68:71], v[180:183]
    ds_read_b128 v[92:95], v9 offset:38912
    v_mfma_f32_16x16x32_bf16 v[184:187], v[108:111], v[72:75], v[184:187]
    v_mfma_f32_16x16x32_bf16 v[188:191], v[108:111], v[76:79], v[188:191]
    ds_read_b64_tr_b16 v[108:109], v15 offset:0
    ds_read_b64_tr_b16 v[110:111], v15 offset:2048
    s_waitcnt lgkmcnt(15)
    v_mfma_f32_16x16x32_bf16 v[192:195], v[112:115], v[64:67], v[192:195]
    v_mfma_f32_16x16x32_bf16 v[196:199], v[112:115], v[68:71], v[196:199]
    v_mfma_f32_16x16x32_bf16 v[200:203], v[112:115], v[72:75], v[200:203]
    v_mfma_f32_16x16x32_bf16 v[204:207], v[112:115], v[76:79], v[204:207]
    ds_read_b64_tr_b16 v[112:113], v12 offset:8192
    ds_read_b64_tr_b16 v[114:115], v12 offset:10240
    v_mfma_f32_16x16x32_bf16 v[208:211], v[116:119], v[64:67], v[208:211]
    v_mfma_f32_16x16x32_bf16 v[212:215], v[116:119], v[68:71], v[212:215]
    v_mfma_f32_16x16x32_bf16 v[216:219], v[116:119], v[72:75], v[216:219]
    v_mfma_f32_16x16x32_bf16 v[220:223], v[116:119], v[76:79], v[220:223]
    ds_read_b64_tr_b16 v[116:117], v13 offset:8192
    ds_read_b64_tr_b16 v[118:119], v13 offset:10240
    s_waitcnt lgkmcnt(15)
    v_mfma_f32_16x16x32_bf16 v[224:227], v[120:123], v[64:67], v[224:227]
    v_mfma_f32_16x16x32_bf16 v[228:231], v[120:123], v[68:71], v[228:231]
    v_mfma_f32_16x16x32_bf16 v[232:235], v[120:123], v[72:75], v[232:235]
    v_mfma_f32_16x16x32_bf16 v[236:239], v[120:123], v[76:79], v[236:239]
    ds_read_b64_tr_b16 v[120:121], v14 offset:8192
    ds_read_b64_tr_b16 v[122:123], v14 offset:10240
    v_mfma_f32_16x16x32_bf16 v[240:243], v[124:127], v[64:67], v[240:243]
    v_mfma_f32_16x16x32_bf16 v[244:247], v[124:127], v[68:71], v[244:247]
    v_mfma_f32_16x16x32_bf16 v[248:251], v[124:127], v[72:75], v[248:251]
    v_mfma_f32_16x16x32_bf16 v[252:255], v[124:127], v[76:79], v[252:255]
    ds_read_b64_tr_b16 v[124:125], v15 offset:8192
    ds_read_b64_tr_b16 v[126:127], v15 offset:10240
    s_barrier
    s_waitcnt lgkmcnt(10)
    v_mfma_f32_16x16x32_bf16 v[128:131], v[96:99], v[80:83], v[128:131]
    v_mfma_f32_16x16x32_bf16 v[132:135], v[96:99], v[84:87], v[132:135]
    ds_read_b128 v[64:67], v8 offset:49152
    v_mfma_f32_16x16x32_bf16 v[136:139], v[96:99], v[88:91], v[136:139]
    v_mfma_f32_16x16x32_bf16 v[140:143], v[96:99], v[92:95], v[140:143]
    ds_read_b64_tr_b16 v[96:97], v12 offset:16384
    ds_read_b64_tr_b16 v[98:99], v12 offset:18432
    v_mfma_f32_16x16x32_bf16 v[144:147], v[100:103], v[80:83], v[144:147]
    v_mfma_f32_16x16x32_bf16 v[148:151], v[100:103], v[84:87], v[148:151]
    ds_read_b128 v[68:71], v8 offset:51200
    v_mfma_f32_16x16x32_bf16 v[152:155], v[100:103], v[88:91], v[152:155]
    v_mfma_f32_16x16x32_bf16 v[156:159], v[100:103], v[92:95], v[156:159]
    ds_read_b64_tr_b16 v[100:101], v13 offset:16384
    ds_read_b64_tr_b16 v[102:103], v13 offset:18432
    s_waitcnt lgkmcnt(14)
    v_mfma_f32_16x16x32_bf16 v[160:163], v[104:107], v[80:83], v[160:163]
    v_mfma_f32_16x16x32_bf16 v[164:167], v[104:107], v[84:87], v[164:167]
    ds_read_b128 v[72:75], v8 offset:53248
    v_mfma_f32_16x16x32_bf16 v[168:171], v[104:107], v[88:91], v[168:171]
    v_mfma_f32_16x16x32_bf16 v[172:175], v[104:107], v[92:95], v[172:175]
    ds_read_b64_tr_b16 v[104:105], v14 offset:16384
    ds_read_b64_tr_b16 v[106:107], v14 offset:18432
    v_mfma_f32_16x16x32_bf16 v[176:179], v[108:111], v[80:83], v[176:179]
    v_mfma_f32_16x16x32_bf16 v[180:183], v[108:111], v[84:87], v[180:183]
    ds_read_b128 v[76:79], v8 offset:55296
    v_mfma_f32_16x16x32_bf16 v[184:187], v[108:111], v[88:91], v[184:187]
    v_mfma_f32_16x16x32_bf16 v[188:191], v[108:111], v[92:95], v[188:191]
    ds_read_b64_tr_b16 v[108:109], v15 offset:16384
    ds_read_b64_tr_b16 v[110:111], v15 offset:18432
    s_waitcnt lgkmcnt(15)
    v_mfma_f32_16x16x32_bf16 v[192:195], v[112:115], v[80:83], v[192:195]
    v_mfma_f32_16x16x32_bf16 v[196:199], v[112:115], v[84:87], v[196:199]
    v_mfma_f32_16x16x32_bf16 v[200:203], v[112:115], v[88:91], v[200:203]
    v_mfma_f32_16x16x32_bf16 v[204:207], v[112:115], v[92:95], v[204:207]
    ds_read_b64_tr_b16 v[112:113], v12 offset:24576
    ds_read_b64_tr_b16 v[114:115], v12 offset:26624
    v_mfma_f32_16x16x32_bf16 v[208:211], v[116:119], v[80:83], v[208:211]
    v_mfma_f32_16x16x32_bf16 v[212:215], v[116:119], v[84:87], v[212:215]
    v_mfma_f32_16x16x32_bf16 v[216:219], v[116:119], v[88:91], v[216:219]
    v_mfma_f32_16x16x32_bf16 v[220:223], v[116:119], v[92:95], v[220:223]
    ds_read_b64_tr_b16 v[116:117], v13 offset:24576
    ds_read_b64_tr_b16 v[118:119], v13 offset:26624
    s_waitcnt lgkmcnt(15)
    v_mfma_f32_16x16x32_bf16 v[224:227], v[120:123], v[80:83], v[224:227]
    v_mfma_f32_16x16x32_bf16 v[228:231], v[120:123], v[84:87], v[228:231]
    v_mfma_f32_16x16x32_bf16 v[232:235], v[120:123], v[88:91], v[232:235]
    v_mfma_f32_16x16x32_bf16 v[236:239], v[120:123], v[92:95], v[236:239]
    ds_read_b64_tr_b16 v[120:121], v14 offset:24576
    ds_read_b64_tr_b16 v[122:123], v14 offset:26624
    v_mfma_f32_16x16x32_bf16 v[240:243], v[124:127], v[80:83], v[240:243]
    v_mfma_f32_16x16x32_bf16 v[244:247], v[124:127], v[84:87], v[244:247]
    v_mfma_f32_16x16x32_bf16 v[248:251], v[124:127], v[88:91], v[248:251]
    v_mfma_f32_16x16x32_bf16 v[252:255], v[124:127], v[92:95], v[252:255]
    ds_read_b64_tr_b16 v[124:125], v15 offset:24576
    ds_read_b64_tr_b16 v[126:127], v15 offset:26624
    s_barrier
    s_waitcnt lgkmcnt(10)
    v_mfma_f32_16x16x32_bf16 v[128:131], v[96:99], v[64:67], v[128:131]
    v_mfma_f32_16x16x32_bf16 v[132:135], v[96:99], v[68:71], v[132:135]
    ds_read_b128 v[80:83], v9 offset:49152
    v_mfma_f32_16x16x32_bf16 v[136:139], v[96:99], v[72:75], v[136:139]
    v_mfma_f32_16x16x32_bf16 v[140:143], v[96:99], v[76:79], v[140:143]
    ds_read_b64_tr_b16 v[96:97], v12 offset:32768
    ds_read_b64_tr_b16 v[98:99], v12 offset:34816
    v_mfma_f32_16x16x32_bf16 v[144:147], v[100:103], v[64:67], v[144:147]
    v_mfma_f32_16x16x32_bf16 v[148:151], v[100:103], v[68:71], v[148:151]
    ds_read_b128 v[84:87], v9 offset:51200
    v_mfma_f32_16x16x32_bf16 v[152:155], v[100:103], v[72:75], v[152:155]
    v_mfma_f32_16x16x32_bf16 v[156:159], v[100:103], v[76:79], v[156:159]
    ds_read_b64_tr_b16 v[100:101], v13 offset:32768
    ds_read_b64_tr_b16 v[102:103], v13 offset:34816
    s_waitcnt lgkmcnt(14)
    v_mfma_f32_16x16x32_bf16 v[160:163], v[104:107], v[64:67], v[160:163]
    v_mfma_f32_16x16x32_bf16 v[164:167], v[104:107], v[68:71], v[164:167]
    ds_read_b128 v[88:91], v9 offset:53248
    v_mfma_f32_16x16x32_bf16 v[168:171], v[104:107], v[72:75], v[168:171]
    v_mfma_f32_16x16x32_bf16 v[172:175], v[104:107], v[76:79], v[172:175]
    ds_read_b64_tr_b16 v[104:105], v14 offset:32768
    ds_read_b64_tr_b16 v[106:107], v14 offset:34816
    v_mfma_f32_16x16x32_bf16 v[176:179], v[108:111], v[64:67], v[176:179]
    v_mfma_f32_16x16x32_bf16 v[180:183], v[108:111], v[68:71], v[180:183]
    ds_read_b128 v[92:95], v9 offset:55296
    v_mfma_f32_16x16x32_bf16 v[184:187], v[108:111], v[72:75], v[184:187]
    v_mfma_f32_16x16x32_bf16 v[188:191], v[108:111], v[76:79], v[188:191]
    ds_read_b64_tr_b16 v[108:109], v15 offset:32768
    ds_read_b64_tr_b16 v[110:111], v15 offset:34816
    s_waitcnt lgkmcnt(15)
    v_mfma_f32_16x16x32_bf16 v[192:195], v[112:115], v[64:67], v[192:195]
    v_mfma_f32_16x16x32_bf16 v[196:199], v[112:115], v[68:71], v[196:199]
    v_mfma_f32_16x16x32_bf16 v[200:203], v[112:115], v[72:75], v[200:203]
    v_mfma_f32_16x16x32_bf16 v[204:207], v[112:115], v[76:79], v[204:207]
    ds_read_b64_tr_b16 v[112:113], v12 offset:40960
    ds_read_b64_tr_b16 v[114:115], v12 offset:43008
    v_mfma_f32_16x16x32_bf16 v[208:211], v[116:119], v[64:67], v[208:211]
    v_mfma_f32_16x16x32_bf16 v[212:215], v[116:119], v[68:71], v[212:215]
    v_mfma_f32_16x16x32_bf16 v[216:219], v[116:119], v[72:75], v[216:219]
    v_mfma_f32_16x16x32_bf16 v[220:223], v[116:119], v[76:79], v[220:223]
    ds_read_b64_tr_b16 v[116:117], v13 offset:40960
    ds_read_b64_tr_b16 v[118:119], v13 offset:43008
    s_waitcnt lgkmcnt(15)
    v_mfma_f32_16x16x32_bf16 v[224:227], v[120:123], v[64:67], v[224:227]
    v_mfma_f32_16x16x32_bf16 v[228:231], v[120:123], v[68:71], v[228:231]
    v_mfma_f32_16x16x32_bf16 v[232:235], v[120:123], v[72:75], v[232:235]
    v_mfma_f32_16x16x32_bf16 v[236:239], v[120:123], v[76:79], v[236:239]
    ds_read_b64_tr_b16 v[120:121], v14 offset:40960
    ds_read_b64_tr_b16 v[122:123], v14 offset:43008
    v_mfma_f32_16x16x32_bf16 v[240:243], v[124:127], v[64:67], v[240:243]
    v_mfma_f32_16x16x32_bf16 v[244:247], v[124:127], v[68:71], v[244:247]
    v_mfma_f32_16x16x32_bf16 v[248:251], v[124:127], v[72:75], v[248:251]
    v_mfma_f32_16x16x32_bf16 v[252:255], v[124:127], v[76:79], v[252:255]
    ds_read_b64_tr_b16 v[124:125], v15 offset:40960
    ds_read_b64_tr_b16 v[126:127], v15 offset:43008
    s_barrier
    s_waitcnt lgkmcnt(10)
    v_mfma_f32_16x16x32_bf16 v[128:131], v[96:99], v[80:83], v[128:131]
    v_mfma_f32_16x16x32_bf16 v[132:135], v[96:99], v[84:87], v[132:135]
    ds_read_b128 v[64:67], v8 offset:0
    v_mfma_f32_16x16x32_bf16 v[136:139], v[96:99], v[88:91], v[136:139]
    v_mfma_f32_16x16x32_bf16 v[140:143], v[96:99], v[92:95], v[140:143]
    ds_read_b64_tr_b16 v[96:97], v16 offset:0
    ds_read_b64_tr_b16 v[98:99], v16 offset:2048
    v_mfma_f32_16x16x32_bf16 v[144:147], v[100:103], v[80:83], v[144:147]
    v_mfma_f32_16x16x32_bf16 v[148:151], v[100:103], v[84:87], v[148:151]
    ds_read_b128 v[68:71], v8 offset:2048
    v_mfma_f32_16x16x32_bf16 v[152:155], v[100:103], v[88:91], v[152:155]
    v_mfma_f32_16x16x32_bf16 v[156:159], v[100:103], v[92:95], v[156:159]
    ds_read_b64_tr_b16 v[100:101], v17 offset:0
    ds_read_b64_tr_b16 v[102:103], v17 offset:2048
    s_waitcnt lgkmcnt(14)
    v_mfma_f32_16x16x32_bf16 v[160:163], v[104:107], v[80:83], v[160:163]
    v_mfma_f32_16x16x32_bf16 v[164:167], v[104:107], v[84:87], v[164:167]
    ds_read_b128 v[72:75], v8 offset:4096
    v_mfma_f32_16x16x32_bf16 v[168:171], v[104:107], v[88:91], v[168:171]
    v_mfma_f32_16x16x32_bf16 v[172:175], v[104:107], v[92:95], v[172:175]
    ds_read_b64_tr_b16 v[104:105], v18 offset:0
    ds_read_b64_tr_b16 v[106:107], v18 offset:2048
    v_mfma_f32_16x16x32_bf16 v[176:179], v[108:111], v[80:83], v[176:179]
    v_mfma_f32_16x16x32_bf16 v[180:183], v[108:111], v[84:87], v[180:183]
    ds_read_b128 v[76:79], v8 offset:6144
    v_mfma_f32_16x16x32_bf16 v[184:187], v[108:111], v[88:91], v[184:187]
    v_mfma_f32_16x16x32_bf16 v[188:191], v[108:111], v[92:95], v[188:191]
    ds_read_b64_tr_b16 v[108:109], v19 offset:0
    ds_read_b64_tr_b16 v[110:111], v19 offset:2048
    s_waitcnt lgkmcnt(15)
    v_mfma_f32_16x16x32_bf16 v[192:195], v[112:115], v[80:83], v[192:195]
    v_mfma_f32_16x16x32_bf16 v[196:199], v[112:115], v[84:87], v[196:199]
    v_mfma_f32_16x16x32_bf16 v[200:203], v[112:115], v[88:91], v[200:203]
    v_mfma_f32_16x16x32_bf16 v[204:207], v[112:115], v[92:95], v[204:207]
    ds_read_b64_tr_b16 v[112:113], v16 offset:8192
    ds_read_b64_tr_b16 v[114:115], v16 offset:10240
    v_mfma_f32_16x16x32_bf16 v[208:211], v[116:119], v[80:83], v[208:211]
    v_mfma_f32_16x16x32_bf16 v[212:215], v[116:119], v[84:87], v[212:215]
    v_mfma_f32_16x16x32_bf16 v[216:219], v[116:119], v[88:91], v[216:219]
    v_mfma_f32_16x16x32_bf16 v[220:223], v[116:119], v[92:95], v[220:223]
    ds_read_b64_tr_b16 v[116:117], v17 offset:8192
    ds_read_b64_tr_b16 v[118:119], v17 offset:10240
    s_waitcnt lgkmcnt(15)
    v_mfma_f32_16x16x32_bf16 v[224:227], v[120:123], v[80:83], v[224:227]
    v_mfma_f32_16x16x32_bf16 v[228:231], v[120:123], v[84:87], v[228:231]
    v_mfma_f32_16x16x32_bf16 v[232:235], v[120:123], v[88:91], v[232:235]
    v_mfma_f32_16x16x32_bf16 v[236:239], v[120:123], v[92:95], v[236:239]
    ds_read_b64_tr_b16 v[120:121], v18 offset:8192
    ds_read_b64_tr_b16 v[122:123], v18 offset:10240
    v_mfma_f32_16x16x32_bf16 v[240:243], v[124:127], v[80:83], v[240:243]
    v_mfma_f32_16x16x32_bf16 v[244:247], v[124:127], v[84:87], v[244:247]
    v_mfma_f32_16x16x32_bf16 v[248:251], v[124:127], v[88:91], v[248:251]
    v_mfma_f32_16x16x32_bf16 v[252:255], v[124:127], v[92:95], v[252:255]
    ds_read_b64_tr_b16 v[124:125], v19 offset:8192
    ds_read_b64_tr_b16 v[126:127], v19 offset:10240
    s_barrier
    s_waitcnt lgkmcnt(10)
    v_mfma_f32_16x16x32_bf16 v[128:131], v[96:99], v[64:67], v[128:131]
    v_mfma_f32_16x16x32_bf16 v[132:135], v[96:99], v[68:71], v[132:135]
    ds_read_b128 v[80:83], v9 offset:0
    v_mfma_f32_16x16x32_bf16 v[136:139], v[96:99], v[72:75], v[136:139]
    v_mfma_f32_16x16x32_bf16 v[140:143], v[96:99], v[76:79], v[140:143]
    ds_read_b64_tr_b16 v[96:97], v16 offset:16384
    ds_read_b64_tr_b16 v[98:99], v16 offset:18432
    v_mfma_f32_16x16x32_bf16 v[144:147], v[100:103], v[64:67], v[144:147]
    v_mfma_f32_16x16x32_bf16 v[148:151], v[100:103], v[68:71], v[148:151]
    ds_read_b128 v[84:87], v9 offset:2048
    v_mfma_f32_16x16x32_bf16 v[152:155], v[100:103], v[72:75], v[152:155]
    v_mfma_f32_16x16x32_bf16 v[156:159], v[100:103], v[76:79], v[156:159]
    ds_read_b64_tr_b16 v[100:101], v17 offset:16384
    ds_read_b64_tr_b16 v[102:103], v17 offset:18432
    s_waitcnt lgkmcnt(14)
    v_mfma_f32_16x16x32_bf16 v[160:163], v[104:107], v[64:67], v[160:163]
    v_mfma_f32_16x16x32_bf16 v[164:167], v[104:107], v[68:71], v[164:167]
    ds_read_b128 v[88:91], v9 offset:4096
    v_mfma_f32_16x16x32_bf16 v[168:171], v[104:107], v[72:75], v[168:171]
    v_mfma_f32_16x16x32_bf16 v[172:175], v[104:107], v[76:79], v[172:175]
    ds_read_b64_tr_b16 v[104:105], v18 offset:16384
    ds_read_b64_tr_b16 v[106:107], v18 offset:18432
    v_mfma_f32_16x16x32_bf16 v[176:179], v[108:111], v[64:67], v[176:179]
    v_mfma_f32_16x16x32_bf16 v[180:183], v[108:111], v[68:71], v[180:183]
    ds_read_b128 v[92:95], v9 offset:6144
    v_mfma_f32_16x16x32_bf16 v[184:187], v[108:111], v[72:75], v[184:187]
    v_mfma_f32_16x16x32_bf16 v[188:191], v[108:111], v[76:79], v[188:191]
    ds_read_b64_tr_b16 v[108:109], v19 offset:16384
    ds_read_b64_tr_b16 v[110:111], v19 offset:18432
    s_waitcnt lgkmcnt(15)
    v_mfma_f32_16x16x32_bf16 v[192:195], v[112:115], v[64:67], v[192:195]
    v_mfma_f32_16x16x32_bf16 v[196:199], v[112:115], v[68:71], v[196:199]
    v_mfma_f32_16x16x32_bf16 v[200:203], v[112:115], v[72:75], v[200:203]
    v_mfma_f32_16x16x32_bf16 v[204:207], v[112:115], v[76:79], v[204:207]
    ds_read_b64_tr_b16 v[112:113], v16 offset:24576
    ds_read_b64_tr_b16 v[114:115], v16 offset:26624
    v_mfma_f32_16x16x32_bf16 v[208:211], v[116:119], v[64:67], v[208:211]
    v_mfma_f32_16x16x32_bf16 v[212:215], v[116:119], v[68:71], v[212:215]
    v_mfma_f32_16x16x32_bf16 v[216:219], v[116:119], v[72:75], v[216:219]
    v_mfma_f32_16x16x32_bf16 v[220:223], v[116:119], v[76:79], v[220:223]
    ds_read_b64_tr_b16 v[116:117], v17 offset:24576
    ds_read_b64_tr_b16 v[118:119], v17 offset:26624
    s_waitcnt lgkmcnt(15)
    v_mfma_f32_16x16x32_bf16 v[224:227], v[120:123], v[64:67], v[224:227]
    v_mfma_f32_16x16x32_bf16 v[228:231], v[120:123], v[68:71], v[228:231]
    v_mfma_f32_16x16x32_bf16 v[232:235], v[120:123], v[72:75], v[232:235]
    v_mfma_f32_16x16x32_bf16 v[236:239], v[120:123], v[76:79], v[236:239]
    ds_read_b64_tr_b16 v[120:121], v18 offset:24576
    ds_read_b64_tr_b16 v[122:123], v18 offset:26624
    v_mfma_f32_16x16x32_bf16 v[240:243], v[124:127], v[64:67], v[240:243]
    v_mfma_f32_16x16x32_bf16 v[244:247], v[124:127], v[68:71], v[244:247]
    v_mfma_f32_16x16x32_bf16 v[248:251], v[124:127], v[72:75], v[248:251]
    v_mfma_f32_16x16x32_bf16 v[252:255], v[124:127], v[76:79], v[252:255]
    ds_read_b64_tr_b16 v[124:125], v19 offset:24576
    ds_read_b64_tr_b16 v[126:127], v19 offset:26624
    s_barrier
    s_waitcnt lgkmcnt(10)
    v_mfma_f32_16x16x32_bf16 v[128:131], v[96:99], v[80:83], v[128:131]
    v_mfma_f32_16x16x32_bf16 v[132:135], v[96:99], v[84:87], v[132:135]
    ds_read_b128 v[64:67], v8 offset:16384
    v_mfma_f32_16x16x32_bf16 v[136:139], v[96:99], v[88:91], v[136:139]
    v_mfma_f32_16x16x32_bf16 v[140:143], v[96:99], v[92:95], v[140:143]
    ds_read_b64_tr_b16 v[96:97], v12 offset:0
    ds_read_b64_tr_b16 v[98:99], v12 offset:2048
    v_mfma_f32_16x16x32_bf16 v[144:147], v[100:103], v[80:83], v[144:147]
    v_mfma_f32_16x16x32_bf16 v[148:151], v[100:103], v[84:87], v[148:151]
    ds_read_b128 v[68:71], v8 offset:18432
    v_mfma_f32_16x16x32_bf16 v[152:155], v[100:103], v[88:91], v[152:155]
    v_mfma_f32_16x16x32_bf16 v[156:159], v[100:103], v[92:95], v[156:159]
    ds_read_b64_tr_b16 v[100:101], v13 offset:0
    ds_read_b64_tr_b16 v[102:103], v13 offset:2048
    s_waitcnt lgkmcnt(14)
    v_mfma_f32_16x16x32_bf16 v[160:163], v[104:107], v[80:83], v[160:163]
    v_mfma_f32_16x16x32_bf16 v[164:167], v[104:107], v[84:87], v[164:167]
    ds_read_b128 v[72:75], v8 offset:20480
    v_mfma_f32_16x16x32_bf16 v[168:171], v[104:107], v[88:91], v[168:171]
    v_mfma_f32_16x16x32_bf16 v[172:175], v[104:107], v[92:95], v[172:175]
    ds_read_b64_tr_b16 v[104:105], v14 offset:0
    ds_read_b64_tr_b16 v[106:107], v14 offset:2048
    v_mfma_f32_16x16x32_bf16 v[176:179], v[108:111], v[80:83], v[176:179]
    v_mfma_f32_16x16x32_bf16 v[180:183], v[108:111], v[84:87], v[180:183]
    ds_read_b128 v[76:79], v8 offset:22528
    v_mfma_f32_16x16x32_bf16 v[184:187], v[108:111], v[88:91], v[184:187]
    v_mfma_f32_16x16x32_bf16 v[188:191], v[108:111], v[92:95], v[188:191]
    ds_read_b64_tr_b16 v[108:109], v15 offset:0
    ds_read_b64_tr_b16 v[110:111], v15 offset:2048
    s_waitcnt lgkmcnt(15)
    v_mfma_f32_16x16x32_bf16 v[192:195], v[112:115], v[80:83], v[192:195]
    v_mfma_f32_16x16x32_bf16 v[196:199], v[112:115], v[84:87], v[196:199]
    v_mfma_f32_16x16x32_bf16 v[200:203], v[112:115], v[88:91], v[200:203]
    v_mfma_f32_16x16x32_bf16 v[204:207], v[112:115], v[92:95], v[204:207]
    ds_read_b64_tr_b16 v[112:113], v12 offset:8192
    ds_read_b64_tr_b16 v[114:115], v12 offset:10240
    v_and_b32 v6, 0xf0, v2
    s_lshl_b32 s27, s56, 10
    s_add_u32 s27, s27, 147456
    v_add_u32 v6, s27, v6
    v_mov_b32 v7, 147456
    ds_read_b128 v[24:27], v6 offset:2048
    ds_read_b128 v[28:31], v6 offset:2304
    ds_read_b128 v[32:35], v6 offset:2560
    ds_read_b128 v[36:39], v6 offset:2816
    ds_read_b64 v[10:11], v7 offset:8200
    v_mfma_f32_16x16x32_bf16 v[208:211], v[116:119], v[80:83], v[208:211]
    v_mfma_f32_16x16x32_bf16 v[212:215], v[116:119], v[84:87], v[212:215]
    v_mfma_f32_16x16x32_bf16 v[216:219], v[116:119], v[88:91], v[216:219]
    v_mfma_f32_16x16x32_bf16 v[220:223], v[116:119], v[92:95], v[220:223]
    ds_read_b64_tr_b16 v[116:117], v13 offset:8192
    ds_read_b64_tr_b16 v[118:119], v13 offset:10240
    s_waitcnt lgkmcnt(15)
    v_mfma_f32_16x16x32_bf16 v[224:227], v[120:123], v[80:83], v[224:227]
    v_mfma_f32_16x16x32_bf16 v[228:231], v[120:123], v[84:87], v[228:231]
    v_mfma_f32_16x16x32_bf16 v[232:235], v[120:123], v[88:91], v[232:235]
    v_mfma_f32_16x16x32_bf16 v[236:239], v[120:123], v[92:95], v[236:239]
    ds_read_b64_tr_b16 v[120:121], v14 offset:8192
    ds_read_b64_tr_b16 v[122:123], v14 offset:10240
    v_mfma_f32_16x16x32_bf16 v[240:243], v[124:127], v[80:83], v[240:243]
    v_mfma_f32_16x16x32_bf16 v[244:247], v[124:127], v[84:87], v[244:247]
    v_mfma_f32_16x16x32_bf16 v[248:251], v[124:127], v[88:91], v[248:251]
    v_mfma_f32_16x16x32_bf16 v[252:255], v[124:127], v[92:95], v[252:255]
    ds_read_b64_tr_b16 v[124:125], v15 offset:8192
    ds_read_b64_tr_b16 v[126:127], v15 offset:10240
    s_barrier
    s_waitcnt lgkmcnt(15)
    v_mfma_f32_16x16x32_bf16 v[128:131], v[96:99], v[64:67], v[128:131]
    v_mfma_f32_16x16x32_bf16 v[132:135], v[96:99], v[68:71], v[132:135]
    ds_read_b128 v[80:83], v9 offset:16384
    v_mfma_f32_16x16x32_bf16 v[136:139], v[96:99], v[72:75], v[136:139]
    v_mfma_f32_16x16x32_bf16 v[140:143], v[96:99], v[76:79], v[140:143]
    ds_read_b64_tr_b16 v[96:97], v12 offset:16384
    ds_read_b64_tr_b16 v[98:99], v12 offset:18432
    v_mfma_f32_16x16x32_bf16 v[144:147], v[100:103], v[64:67], v[144:147]
    v_mfma_f32_16x16x32_bf16 v[148:151], v[100:103], v[68:71], v[148:151]
    ds_read_b128 v[84:87], v9 offset:18432
    v_mfma_f32_16x16x32_bf16 v[152:155], v[100:103], v[72:75], v[152:155]
    v_mfma_f32_16x16x32_bf16 v[156:159], v[100:103], v[76:79], v[156:159]
    ds_read_b64_tr_b16 v[100:101], v13 offset:16384
    ds_read_b64_tr_b16 v[102:103], v13 offset:18432
    s_waitcnt lgkmcnt(15)
    v_mfma_f32_16x16x32_bf16 v[160:163], v[104:107], v[64:67], v[160:163]
    v_mfma_f32_16x16x32_bf16 v[164:167], v[104:107], v[68:71], v[164:167]
    ds_read_b128 v[88:91], v9 offset:20480
    v_mfma_f32_16x16x32_bf16 v[168:171], v[104:107], v[72:75], v[168:171]
    v_mfma_f32_16x16x32_bf16 v[172:175], v[104:107], v[76:79], v[172:175]
    ds_read_b64_tr_b16 v[104:105], v14 offset:16384
    ds_read_b64_tr_b16 v[106:107], v14 offset:18432
    v_mfma_f32_16x16x32_bf16 v[176:179], v[108:111], v[64:67], v[176:179]
    v_mfma_f32_16x16x32_bf16 v[180:183], v[108:111], v[68:71], v[180:183]
    ds_read_b128 v[92:95], v9 offset:22528
    v_mfma_f32_16x16x32_bf16 v[184:187], v[108:111], v[72:75], v[184:187]
    v_mfma_f32_16x16x32_bf16 v[188:191], v[108:111], v[76:79], v[188:191]
    ds_read_b64_tr_b16 v[108:109], v15 offset:16384
    ds_read_b64_tr_b16 v[110:111], v15 offset:18432
    s_waitcnt lgkmcnt(15)
    v_mfma_f32_16x16x32_bf16 v[192:195], v[112:115], v[64:67], v[192:195]
    v_mfma_f32_16x16x32_bf16 v[196:199], v[112:115], v[68:71], v[196:199]
    v_mfma_f32_16x16x32_bf16 v[200:203], v[112:115], v[72:75], v[200:203]
    v_mfma_f32_16x16x32_bf16 v[204:207], v[112:115], v[76:79], v[204:207]
    ds_read_b64_tr_b16 v[112:113], v12 offset:24576
    ds_read_b64_tr_b16 v[114:115], v12 offset:26624
    v_and_b32 v6, 0x30, v1
    s_lshl_b32 s27, s57, 8
    s_add_u32 s27, s27, 147456
    v_add_u32 v6, s27, v6
    v_readfirstlane_b32 s58, v10
    v_readfirstlane_b32 s59, v11
    ds_read_b128 v[40:43], v6 offset:0
    ds_read_b128 v[44:47], v6 offset:64
    ds_read_b128 v[48:51], v6 offset:512
    ds_read_b128 v[52:55], v6 offset:576
    v_mfma_f32_16x16x32_bf16 v[208:211], v[116:119], v[64:67], v[208:211]
    v_mfma_f32_16x16x32_bf16 v[212:215], v[116:119], v[68:71], v[212:215]
    v_mfma_f32_16x16x32_bf16 v[216:219], v[116:119], v[72:75], v[216:219]
    v_mfma_f32_16x16x32_bf16 v[220:223], v[116:119], v[76:79], v[220:223]
    ds_read_b64_tr_b16 v[116:117], v13 offset:24576
    ds_read_b64_tr_b16 v[118:119], v13 offset:26624
    s_waitcnt lgkmcnt(15)
    v_mfma_f32_16x16x32_bf16 v[224:227], v[120:123], v[64:67], v[224:227]
    v_mfma_f32_16x16x32_bf16 v[228:231], v[120:123], v[68:71], v[228:231]
    v_mfma_f32_16x16x32_bf16 v[232:235], v[120:123], v[72:75], v[232:235]
    v_mfma_f32_16x16x32_bf16 v[236:239], v[120:123], v[76:79], v[236:239]
    ds_read_b64_tr_b16 v[120:121], v14 offset:24576
    ds_read_b64_tr_b16 v[122:123], v14 offset:26624
    v_mfma_f32_16x16x32_bf16 v[240:243], v[124:127], v[64:67], v[240:243]
    v_mfma_f32_16x16x32_bf16 v[244:247], v[124:127], v[68:71], v[244:247]
    v_mfma_f32_16x16x32_bf16 v[248:251], v[124:127], v[72:75], v[248:251]
    v_mfma_f32_16x16x32_bf16 v[252:255], v[124:127], v[76:79], v[252:255]
    ds_read_b64_tr_b16 v[124:125], v15 offset:24576
    ds_read_b64_tr_b16 v[126:127], v15 offset:26624
    s_barrier
    s_waitcnt lgkmcnt(14)
    v_mfma_f32_16x16x32_bf16 v[128:131], v[96:99], v[80:83], v[128:131]
    v_mfma_f32_16x16x32_bf16 v[132:135], v[96:99], v[84:87], v[132:135]
    v_mfma_f32_16x16x32_bf16 v[136:139], v[96:99], v[88:91], v[136:139]
    v_mfma_f32_16x16x32_bf16 v[140:143], v[96:99], v[92:95], v[140:143]
    v_mfma_f32_16x16x32_bf16 v[144:147], v[100:103], v[80:83], v[144:147]
    v_mfma_f32_16x16x32_bf16 v[148:151], v[100:103], v[84:87], v[148:151]
    v_mfma_f32_16x16x32_bf16 v[152:155], v[100:103], v[88:91], v[152:155]
    v_mfma_f32_16x16x32_bf16 v[156:159], v[100:103], v[92:95], v[156:159]
    s_waitcnt lgkmcnt(12)
    v_mfma_f32_16x16x32_bf16 v[160:163], v[104:107], v[80:83], v[160:163]
    v_mfma_f32_16x16x32_bf16 v[164:167], v[104:107], v[84:87], v[164:167]
    v_mfma_f32_16x16x32_bf16 v[168:171], v[104:107], v[88:91], v[168:171]
    v_mfma_f32_16x16x32_bf16 v[172:175], v[104:107], v[92:95], v[172:175]
    v_mfma_f32_16x16x32_bf16 v[176:179], v[108:111], v[80:83], v[176:179]
    v_mfma_f32_16x16x32_bf16 v[180:183], v[108:111], v[84:87], v[180:183]
    v_mfma_f32_16x16x32_bf16 v[184:187], v[108:111], v[88:91], v[184:187]
    v_mfma_f32_16x16x32_bf16 v[188:191], v[108:111], v[92:95], v[188:191]
    s_waitcnt lgkmcnt(4)
    v_mfma_f32_16x16x32_bf16 v[192:195], v[112:115], v[80:83], v[192:195]
    v_mfma_f32_16x16x32_bf16 v[196:199], v[112:115], v[84:87], v[196:199]
    v_mfma_f32_16x16x32_bf16 v[200:203], v[112:115], v[88:91], v[200:203]
    v_mfma_f32_16x16x32_bf16 v[204:207], v[112:115], v[92:95], v[204:207]
    v_mfma_f32_16x16x32_bf16 v[208:211], v[116:119], v[80:83], v[208:211]
    v_mfma_f32_16x16x32_bf16 v[212:215], v[116:119], v[84:87], v[212:215]
    v_mfma_f32_16x16x32_bf16 v[216:219], v[116:119], v[88:91], v[216:219]
    v_mfma_f32_16x16x32_bf16 v[220:223], v[116:119], v[92:95], v[220:223]
    s_waitcnt lgkmcnt(0)
    v_mfma_f32_16x16x32_bf16 v[224:227], v[120:123], v[80:83], v[224:227]
    v_mfma_f32_16x16x32_bf16 v[228:231], v[120:123], v[84:87], v[228:231]
    v_mfma_f32_16x16x32_bf16 v[232:235], v[120:123], v[88:91], v[232:235]
    v_mfma_f32_16x16x32_bf16 v[236:239], v[120:123], v[92:95], v[236:239]
    v_mfma_f32_16x16x32_bf16 v[240:243], v[124:127], v[80:83], v[240:243]
    v_mfma_f32_16x16x32_bf16 v[244:247], v[124:127], v[84:87], v[244:247]
    v_mfma_f32_16x16x32_bf16 v[248:251], v[124:127], v[88:91], v[248:251]
    v_mfma_f32_16x16x32_bf16 v[252:255], v[124:127], v[92:95], v[252:255]
    v_mov_b32 v20, 1
    s_mov_b64 exec, 1
    ds_add_u32 v7, v20 offset:8224
    s_mov_b64 exec, -1
    s_setprio 1
    ds_read_b128 v[64:67], v6 offset:128
    ds_read_b128 v[68:71], v6 offset:192
    ds_read_b128 v[72:75], v6 offset:640
    ds_read_b128 v[76:79], v6 offset:704
    v_fma_f32 v128, -v24, v40, v128
    v_fma_f32 v192, -v24, v48, v192
    v_fma_f32 v129, -v24, v41, v129
    v_fma_f32 v193, -v24, v49, v193
    v_fma_f32 v130, -v24, v42, v130
    v_fma_f32 v194, -v24, v50, v194
    v_fma_f32 v131, -v24, v43, v131
    v_fma_f32 v195, -v24, v51, v195
    v_mul_f32 v128, v128, v26
    v_mul_f32 v129, v129, v26
    v_mul_f32 v130, v130, v26
    v_mul_f32 v131, v131, v26
    v_mul_f32 v128, v128, v192
    v_mul_f32 v129, v129, v193
    v_mul_f32 v130, v130, v194
    v_mul_f32 v131, v131, v195
    v_cvt_pk_bf16_f32 v128, v128, v129
    v_cvt_pk_bf16_f32 v129, v130, v131
    v_fma_f32 v144, -v24, v44, v144
    v_fma_f32 v208, -v24, v52, v208
    v_fma_f32 v145, -v24, v45, v145
    v_fma_f32 v209, -v24, v53, v209
    v_fma_f32 v146, -v24, v46, v146
    v_fma_f32 v210, -v24, v54, v210
    v_fma_f32 v147, -v24, v47, v147
    v_fma_f32 v211, -v24, v55, v211
    v_mul_f32 v144, v144, v26
    v_mul_f32 v145, v145, v26
    v_mul_f32 v146, v146, v26
    v_mul_f32 v147, v147, v26
    v_mul_f32 v144, v144, v208
    v_mul_f32 v145, v145, v209
    v_mul_f32 v146, v146, v210
    v_mul_f32 v147, v147, v211
    v_cvt_pk_bf16_f32 v130, v144, v145
    v_cvt_pk_bf16_f32 v131, v146, v147
    buffer_store_dwordx4 v[128:131], v2, s[40:43], s70 offen offset:0 sc1
    v_fma_f32 v132, -v28, v40, v132
    v_fma_f32 v196, -v28, v48, v196
    v_fma_f32 v133, -v28, v41, v133
    v_fma_f32 v197, -v28, v49, v197
    v_fma_f32 v134, -v28, v42, v134
    v_fma_f32 v198, -v28, v50, v198
    v_fma_f32 v135, -v28, v43, v135
    v_fma_f32 v199, -v28, v51, v199
    v_mul_f32 v132, v132, v30
    v_mul_f32 v133, v133, v30
    v_mul_f32 v134, v134, v30
    v_mul_f32 v135, v135, v30
    v_mul_f32 v132, v132, v196
    v_mul_f32 v133, v133, v197
    v_mul_f32 v134, v134, v198
    v_mul_f32 v135, v135, v199
    v_cvt_pk_bf16_f32 v132, v132, v133
    v_cvt_pk_bf16_f32 v133, v134, v135
    v_fma_f32 v148, -v28, v44, v148
    v_fma_f32 v212, -v28, v52, v212
    v_fma_f32 v149, -v28, v45, v149
    v_fma_f32 v213, -v28, v53, v213
    v_fma_f32 v150, -v28, v46, v150
    v_fma_f32 v214, -v28, v54, v214
    v_fma_f32 v151, -v28, v47, v151
    v_fma_f32 v215, -v28, v55, v215
    v_mul_f32 v148, v148, v30
    v_mul_f32 v149, v149, v30
    v_mul_f32 v150, v150, v30
    v_mul_f32 v151, v151, v30
    v_mul_f32 v148, v148, v212
    v_mul_f32 v149, v149, v213
    v_mul_f32 v150, v150, v214
    v_mul_f32 v151, v151, v215
    v_cvt_pk_bf16_f32 v134, v148, v149
    v_cvt_pk_bf16_f32 v135, v150, v151
    buffer_store_dwordx4 v[132:135], v2, s[40:43], s70 offen offset:1024 sc1
    v_fma_f32 v136, -v32, v40, v136
    v_fma_f32 v200, -v32, v48, v200
    v_fma_f32 v137, -v32, v41, v137
    v_fma_f32 v201, -v32, v49, v201
    v_fma_f32 v138, -v32, v42, v138
    v_fma_f32 v202, -v32, v50, v202
    v_fma_f32 v139, -v32, v43, v139
    v_fma_f32 v203, -v32, v51, v203
    v_mul_f32 v136, v136, v34
    v_mul_f32 v137, v137, v34
    v_mul_f32 v138, v138, v34
    v_mul_f32 v139, v139, v34
    v_mul_f32 v136, v136, v200
    v_mul_f32 v137, v137, v201
    v_mul_f32 v138, v138, v202
    v_mul_f32 v139, v139, v203
    v_cvt_pk_bf16_f32 v136, v136, v137
    v_cvt_pk_bf16_f32 v137, v138, v139
    v_fma_f32 v152, -v32, v44, v152
    v_fma_f32 v216, -v32, v52, v216
    v_fma_f32 v153, -v32, v45, v153
    v_fma_f32 v217, -v32, v53, v217
    v_fma_f32 v154, -v32, v46, v154
    v_fma_f32 v218, -v32, v54, v218
    v_fma_f32 v155, -v32, v47, v155
    v_fma_f32 v219, -v32, v55, v219
    v_mul_f32 v152, v152, v34
    v_mul_f32 v153, v153, v34
    v_mul_f32 v154, v154, v34
    v_mul_f32 v155, v155, v34
    v_mul_f32 v152, v152, v216
    v_mul_f32 v153, v153, v217
    v_mul_f32 v154, v154, v218
    v_mul_f32 v155, v155, v219
    v_cvt_pk_bf16_f32 v138, v152, v153
    v_cvt_pk_bf16_f32 v139, v154, v155
    buffer_store_dwordx4 v[136:139], v2, s[40:43], s70 offen offset:2048 sc1
    v_fma_f32 v140, -v36, v40, v140
    v_fma_f32 v204, -v36, v48, v204
    v_fma_f32 v141, -v36, v41, v141
    v_fma_f32 v205, -v36, v49, v205
    v_fma_f32 v142, -v36, v42, v142
    v_fma_f32 v206, -v36, v50, v206
    v_fma_f32 v143, -v36, v43, v143
    v_fma_f32 v207, -v36, v51, v207
    v_mul_f32 v140, v140, v38
    v_mul_f32 v141, v141, v38
    v_mul_f32 v142, v142, v38
    v_mul_f32 v143, v143, v38
    v_mul_f32 v140, v140, v204
    v_mul_f32 v141, v141, v205
    v_mul_f32 v142, v142, v206
    v_mul_f32 v143, v143, v207
    v_cvt_pk_bf16_f32 v140, v140, v141
    v_cvt_pk_bf16_f32 v141, v142, v143
    v_fma_f32 v156, -v36, v44, v156
    v_fma_f32 v220, -v36, v52, v220
    v_fma_f32 v157, -v36, v45, v157
    v_fma_f32 v221, -v36, v53, v221
    v_fma_f32 v158, -v36, v46, v158
    v_fma_f32 v222, -v36, v54, v222
    v_fma_f32 v159, -v36, v47, v159
    v_fma_f32 v223, -v36, v55, v223
    v_mul_f32 v156, v156, v38
    v_mul_f32 v157, v157, v38
    v_mul_f32 v158, v158, v38
    v_mul_f32 v159, v159, v38
    v_mul_f32 v156, v156, v220
    v_mul_f32 v157, v157, v221
    v_mul_f32 v158, v158, v222
    v_mul_f32 v159, v159, v223
    v_cvt_pk_bf16_f32 v142, v156, v157
    v_cvt_pk_bf16_f32 v143, v158, v159
    buffer_store_dwordx4 v[140:143], v2, s[40:43], s70 offen offset:3072 sc1
    s_add_u32 s70, s70, 131072
    s_waitcnt lgkmcnt(0)
    v_fma_f32 v160, -v24, v64, v160
    v_fma_f32 v224, -v24, v72, v224
    v_fma_f32 v161, -v24, v65, v161
    v_fma_f32 v225, -v24, v73, v225
    v_fma_f32 v162, -v24, v66, v162
    v_fma_f32 v226, -v24, v74, v226
    v_fma_f32 v163, -v24, v67, v163
    v_fma_f32 v227, -v24, v75, v227
    v_mul_f32 v160, v160, v26
    v_mul_f32 v161, v161, v26
    v_mul_f32 v162, v162, v26
    v_mul_f32 v163, v163, v26
    v_mul_f32 v160, v160, v224
    v_mul_f32 v161, v161, v225
    v_mul_f32 v162, v162, v226
    v_mul_f32 v163, v163, v227
    v_cvt_pk_bf16_f32 v160, v160, v161
    v_cvt_pk_bf16_f32 v161, v162, v163
    v_fma_f32 v176, -v24, v68, v176
    v_fma_f32 v240, -v24, v76, v240
    v_fma_f32 v177, -v24, v69, v177
    v_fma_f32 v241, -v24, v77, v241
    v_fma_f32 v178, -v24, v70, v178
    v_fma_f32 v242, -v24, v78, v242
    v_fma_f32 v179, -v24, v71, v179
    v_fma_f32 v243, -v24, v79, v243
    v_mul_f32 v176, v176, v26
    v_mul_f32 v177, v177, v26
    v_mul_f32 v178, v178, v26
    v_mul_f32 v179, v179, v26
    v_mul_f32 v176, v176, v240
    v_mul_f32 v177, v177, v241
    v_mul_f32 v178, v178, v242
    v_mul_f32 v179, v179, v243
    v_cvt_pk_bf16_f32 v162, v176, v177
    v_cvt_pk_bf16_f32 v163, v178, v179
    buffer_store_dwordx4 v[160:163], v2, s[40:43], s70 offen offset:0 sc1
    v_fma_f32 v164, -v28, v64, v164
    v_fma_f32 v228, -v28, v72, v228
    v_fma_f32 v165, -v28, v65, v165
    v_fma_f32 v229, -v28, v73, v229
    v_fma_f32 v166, -v28, v66, v166
    v_fma_f32 v230, -v28, v74, v230
    v_fma_f32 v167, -v28, v67, v167
    v_fma_f32 v231, -v28, v75, v231
    v_mul_f32 v164, v164, v30
    v_mul_f32 v165, v165, v30
    v_mul_f32 v166, v166, v30
    v_mul_f32 v167, v167, v30
    v_mul_f32 v164, v164, v228
    v_mul_f32 v165, v165, v229
    v_mul_f32 v166, v166, v230
    v_mul_f32 v167, v167, v231
    v_cvt_pk_bf16_f32 v164, v164, v165
    v_cvt_pk_bf16_f32 v165, v166, v167
    v_fma_f32 v180, -v28, v68, v180
    v_fma_f32 v244, -v28, v76, v244
    v_fma_f32 v181, -v28, v69, v181
    v_fma_f32 v245, -v28, v77, v245
    v_fma_f32 v182, -v28, v70, v182
    v_fma_f32 v246, -v28, v78, v246
    v_fma_f32 v183, -v28, v71, v183
    v_fma_f32 v247, -v28, v79, v247
    v_mul_f32 v180, v180, v30
    v_mul_f32 v181, v181, v30
    v_mul_f32 v182, v182, v30
    v_mul_f32 v183, v183, v30
    v_mul_f32 v180, v180, v244
    v_mul_f32 v181, v181, v245
    v_mul_f32 v182, v182, v246
    v_mul_f32 v183, v183, v247
    v_cvt_pk_bf16_f32 v166, v180, v181
    v_cvt_pk_bf16_f32 v167, v182, v183
    buffer_store_dwordx4 v[164:167], v2, s[40:43], s70 offen offset:1024 sc1
    v_fma_f32 v168, -v32, v64, v168
    v_fma_f32 v232, -v32, v72, v232
    v_fma_f32 v169, -v32, v65, v169
    v_fma_f32 v233, -v32, v73, v233
    v_fma_f32 v170, -v32, v66, v170
    v_fma_f32 v234, -v32, v74, v234
    v_fma_f32 v171, -v32, v67, v171
    v_fma_f32 v235, -v32, v75, v235
    v_mul_f32 v168, v168, v34
    v_mul_f32 v169, v169, v34
    v_mul_f32 v170, v170, v34
    v_mul_f32 v171, v171, v34
    v_mul_f32 v168, v168, v232
    v_mul_f32 v169, v169, v233
    v_mul_f32 v170, v170, v234
    v_mul_f32 v171, v171, v235
    v_cvt_pk_bf16_f32 v168, v168, v169
    v_cvt_pk_bf16_f32 v169, v170, v171
    v_fma_f32 v184, -v32, v68, v184
    v_fma_f32 v248, -v32, v76, v248
    v_fma_f32 v185, -v32, v69, v185
    v_fma_f32 v249, -v32, v77, v249
    v_fma_f32 v186, -v32, v70, v186
    v_fma_f32 v250, -v32, v78, v250
    v_fma_f32 v187, -v32, v71, v187
    v_fma_f32 v251, -v32, v79, v251
    v_mul_f32 v184, v184, v34
    v_mul_f32 v185, v185, v34
    v_mul_f32 v186, v186, v34
    v_mul_f32 v187, v187, v34
    v_mul_f32 v184, v184, v248
    v_mul_f32 v185, v185, v249
    v_mul_f32 v186, v186, v250
    v_mul_f32 v187, v187, v251
    v_cvt_pk_bf16_f32 v170, v184, v185
    v_cvt_pk_bf16_f32 v171, v186, v187
    buffer_store_dwordx4 v[168:171], v2, s[40:43], s70 offen offset:2048 sc1
    v_fma_f32 v172, -v36, v64, v172
    v_fma_f32 v236, -v36, v72, v236
    v_fma_f32 v173, -v36, v65, v173
    v_fma_f32 v237, -v36, v73, v237
    v_fma_f32 v174, -v36, v66, v174
    v_fma_f32 v238, -v36, v74, v238
    v_fma_f32 v175, -v36, v67, v175
    v_fma_f32 v239, -v36, v75, v239
    v_mul_f32 v172, v172, v38
    v_mul_f32 v173, v173, v38
    v_mul_f32 v174, v174, v38
    v_mul_f32 v175, v175, v38
    v_mul_f32 v172, v172, v236
    v_mul_f32 v173, v173, v237
    v_mul_f32 v174, v174, v238
    v_mul_f32 v175, v175, v239
    v_cvt_pk_bf16_f32 v172, v172, v173
    v_cvt_pk_bf16_f32 v173, v174, v175
    v_fma_f32 v188, -v36, v68, v188
    v_fma_f32 v252, -v36, v76, v252
    v_fma_f32 v189, -v36, v69, v189
    v_fma_f32 v253, -v36, v77, v253
    v_fma_f32 v190, -v36, v70, v190
    v_fma_f32 v254, -v36, v78, v254
    v_fma_f32 v191, -v36, v71, v191
    v_fma_f32 v255, -v36, v79, v255
    v_mul_f32 v188, v188, v38
    v_mul_f32 v189, v189, v38
    v_mul_f32 v190, v190, v38
    v_mul_f32 v191, v191, v38
    v_mul_f32 v188, v188, v252
    v_mul_f32 v189, v189, v253
    v_mul_f32 v190, v190, v254
    v_mul_f32 v191, v191, v255
    v_cvt_pk_bf16_f32 v174, v188, v189
    v_cvt_pk_bf16_f32 v175, v190, v191
    buffer_store_dwordx4 v[172:175], v2, s[40:43], s70 offen offset:3072 sc1
    s_add_u32 s70, s70, 131072
    s_add_u32 s27, s72, 0
    buffer_load_dwordx4 v[56:59], v2, s[40:43], s27 offen sc1
    s_add_u32 s27, s72, 1024
    buffer_load_dwordx4 v[60:63], v2, s[40:43], s27 offen sc1
    s_add_u32 s27, s72, 2048
    buffer_load_dwordx4 v[64:67], v2, s[40:43], s27 offen sc1
    s_add_u32 s27, s72, 3072
    buffer_load_dwordx4 v[68:71], v2, s[40:43], s27 offen sc1
    s_add_u32 s27, s72, 4096
    buffer_load_dwordx4 v[72:75], v2, s[40:43], s27 offen sc1
    s_add_u32 s27, s72, 40960
    buffer_load_dwordx4 v[76:79], v2, s[40:43], s27 offen sc1
    s_add_u32 s27, s72, 41984
    buffer_load_dwordx4 v[80:83], v2, s[40:43], s27 offen sc1
    s_add_u32 s27, s72, 43008
    buffer_load_dwordx4 v[84:87], v2, s[40:43], s27 offen sc1
    s_add_u32 s27, s72, 44032
    buffer_load_dwordx4 v[88:91], v2, s[40:43], s27 offen sc1
    s_add_u32 s27, s72, 45056
    buffer_load_dwordx4 v[92:95], v2, s[40:43], s27 offen sc1
    s_add_u32 s27, s72, 81920
    buffer_load_dwordx4 v[96:99], v2, s[40:43], s27 offen sc1
    s_add_u32 s27, s72, 82944
    buffer_load_dwordx4 v[100:103], v2, s[40:43], s27 offen sc1
    s_add_u32 s27, s72, 83968
    buffer_load_dwordx4 v[104:107], v2, s[40:43], s27 offen sc1
    s_add_u32 s27, s72, 84992
    buffer_load_dwordx4 v[108:111], v2, s[40:43], s27 offen sc1
    s_add_u32 s27, s72, 86016
    buffer_load_dwordx4 v[112:115], v2, s[40:43], s27 offen sc1
    s_add_u32 s27, s72, 122880
    buffer_load_dwordx4 v[116:119], v2, s[40:43], s27 offen sc1
    s_add_u32 s27, s72, 123904
    buffer_load_dwordx4 v[120:123], v2, s[40:43], s27 offen sc1
    s_add_u32 s27, s72, 124928
    buffer_load_dwordx4 v[124:127], v2, s[40:43], s27 offen sc1
    v_mov_b32 v10, 1
    s_waitcnt vmcnt(18)
    s_mov_b64 exec, 1
    ds_add_rtn_u32 v10, v7, v10 offset:8192
    s_mov_b64 exec, -1
    s_waitcnt lgkmcnt(0)
    v_readfirstlane_b32 s27, v10
    s_nop 1
    s_cmp_lg_u32 s27, 3
    s_cbranch_scc1 GC_NF

    s_lshl_b32 s62, s25, 3
    s_add_u32 s62, s62, s26
    s_lshl_b32 s62, s62, 9
    s_add_u32 s62, s62, 14680064
    v_mov_b32 v10, s58
    v_mov_b32 v11, s59
    s_mov_b64 exec, 1
    buffer_store_dwordx2 v[10:11], v3, s[40:43], s62 offen sc1
    s_mov_b64 exec, -1

GC_NF:
    s_setprio 0
    s_cmp_lg_u32 s24, 0
    s_cbranch_scc1 OW_20
    s_lshl_b32 s62, s26, 14
    s_add_u32 s62, s62, 13893632
    s_add_u32 s27, s62, 0
    buffer_load_dwordx4 v[12:15], v2, s[40:43], s27 offen sc1
    s_add_u32 s27, s62, 2048
    buffer_load_dwordx4 v[16:19], v2, s[40:43], s27 offen sc1
    s_add_u32 s27, s62, 5120
    buffer_load_dwordx4 v[20:23], v2, s[40:43], s27 offen sc1
    s_add_u32 s27, s62, 10240
    buffer_load_dwordx4 v[24:27], v2, s[40:43], s27 offen sc1
    s_add_u32 s27, s62, 13312
    buffer_load_dwordx4 v[28:31], v2, s[40:43], s27 offen sc1
OW_20:
    s_add_u32 s27, s72, 125952
    buffer_load_dwordx4 v[128:131], v2, s[40:43], s27 offen sc1
    s_add_u32 s27, s72, 126976
    buffer_load_dwordx4 v[132:135], v2, s[40:43], s27 offen sc1
    s_add_u32 s27, s73, 0
    buffer_load_dwordx4 v[136:139], v2, s[40:43], s27 offen sc1
    s_add_u32 s27, s73, 1024
    buffer_load_dwordx4 v[140:143], v2, s[40:43], s27 offen sc1
    s_add_u32 s27, s73, 2048
    buffer_load_dwordx4 v[144:147], v2, s[40:43], s27 offen sc1
    s_add_u32 s27, s73, 3072
    buffer_load_dwordx4 v[148:151], v2, s[40:43], s27 offen sc1
    s_add_u32 s27, s73, 4096
    buffer_load_dwordx4 v[152:155], v2, s[40:43], s27 offen sc1
    s_add_u32 s27, s73, 40960
    buffer_load_dwordx4 v[156:159], v2, s[40:43], s27 offen sc1
    s_add_u32 s27, s73, 41984
    buffer_load_dwordx4 v[160:163], v2, s[40:43], s27 offen sc1
    s_add_u32 s27, s73, 43008
    buffer_load_dwordx4 v[164:167], v2, s[40:43], s27 offen sc1
    s_add_u32 s27, s73, 44032
    buffer_load_dwordx4 v[168:171], v2, s[40:43], s27 offen sc1
    s_add_u32 s27, s73, 45056
    buffer_load_dwordx4 v[172:175], v2, s[40:43], s27 offen sc1
    s_cmp_lg_u32 s24, 0
    s_cbranch_scc1 OW_21
    s_waitcnt vmcnt(12)
    v_xor_b32 v32, s58, v13
    v_xor_b32 v33, s58, v15
    v_or_b32 v32, v32, v33
    v_xor_b32 v33, s58, v17
    v_or_b32 v32, v32, v33
    v_xor_b32 v33, s58, v19
    v_or_b32 v32, v32, v33
    v_xor_b32 v33, s58, v21
    v_or_b32 v32, v32, v33
    v_xor_b32 v33, s58, v23
    v_or_b32 v32, v32, v33
    v_xor_b32 v33, s58, v25
    v_or_b32 v32, v32, v33
    v_xor_b32 v33, s58, v27
    v_or_b32 v32, v32, v33
    v_xor_b32 v33, s58, v29
    v_or_b32 v32, v32, v33
    v_xor_b32 v33, s58, v31
    v_or_b32 v32, v32, v33
    s_mov_b32 s79, 200000
RT_22:
    v_cmp_ne_u32 vcc, 0, v32
    s_nop 1
    s_cmp_eq_u64 vcc, 0
    s_cbranch_scc1 RTOK_23
    s_sub_u32 s79, s79, 1
    s_cbranch_scc1 RTOK_23
    s_sleep 8

    s_lshl_b32 s62, s26, 14
    s_add_u32 s62, s62, 13893632
    s_add_u32 s27, s62, 0
    buffer_load_dwordx4 v[12:15], v2, s[40:43], s27 offen sc1
    s_add_u32 s27, s62, 2048
    buffer_load_dwordx4 v[16:19], v2, s[40:43], s27 offen sc1
    s_add_u32 s27, s62, 5120
    buffer_load_dwordx4 v[20:23], v2, s[40:43], s27 offen sc1
    s_add_u32 s27, s62, 10240
    buffer_load_dwordx4 v[24:27], v2, s[40:43], s27 offen sc1
    s_add_u32 s27, s62, 13312
    buffer_load_dwordx4 v[28:31], v2, s[40:43], s27 offen sc1
    s_waitcnt vmcnt(0)
    v_xor_b32 v32, s58, v13
    v_xor_b32 v33, s58, v15
    v_or_b32 v32, v32, v33
    v_xor_b32 v33, s58, v17
    v_or_b32 v32, v32, v33
    v_xor_b32 v33, s58, v19
    v_or_b32 v32, v32, v33
    v_xor_b32 v33, s58, v21
    v_or_b32 v32, v32, v33
    v_xor_b32 v33, s58, v23
    v_or_b32 v32, v32, v33
    v_xor_b32 v33, s58, v25
    v_or_b32 v32, v32, v33
    v_xor_b32 v33, s58, v27
    v_or_b32 v32, v32, v33
    v_xor_b32 v33, s58, v29
    v_or_b32 v32, v32, v33
    v_xor_b32 v33, s58, v31
    v_or_b32 v32, v32, v33
    s_branch RT_22
RTOK_23:
    v_add_f32 v12, v12, v16
    v_add_f32 v14, v14, v18
    v_add_f32 v12, v12, v20
    v_add_f32 v14, v14, v22
    v_add_f32 v12, v12, v24
    v_add_f32 v14, v14, v26
    v_add_f32 v12, v12, v28
    v_add_f32 v14, v14, v30
    v_mov_b32 v13, v14
    v_lshrrev_b32 v32, 1, v2
    v_add_u32 v32, v32, v7
    ds_write_b64 v32, v[12:13] offset:1024
    v_mov_b32 v20, 1
    s_waitcnt lgkmcnt(0)
    s_mov_b64 exec, 1
    ds_add_u32 v7, v20 offset:8216
    s_mov_b64 exec, -1
OW_21:
LS_24:
    ds_read_b32 v12, v7 offset:8208
    s_waitcnt lgkmcnt(0)
    v_readfirstlane_b32 s27, v12
    s_nop 1
    s_cmp_ge_u32 s27, 8
    s_cbranch_scc1 LS_24_D
    s_sleep 2
    s_branch LS_24

LS_24_D:
    s_add_u32 s65, s72, 163840
    s_mul_i32 s67, s83, 81920
    s_add_u32 s67, s67, s82
    s_add_u32 s67, s67, 1966080
    s_and_b32 s69, s83, 3
    s_mul_i32 s69, s69, 40960
    s_add_u32 s69, s69, s82
    s_add_u32 s69, s69, 2621440

    s_lshl_b32 s76, s24, 12
    s_add_u32 m0, s76, 32768
    s_add_u32 s27, s65, 40960
    buffer_load_dwordx4 v2, s[40:43], s27 offen sc1 lds
    s_add_u32 m0, s76, 33792
    s_add_u32 s27, s65, 41984
    buffer_load_dwordx4 v2, s[40:43], s27 offen sc1 lds
    s_add_u32 m0, s76, 34816
    s_add_u32 s27, s65, 43008
    buffer_load_dwordx4 v2, s[40:43], s27 offen sc1 lds
    s_add_u32 m0, s76, 35840
    s_add_u32 s27, s65, 44032
    buffer_load_dwordx4 v2, s[40:43], s27 offen sc1 lds
    s_add_u32 m0, s76, 49152
    s_add_u32 s27, s65, 45056
    buffer_load_dwordx4 v2, s[40:43], s27 offen sc1 lds
    s_add_u32 m0, s76, 50176
    s_add_u32 s27, s67, 0
    buffer_load_dwordx4 v2, s[40:43], s27 offen sc1 lds
    s_add_u32 m0, s76, 51200
    s_add_u32 s27, s67, 1024
    buffer_load_dwordx4 v2, s[40:43], s27 offen sc1 lds
    s_add_u32 m0, s76, 52224
    s_add_u32 s27, s67, 2048
    buffer_load_dwordx4 v2, s[40:43], s27 offen sc1 lds
    s_add_u32 m0, s76, 65536
    s_add_u32 s27, s67, 3072
    buffer_load_dwordx4 v2, s[40:43], s27 offen sc1 lds
    s_add_u32 m0, s76, 66560
    s_add_u32 s27, s67, 4096
    buffer_load_dwordx4 v2, s[40:43], s27 offen sc1 lds
    s_add_u32 m0, s76, 67584
    s_add_u32 s27, s67, 40960
    buffer_load_dwordx4 v2, s[40:43], s27 offen sc1 lds
    s_add_u32 m0, s76, 68608
    s_add_u32 s27, s67, 41984
    buffer_load_dwordx4 v2, s[40:43], s27 offen sc1 lds
    s_add_u32 m0, s76, 81920
    s_add_u32 s27, s67, 43008
    buffer_load_dwordx4 v2, s[40:43], s27 offen sc1 lds
    s_add_u32 m0, s76, 82944
    s_add_u32 s27, s67, 44032
    buffer_load_dwordx4 v2, s[40:43], s27 offen sc1 lds
    s_add_u32 m0, s76, 83968
    s_add_u32 s27, s67, 45056
    buffer_load_dwordx4 v2, s[40:43], s27 offen sc1 lds
    s_add_u32 m0, s76, 84992
    s_add_u32 s27, s69, 0
    buffer_load_dwordx4 v2, s[40:43], s27 offen sc1 lds
    s_add_u32 m0, s76, 131072
    s_add_u32 s27, s69, 1024
    buffer_load_dwordx4 v2, s[40:43], s27 offen sc1 lds
    s_add_u32 m0, s76, 132096
    s_add_u32 s27, s69, 2048
    buffer_load_dwordx4 v2, s[40:43], s27 offen sc1 lds
    s_add_u32 m0, s76, 133120
    s_add_u32 s27, s69, 3072
    buffer_load_dwordx4 v2, s[40:43], s27 offen sc1 lds
    s_add_u32 m0, s76, 134144
    s_add_u32 s27, s69, 4096
    buffer_load_dwordx4 v2, s[40:43], s27 offen sc1 lds
    s_mov_b32 s75, 155652
    s_mov_b32 s71, 155668
    s_branch P2_E
KV_TAIL:
    v_and_b32 v40, 0x30, v1
    s_lshl_b32 s27, s56, 8
    v_add_u32 v40, s27, v40
    s_mov_b32 s60, 1.0
    s_mov_b32 s61, 1.0
    s_mov_b32 s62, 897988541
    s_mov_b32 s63, 897988541
    v_and_b32 v41, 8, v1
    v_cmp_eq_u32 vcc, 0, v41
    s_lshl_b32 s27, s57, 9
    v_add_u32 v28, s27, v28
    s_barrier

    ds_read_b128 v[48:51], v28 offset:31744
    ds_read_b128 v[52:55], v28 offset:32000
    ds_read_b128 v[144:147], v40 offset:24576
    ds_read_b128 v[160:163], v40 offset:25088
    ds_read_b128 v[72:75], v40 offset:25600
    ds_read_b128 v[148:151], v40 offset:24640
    ds_read_b128 v[164:167], v40 offset:25152
    ds_read_b128 v[76:79], v40 offset:25664
    ds_read_b128 v[152:155], v40 offset:24704
    ds_read_b128 v[168:171], v40 offset:25216
    ds_read_b128 v[80:83], v40 offset:25728
    ds_read_b128 v[156:159], v40 offset:24768
    ds_read_b128 v[172:175], v40 offset:25280
    ds_read_b128 v[84:87], v40 offset:25792
    s_waitcnt lgkmcnt(12)
    v_mov_b32 v12, v48
    v_mov_b32 v13, v48
    v_mov_b32 v14, v49
    v_mov_b32 v15, v49
    v_mov_b32 v16, v50
    v_mov_b32 v17, v50
    v_mov_b32 v18, v52
    v_mov_b32 v19, v52
    v_mov_b32 v20, v53
    v_mov_b32 v21, v53
    s_waitcnt lgkmcnt(0)
    v_pk_fma_f32 v[176:177], v[144:145], v[12:13], v[176:177] neg_lo:[1,0,0] neg_hi:[1,0,0]
    v_pk_mul_f32 v[88:89], v[176:177], v[72:73]
    v_pk_fma_f32 v[176:177], v[176:177], v[160:161], s[60:61]
    v_exp_f32_e64 v88, v88 clamp
    v_exp_f32_e64 v89, v89 clamp
    v_max_f32 v176, v176, v88
    v_max_f32 v177, v177, v89
    v_pk_add_f32 v[176:177], v[176:177], s[62:63]
    v_cvt_pk_bf16_f32 v96, v176, v177

    v_pk_fma_f32 v[178:179], v[146:147], v[12:13], v[178:179] neg_lo:[1,0,0] neg_hi:[1,0,0]
    v_pk_mul_f32 v[90:91], v[178:179], v[74:75]
    v_pk_fma_f32 v[178:179], v[178:179], v[162:163], s[60:61]
    v_exp_f32_e64 v90, v90 clamp
    v_exp_f32_e64 v91, v91 clamp
    v_max_f32 v178, v178, v90
    v_max_f32 v179, v179, v91
    v_pk_add_f32 v[178:179], v[178:179], s[62:63]
    v_cvt_pk_bf16_f32 v97, v178, v179

    v_pk_fma_f32 v[180:181], v[148:149], v[12:13], v[180:181] neg_lo:[1,0,0] neg_hi:[1,0,0]
    v_pk_mul_f32 v[88:89], v[180:181], v[76:77]
    v_pk_fma_f32 v[180:181], v[180:181], v[164:165], s[60:61]
    v_exp_f32_e64 v88, v88 clamp
    v_exp_f32_e64 v89, v89 clamp
    v_max_f32 v180, v180, v88
    v_max_f32 v181, v181, v89
    v_pk_add_f32 v[180:181], v[180:181], s[62:63]
    v_cvt_pk_bf16_f32 v98, v180, v181

    v_pk_fma_f32 v[182:183], v[150:151], v[12:13], v[182:183] neg_lo:[1,0,0] neg_hi:[1,0,0]
    v_pk_mul_f32 v[90:91], v[182:183], v[78:79]
    v_pk_fma_f32 v[182:183], v[182:183], v[166:167], s[60:61]
    v_exp_f32_e64 v90, v90 clamp
    v_exp_f32_e64 v91, v91 clamp
    v_max_f32 v182, v182, v90
    v_max_f32 v183, v183, v91
    v_pk_add_f32 v[182:183], v[182:183], s[62:63]
    v_cvt_pk_bf16_f32 v99, v182, v183

    v_pk_fma_f32 v[184:185], v[152:153], v[12:13], v[184:185] neg_lo:[1,0,0] neg_hi:[1,0,0]
    v_pk_mul_f32 v[88:89], v[184:185], v[80:81]
    v_pk_fma_f32 v[184:185], v[184:185], v[168:169], s[60:61]
    v_exp_f32_e64 v88, v88 clamp
    v_exp_f32_e64 v89, v89 clamp
    v_max_f32 v184, v184, v88
    v_max_f32 v185, v185, v89
    v_pk_add_f32 v[184:185], v[184:185], s[62:63]
    v_cvt_pk_bf16_f32 v100, v184, v185

    v_pk_fma_f32 v[186:187], v[154:155], v[12:13], v[186:187] neg_lo:[1,0,0] neg_hi:[1,0,0]
    v_pk_mul_f32 v[90:91], v[186:187], v[82:83]
    v_pk_fma_f32 v[186:187], v[186:187], v[170:171], s[60:61]
    v_exp_f32_e64 v90, v90 clamp
    v_exp_f32_e64 v91, v91 clamp
    v_max_f32 v186, v186, v90
    v_max_f32 v187, v187, v91
    v_pk_add_f32 v[186:187], v[186:187], s[62:63]
    v_cvt_pk_bf16_f32 v101, v186, v187

    v_pk_fma_f32 v[188:189], v[156:157], v[12:13], v[188:189] neg_lo:[1,0,0] neg_hi:[1,0,0]
    v_pk_mul_f32 v[88:89], v[188:189], v[84:85]
    v_pk_fma_f32 v[188:189], v[188:189], v[172:173], s[60:61]
    v_exp_f32_e64 v88, v88 clamp
    v_exp_f32_e64 v89, v89 clamp
    v_max_f32 v188, v188, v88
    v_max_f32 v189, v189, v89
    v_pk_add_f32 v[188:189], v[188:189], s[62:63]
    v_cvt_pk_bf16_f32 v102, v188, v189

    v_pk_fma_f32 v[190:191], v[158:159], v[12:13], v[190:191] neg_lo:[1,0,0] neg_hi:[1,0,0]
    v_pk_mul_f32 v[90:91], v[190:191], v[86:87]
    v_pk_fma_f32 v[190:191], v[190:191], v[174:175], s[60:61]
    v_exp_f32_e64 v90, v90 clamp
    v_exp_f32_e64 v91, v91 clamp
    v_max_f32 v190, v190, v90
    v_max_f32 v191, v191, v91
    v_pk_add_f32 v[190:191], v[190:191], s[62:63]
    v_cvt_pk_bf16_f32 v103, v190, v191

    v_pk_fma_f32 v[192:193], v[144:145], v[14:15], v[192:193] neg_lo:[1,0,0] neg_hi:[1,0,0]
    v_pk_mul_f32 v[88:89], v[192:193], v[72:73]
    v_pk_fma_f32 v[192:193], v[192:193], v[160:161], s[60:61]
    v_exp_f32_e64 v88, v88 clamp
    v_exp_f32_e64 v89, v89 clamp
    v_max_f32 v192, v192, v88
    v_max_f32 v193, v193, v89
    v_pk_add_f32 v[192:193], v[192:193], s[62:63]
    v_cvt_pk_bf16_f32 v104, v192, v193

    v_pk_fma_f32 v[194:195], v[146:147], v[14:15], v[194:195] neg_lo:[1,0,0] neg_hi:[1,0,0]
    v_pk_mul_f32 v[90:91], v[194:195], v[74:75]
    v_pk_fma_f32 v[194:195], v[194:195], v[162:163], s[60:61]
    v_exp_f32_e64 v90, v90 clamp
    v_exp_f32_e64 v91, v91 clamp
    v_max_f32 v194, v194, v90
    v_max_f32 v195, v195, v91
    v_pk_add_f32 v[194:195], v[194:195], s[62:63]
    v_cvt_pk_bf16_f32 v105, v194, v195

    v_pk_fma_f32 v[196:197], v[148:149], v[14:15], v[196:197] neg_lo:[1,0,0] neg_hi:[1,0,0]
    v_pk_mul_f32 v[88:89], v[196:197], v[76:77]
    v_pk_fma_f32 v[196:197], v[196:197], v[164:165], s[60:61]
    v_exp_f32_e64 v88, v88 clamp
    v_exp_f32_e64 v89, v89 clamp
    v_max_f32 v196, v196, v88
    v_max_f32 v197, v197, v89
    v_pk_add_f32 v[196:197], v[196:197], s[62:63]
    v_cvt_pk_bf16_f32 v106, v196, v197

    v_pk_fma_f32 v[198:199], v[150:151], v[14:15], v[198:199] neg_lo:[1,0,0] neg_hi:[1,0,0]
    v_pk_mul_f32 v[90:91], v[198:199], v[78:79]
    v_pk_fma_f32 v[198:199], v[198:199], v[166:167], s[60:61]
    v_exp_f32_e64 v90, v90 clamp
    v_exp_f32_e64 v91, v91 clamp
    v_max_f32 v198, v198, v90
    v_max_f32 v199, v199, v91
    v_pk_add_f32 v[198:199], v[198:199], s[62:63]
    v_cvt_pk_bf16_f32 v107, v198, v199

    v_pk_fma_f32 v[200:201], v[152:153], v[14:15], v[200:201] neg_lo:[1,0,0] neg_hi:[1,0,0]
    v_pk_mul_f32 v[88:89], v[200:201], v[80:81]
    v_pk_fma_f32 v[200:201], v[200:201], v[168:169], s[60:61]
    v_exp_f32_e64 v88, v88 clamp
    v_exp_f32_e64 v89, v89 clamp
    v_max_f32 v200, v200, v88
    v_max_f32 v201, v201, v89
    v_pk_add_f32 v[200:201], v[200:201], s[62:63]
    v_cvt_pk_bf16_f32 v108, v200, v201

    v_pk_fma_f32 v[202:203], v[154:155], v[14:15], v[202:203] neg_lo:[1,0,0] neg_hi:[1,0,0]
    v_pk_mul_f32 v[90:91], v[202:203], v[82:83]
    v_pk_fma_f32 v[202:203], v[202:203], v[170:171], s[60:61]
    v_exp_f32_e64 v90, v90 clamp
    v_exp_f32_e64 v91, v91 clamp
    v_max_f32 v202, v202, v90
    v_max_f32 v203, v203, v91
    v_pk_add_f32 v[202:203], v[202:203], s[62:63]
    v_cvt_pk_bf16_f32 v109, v202, v203

    v_pk_fma_f32 v[204:205], v[156:157], v[14:15], v[204:205] neg_lo:[1,0,0] neg_hi:[1,0,0]
    v_pk_mul_f32 v[88:89], v[204:205], v[84:85]
    v_pk_fma_f32 v[204:205], v[204:205], v[172:173], s[60:61]
    v_exp_f32_e64 v88, v88 clamp
    v_exp_f32_e64 v89, v89 clamp
    v_max_f32 v204, v204, v88
    v_max_f32 v205, v205, v89
    v_pk_add_f32 v[204:205], v[204:205], s[62:63]
    v_cvt_pk_bf16_f32 v110, v204, v205

    v_pk_fma_f32 v[206:207], v[158:159], v[14:15], v[206:207] neg_lo:[1,0,0] neg_hi:[1,0,0]
    v_pk_mul_f32 v[90:91], v[206:207], v[86:87]
    v_pk_fma_f32 v[206:207], v[206:207], v[174:175], s[60:61]
    v_exp_f32_e64 v90, v90 clamp
    v_exp_f32_e64 v91, v91 clamp
    v_max_f32 v206, v206, v90
    v_max_f32 v207, v207, v91
    v_pk_add_f32 v[206:207], v[206:207], s[62:63]
    v_cvt_pk_bf16_f32 v111, v206, v207

    v_pk_fma_f32 v[208:209], v[144:145], v[16:17], v[208:209] neg_lo:[1,0,0] neg_hi:[1,0,0]
    v_pk_mul_f32 v[92:93], v[208:209], v[160:161]
    v_cvt_pk_bf16_f32 v94, v92, v93
    v_cndmask_b32 v120, v94, v24, vcc
    v_pk_mul_f32 v[88:89], v[208:209], v[72:73]
    v_pk_fma_f32 v[208:209], v[208:209], v[160:161], s[60:61]
    v_exp_f32_e64 v88, v88 clamp
    v_exp_f32_e64 v89, v89 clamp
    v_max_f32 v208, v208, v88
    v_max_f32 v209, v209, v89
    v_pk_add_f32 v[208:209], v[208:209], s[62:63]
    v_cvt_pk_bf16_f32 v112, v208, v209

    v_pk_fma_f32 v[210:211], v[146:147], v[16:17], v[210:211] neg_lo:[1,0,0] neg_hi:[1,0,0]
    v_pk_mul_f32 v[92:93], v[210:211], v[162:163]
    v_cvt_pk_bf16_f32 v94, v92, v93
    v_cndmask_b32 v121, v94, v24, vcc
    v_pk_mul_f32 v[90:91], v[210:211], v[74:75]
    v_pk_fma_f32 v[210:211], v[210:211], v[162:163], s[60:61]
    v_exp_f32_e64 v90, v90 clamp
    v_exp_f32_e64 v91, v91 clamp
    v_max_f32 v210, v210, v90
    v_max_f32 v211, v211, v91
    v_pk_add_f32 v[210:211], v[210:211], s[62:63]
    v_cvt_pk_bf16_f32 v113, v210, v211

    v_pk_fma_f32 v[212:213], v[148:149], v[16:17], v[212:213] neg_lo:[1,0,0] neg_hi:[1,0,0]
    v_pk_mul_f32 v[92:93], v[212:213], v[164:165]
    v_cvt_pk_bf16_f32 v94, v92, v93
    v_cndmask_b32 v122, v94, v24, vcc
    v_pk_mul_f32 v[88:89], v[212:213], v[76:77]
    v_pk_fma_f32 v[212:213], v[212:213], v[164:165], s[60:61]
    v_exp_f32_e64 v88, v88 clamp
    v_exp_f32_e64 v89, v89 clamp
    v_max_f32 v212, v212, v88
    v_max_f32 v213, v213, v89
    v_pk_add_f32 v[212:213], v[212:213], s[62:63]
    v_cvt_pk_bf16_f32 v114, v212, v213

    v_pk_fma_f32 v[214:215], v[150:151], v[16:17], v[214:215] neg_lo:[1,0,0] neg_hi:[1,0,0]
    v_pk_mul_f32 v[92:93], v[214:215], v[166:167]
    v_cvt_pk_bf16_f32 v94, v92, v93
    v_cndmask_b32 v123, v94, v24, vcc
    v_pk_mul_f32 v[90:91], v[214:215], v[78:79]
    v_pk_fma_f32 v[214:215], v[214:215], v[166:167], s[60:61]
    v_exp_f32_e64 v90, v90 clamp
    v_exp_f32_e64 v91, v91 clamp
    v_max_f32 v214, v214, v90
    v_max_f32 v215, v215, v91
    v_pk_add_f32 v[214:215], v[214:215], s[62:63]
    v_cvt_pk_bf16_f32 v115, v214, v215

    v_pk_fma_f32 v[216:217], v[152:153], v[16:17], v[216:217] neg_lo:[1,0,0] neg_hi:[1,0,0]
    v_pk_mul_f32 v[92:93], v[216:217], v[168:169]
    v_cvt_pk_bf16_f32 v94, v92, v93
    v_cndmask_b32 v124, v94, v24, vcc
    v_pk_mul_f32 v[88:89], v[216:217], v[80:81]
    v_pk_fma_f32 v[216:217], v[216:217], v[168:169], s[60:61]
    v_exp_f32_e64 v88, v88 clamp
    v_exp_f32_e64 v89, v89 clamp
    v_max_f32 v216, v216, v88
    v_max_f32 v217, v217, v89
    v_pk_add_f32 v[216:217], v[216:217], s[62:63]
    v_cvt_pk_bf16_f32 v116, v216, v217

    v_pk_fma_f32 v[218:219], v[154:155], v[16:17], v[218:219] neg_lo:[1,0,0] neg_hi:[1,0,0]
    v_pk_mul_f32 v[92:93], v[218:219], v[170:171]
    v_cvt_pk_bf16_f32 v94, v92, v93
    v_cndmask_b32 v125, v94, v24, vcc
    v_pk_mul_f32 v[90:91], v[218:219], v[82:83]
    v_pk_fma_f32 v[218:219], v[218:219], v[170:171], s[60:61]
    v_exp_f32_e64 v90, v90 clamp
    v_exp_f32_e64 v91, v91 clamp
    v_max_f32 v218, v218, v90
    v_max_f32 v219, v219, v91
    v_pk_add_f32 v[218:219], v[218:219], s[62:63]
    v_cvt_pk_bf16_f32 v117, v218, v219

    v_pk_fma_f32 v[220:221], v[156:157], v[16:17], v[220:221] neg_lo:[1,0,0] neg_hi:[1,0,0]
    v_pk_mul_f32 v[92:93], v[220:221], v[172:173]
    v_cvt_pk_bf16_f32 v94, v92, v93
    v_cndmask_b32 v126, v94, v24, vcc
    v_pk_mul_f32 v[88:89], v[220:221], v[84:85]
    v_pk_fma_f32 v[220:221], v[220:221], v[172:173], s[60:61]
    v_exp_f32_e64 v88, v88 clamp
    v_exp_f32_e64 v89, v89 clamp
    v_max_f32 v220, v220, v88
    v_max_f32 v221, v221, v89
    v_pk_add_f32 v[220:221], v[220:221], s[62:63]
    v_cvt_pk_bf16_f32 v118, v220, v221

    v_pk_fma_f32 v[222:223], v[158:159], v[16:17], v[222:223] neg_lo:[1,0,0] neg_hi:[1,0,0]
    v_pk_mul_f32 v[92:93], v[222:223], v[174:175]
    v_cvt_pk_bf16_f32 v94, v92, v93
    v_cndmask_b32 v127, v94, v24, vcc
    v_pk_mul_f32 v[90:91], v[222:223], v[86:87]
    v_pk_fma_f32 v[222:223], v[222:223], v[174:175], s[60:61]
    v_exp_f32_e64 v90, v90 clamp
    v_exp_f32_e64 v91, v91 clamp
    v_max_f32 v222, v222, v90
    v_max_f32 v223, v223, v91
    v_pk_add_f32 v[222:223], v[222:223], s[62:63]
    v_cvt_pk_bf16_f32 v119, v222, v223

    v_pk_fma_f32 v[224:225], v[144:145], v[18:19], v[224:225] neg_lo:[1,0,0] neg_hi:[1,0,0]
    v_pk_mul_f32 v[224:225], v[224:225], v[160:161]
    v_cvt_pk_bf16_f32 v128, v224, v225
    v_pk_fma_f32 v[226:227], v[146:147], v[18:19], v[226:227] neg_lo:[1,0,0] neg_hi:[1,0,0]
    v_pk_mul_f32 v[226:227], v[226:227], v[162:163]
    v_cvt_pk_bf16_f32 v129, v226, v227
    v_pk_fma_f32 v[228:229], v[148:149], v[18:19], v[228:229] neg_lo:[1,0,0] neg_hi:[1,0,0]
    v_pk_mul_f32 v[228:229], v[228:229], v[164:165]
    v_cvt_pk_bf16_f32 v130, v228, v229
    v_pk_fma_f32 v[230:231], v[150:151], v[18:19], v[230:231] neg_lo:[1,0,0] neg_hi:[1,0,0]
    v_pk_mul_f32 v[230:231], v[230:231], v[166:167]
    v_cvt_pk_bf16_f32 v131, v230, v231
    v_pk_fma_f32 v[232:233], v[152:153], v[18:19], v[232:233] neg_lo:[1,0,0] neg_hi:[1,0,0]
    v_pk_mul_f32 v[232:233], v[232:233], v[168:169]
    v_cvt_pk_bf16_f32 v132, v232, v233
    v_pk_fma_f32 v[234:235], v[154:155], v[18:19], v[234:235] neg_lo:[1,0,0] neg_hi:[1,0,0]
    v_pk_mul_f32 v[234:235], v[234:235], v[170:171]
    v_cvt_pk_bf16_f32 v133, v234, v235
    v_pk_fma_f32 v[236:237], v[156:157], v[18:19], v[236:237] neg_lo:[1,0,0] neg_hi:[1,0,0]
    v_pk_mul_f32 v[236:237], v[236:237], v[172:173]
    v_cvt_pk_bf16_f32 v134, v236, v237
    v_pk_fma_f32 v[238:239], v[158:159], v[18:19], v[238:239] neg_lo:[1,0,0] neg_hi:[1,0,0]
    v_pk_mul_f32 v[238:239], v[238:239], v[174:175]
    v_cvt_pk_bf16_f32 v135, v238, v239
    v_pk_fma_f32 v[240:241], v[144:145], v[20:21], v[240:241] neg_lo:[1,0,0] neg_hi:[1,0,0]
    v_pk_mul_f32 v[240:241], v[240:241], v[160:161]
    v_cvt_pk_bf16_f32 v136, v240, v241
    v_pk_fma_f32 v[242:243], v[146:147], v[20:21], v[242:243] neg_lo:[1,0,0] neg_hi:[1,0,0]
    v_pk_mul_f32 v[242:243], v[242:243], v[162:163]
    v_cvt_pk_bf16_f32 v137, v242, v243
    v_pk_fma_f32 v[244:245], v[148:149], v[20:21], v[244:245] neg_lo:[1,0,0] neg_hi:[1,0,0]
    v_pk_mul_f32 v[244:245], v[244:245], v[164:165]
    v_cvt_pk_bf16_f32 v138, v244, v245
    v_pk_fma_f32 v[246:247], v[150:151], v[20:21], v[246:247] neg_lo:[1,0,0] neg_hi:[1,0,0]
    v_pk_mul_f32 v[246:247], v[246:247], v[166:167]
    v_cvt_pk_bf16_f32 v139, v246, v247
    v_pk_fma_f32 v[248:249], v[152:153], v[20:21], v[248:249] neg_lo:[1,0,0] neg_hi:[1,0,0]
    v_pk_mul_f32 v[248:249], v[248:249], v[168:169]
    v_cvt_pk_bf16_f32 v140, v248, v249
    v_pk_fma_f32 v[250:251], v[154:155], v[20:21], v[250:251] neg_lo:[1,0,0] neg_hi:[1,0,0]
    v_pk_mul_f32 v[250:251], v[250:251], v[170:171]
    v_cvt_pk_bf16_f32 v141, v250, v251
    v_pk_fma_f32 v[252:253], v[156:157], v[20:21], v[252:253] neg_lo:[1,0,0] neg_hi:[1,0,0]
    v_pk_mul_f32 v[252:253], v[252:253], v[172:173]
    v_cvt_pk_bf16_f32 v142, v252, v253
    v_pk_fma_f32 v[254:255], v[158:159], v[20:21], v[254:255] neg_lo:[1,0,0] neg_hi:[1,0,0]
    v_pk_mul_f32 v[254:255], v[254:255], v[174:175]
    v_cvt_pk_bf16_f32 v143, v254, v255
    s_nop 1
    v_mfma_f32_16x16x32_bf16 v[176:179], v[96:99], v[128:131], 0
    v_mfma_f32_16x16x32_bf16 v[180:183], v[104:107], v[136:139], 0
    v_mfma_f32_16x16x32_bf16 v[184:187], v[96:99], v[120:123], 0
    v_mfma_f32_16x16x32_bf16 v[188:191], v[112:115], v[128:131], 0
    v_mfma_f32_16x16x32_bf16 v[192:195], v[104:107], v[120:123], 0
    v_mfma_f32_16x16x32_bf16 v[196:199], v[112:115], v[136:139], 0
    v_mfma_f32_16x16x32_bf16 v[200:203], v[112:115], v[120:123], 0
    v_mfma_f32_16x16x32_bf16 v[176:179], v[100:103], v[132:135], v[176:179]
    v_mfma_f32_16x16x32_bf16 v[180:183], v[108:111], v[140:143], v[180:183]
    v_mfma_f32_16x16x32_bf16 v[184:187], v[100:103], v[124:127], v[184:187]
    v_mfma_f32_16x16x32_bf16 v[188:191], v[116:119], v[132:135], v[188:191]
    v_mfma_f32_16x16x32_bf16 v[192:195], v[108:111], v[124:127], v[192:195]
    v_mfma_f32_16x16x32_bf16 v[196:199], v[116:119], v[140:143], v[196:199]
    v_mfma_f32_16x16x32_bf16 v[200:203], v[116:119], v[124:127], v[200:203]
    s_waitcnt lgkmcnt(0)
    s_mov_b64 exec, 1
    ds_add_u32 v3, v30 offset:30728
    s_mov_b64 exec, -1
    v_and_b32 v41, 4, v1
    v_cmp_ne_u32 vcc, 0, v41
    v_and_b32 v41, 16, v1
    v_cmp_ne_u32 s[64:65], 0, v41
    s_lshl_b32 s27, s57, 12
    v_add_u32 v44, s27, v2
    s_lshl_b32 s27, s57, 2
    v_mov_b32 v29, s27

    v_cndmask_b32 v184, v184, v192, vcc
    v_cndmask_b32 v188, v188, v196, s[64:65]
    v_cndmask_b32 v185, v185, v193, vcc
    v_cndmask_b32 v189, v189, v197, s[64:65]
    v_cndmask_b32 v186, v186, v194, vcc
    v_cndmask_b32 v190, v190, v198, s[64:65]
    v_cndmask_b32 v187, v187, v195, vcc
    v_cndmask_b32 v191, v191, v199, s[64:65]
    s_nop 1
    v_permlane32_swap_b32 v188, v200
    v_permlane32_swap_b32 v189, v201
    v_permlane32_swap_b32 v190, v202
    v_permlane32_swap_b32 v191, v203
    s_cmp_eq_u32 s56, 0
    s_cbranch_scc1 KV_RG0
    ds_write_b128 v44, v[176:179] offset:16384
    ds_write_b128 v44, v[180:183] offset:17408
    ds_write_b128 v44, v[184:187] offset:18432
    ds_write_b128 v44, v[188:191] offset:19456
    s_waitcnt lgkmcnt(0)
    s_mov_b64 exec, 1
    ds_add_u32 v29, v30 offset:30720
    s_mov_b64 exec, -1
    v_bfe_u32 v44, v1, 2, 3
    v_lshrrev_b32 v46, 5, v1
    v_lshl_add_u32 v44, v46, 4, v44
    v_mul_u32_u24 v44, 160, v44

    v_add_u32 v44, 61440, v44
    v_and_b32 v46, 3, v1
    s_mul_i32 s29, s57, 80
    v_lshl_add_u32 v8, v46, 3, v44
    v_add_u32 v8, s29, v8
    v_add_u32 v9, 51200, v8
    v_mul_u32_u24 v46, 40, v46
    s_mul_i32 s29, s57, 5120
    s_add_u32 s29, s29, 32
    v_add3_u32 v10, v46, v44, s29
    v_add_u32 v11, 51200, v10

LS_32:
    ds_read_b32 v34, v3 offset:30728
    s_waitcnt lgkmcnt(0)
    v_readfirstlane_b32 s27, v34
    s_nop 1
    s_cmp_ge_u32 s27, 8
    s_cbranch_scc1 LS_32_D
    s_sleep 2
    s_branch LS_32

LS_32_D:
    ds_read_b64_tr_b16 v[44:45], v8 offset:0
    ds_read_b64_tr_b16 v[46:47], v8 offset:1280
    ds_read_b64_tr_b16 v[48:49], v8 offset:40
    ds_read_b64_tr_b16 v[50:51], v8 offset:1320
    ds_read_b64_tr_b16 v[52:53], v10 offset:0
    ds_read_b64_tr_b16 v[54:55], v10 offset:1280
    ds_read_b64_tr_b16 v[56:57], v8 offset:5120
    ds_read_b64_tr_b16 v[58:59], v8 offset:6400
    ds_read_b64_tr_b16 v[60:61], v8 offset:5160
    ds_read_b64_tr_b16 v[62:63], v8 offset:6440
    ds_read_b64_tr_b16 v[64:65], v8 offset:10240
    ds_read_b64_tr_b16 v[66:67], v8 offset:11520
    ds_read_b64_tr_b16 v[68:69], v8 offset:10280
    ds_read_b64_tr_b16 v[70:71], v8 offset:11560
    s_waitcnt lgkmcnt(12)
    v_mfma_f32_16x16x32_bf16 v[12:15], v[24:27], v[44:47], 0
    ds_read_b64_tr_b16 v[72:73], v10 offset:10240
    ds_read_b64_tr_b16 v[74:75], v10 offset:11520
    s_waitcnt lgkmcnt(12)
    v_mfma_f32_16x16x32_bf16 v[16:19], v[24:27], v[48:51], 0
    ds_read_b64_tr_b16 v[44:45], v8 offset:15360
    ds_read_b64_tr_b16 v[46:47], v8 offset:16640
    s_waitcnt lgkmcnt(12)
    v_mfma_f32_16x16x32_bf16 v[20:23], v[24:27], v[52:55], 0
    ds_read_b64_tr_b16 v[48:49], v8 offset:15400
    ds_read_b64_tr_b16 v[50:51], v8 offset:16680
    s_waitcnt lgkmcnt(12)
    v_mfma_f32_16x16x32_bf16 v[12:15], v[24:27], v[56:59], v[12:15]
    ds_read_b64_tr_b16 v[52:53], v8 offset:20480
    ds_read_b64_tr_b16 v[54:55], v8 offset:21760
    s_waitcnt lgkmcnt(12)
    v_mfma_f32_16x16x32_bf16 v[16:19], v[24:27], v[60:63], v[16:19]
    ds_read_b64_tr_b16 v[56:57], v8 offset:20520
    ds_read_b64_tr_b16 v[58:59], v8 offset:21800
    s_waitcnt lgkmcnt(12)
    v_mfma_f32_16x16x32_bf16 v[12:15], v[24:27], v[64:67], v[12:15]
    ds_read_b64_tr_b16 v[60:61], v10 offset:20480
    ds_read_b64_tr_b16 v[62:63], v10 offset:21760
    s_waitcnt lgkmcnt(12)
    v_mfma_f32_16x16x32_bf16 v[16:19], v[24:27], v[68:71], v[16:19]
    ds_read_b64_tr_b16 v[64:65], v8 offset:25600
    ds_read_b64_tr_b16 v[66:67], v8 offset:26880
    s_waitcnt lgkmcnt(12)
    v_mfma_f32_16x16x32_bf16 v[20:23], v[24:27], v[72:75], v[20:23]
    ds_read_b64_tr_b16 v[68:69], v8 offset:25640
    ds_read_b64_tr_b16 v[70:71], v8 offset:26920
    s_waitcnt lgkmcnt(12)
    v_mfma_f32_16x16x32_bf16 v[12:15], v[24:27], v[44:47], v[12:15]
    ds_read_b64_tr_b16 v[72:73], v8 offset:30720
    ds_read_b64_tr_b16 v[74:75], v8 offset:32000
    s_waitcnt lgkmcnt(12)
    v_mfma_f32_16x16x32_bf16 v[16:19], v[24:27], v[48:51], v[16:19]
    ds_read_b64_tr_b16 v[44:45], v8 offset:30760
    ds_read_b64_tr_b16 v[46:47], v8 offset:32040
    s_waitcnt lgkmcnt(12)
    v_mfma_f32_16x16x32_bf16 v[12:15], v[24:27], v[52:55], v[12:15]
    ds_read_b64_tr_b16 v[48:49], v10 offset:30720
    ds_read_b64_tr_b16 v[50:51], v10 offset:32000
    s_waitcnt lgkmcnt(12)
    v_mfma_f32_16x16x32_bf16 v[16:19], v[24:27], v[56:59], v[16:19]
    ds_read_b64_tr_b16 v[52:53], v8 offset:35840
    ds_read_b64_tr_b16 v[54:55], v8 offset:37120
    s_waitcnt lgkmcnt(12)
    v_mfma_f32_16x16x32_bf16 v[20:23], v[24:27], v[60:63], v[20:23]
    ds_read_b64_tr_b16 v[56:57], v8 offset:35880
    ds_read_b64_tr_b16 v[58:59], v8 offset:37160
    s_waitcnt lgkmcnt(12)
    v_mfma_f32_16x16x32_bf16 v[12:15], v[24:27], v[64:67], v[12:15]
    ds_read_b64_tr_b16 v[60:61], v8 offset:40960
    ds_read_b64_tr_b16 v[62:63], v8 offset:42240
    s_waitcnt lgkmcnt(12)
    v_mfma_f32_16x16x32_bf16 v[16:19], v[24:27], v[68:71], v[16:19]
    ds_read_b64_tr_b16 v[64:65], v8 offset:41000
    ds_read_b64_tr_b16 v[66:67], v8 offset:42280
    s_waitcnt lgkmcnt(12)
    v_mfma_f32_16x16x32_bf16 v[12:15], v[24:27], v[72:75], v[12:15]
    ds_read_b64_tr_b16 v[68:69], v10 offset:40960
    ds_read_b64_tr_b16 v[70:71], v10 offset:42240
    s_waitcnt lgkmcnt(12)
    v_mfma_f32_16x16x32_bf16 v[16:19], v[24:27], v[44:47], v[16:19]
    ds_read_b64_tr_b16 v[72:73], v8 offset:46080
    ds_read_b64_tr_b16 v[74:75], v8 offset:47360
    s_waitcnt lgkmcnt(12)
    v_mfma_f32_16x16x32_bf16 v[20:23], v[24:27], v[48:51], v[20:23]
    ds_read_b64_tr_b16 v[44:45], v8 offset:46120
    ds_read_b64_tr_b16 v[46:47], v8 offset:47400
    s_waitcnt lgkmcnt(12)
    v_mfma_f32_16x16x32_bf16 v[12:15], v[24:27], v[52:55], v[12:15]
    ds_read_b64_tr_b16 v[48:49], v9 offset:0
    ds_read_b64_tr_b16 v[50:51], v9 offset:1280
    s_waitcnt lgkmcnt(12)
    v_mfma_f32_16x16x32_bf16 v[16:19], v[24:27], v[56:59], v[16:19]
    ds_read_b64_tr_b16 v[52:53], v9 offset:40
    ds_read_b64_tr_b16 v[54:55], v9 offset:1320
    s_waitcnt lgkmcnt(12)
    v_mfma_f32_16x16x32_bf16 v[12:15], v[24:27], v[60:63], v[12:15]
    ds_read_b64_tr_b16 v[56:57], v11 offset:0
    ds_read_b64_tr_b16 v[58:59], v11 offset:1280
    s_waitcnt lgkmcnt(12)
    v_mfma_f32_16x16x32_bf16 v[16:19], v[24:27], v[64:67], v[16:19]
    ds_read_b64_tr_b16 v[60:61], v9 offset:5120
    ds_read_b64_tr_b16 v[62:63], v9 offset:6400
    s_waitcnt lgkmcnt(12)
    v_mfma_f32_16x16x32_bf16 v[20:23], v[24:27], v[68:71], v[20:23]
    ds_read_b64_tr_b16 v[64:65], v9 offset:5160
    ds_read_b64_tr_b16 v[66:67], v9 offset:6440
    s_waitcnt lgkmcnt(12)
    v_mfma_f32_16x16x32_bf16 v[12:15], v[24:27], v[72:75], v[12:15]
    ds_read_b64_tr_b16 v[68:69], v9 offset:10240
    ds_read_b64_tr_b16 v[70:71], v9 offset:11520
    s_waitcnt lgkmcnt(12)
    v_mfma_f32_16x16x32_bf16 v[16:19], v[24:27], v[44:47], v[16:19]
    ds_read_b64_tr_b16 v[72:73], v9 offset:10280
    ds_read_b64_tr_b16 v[74:75], v9 offset:11560
    s_waitcnt lgkmcnt(12)
    v_mfma_f32_16x16x32_bf16 v[12:15], v[24:27], v[48:51], v[12:15]
    ds_read_b64_tr_b16 v[44:45], v11 offset:10240
    ds_read_b64_tr_b16 v[46:47], v11 offset:11520
    s_waitcnt lgkmcnt(12)
    v_mfma_f32_16x16x32_bf16 v[16:19], v[24:27], v[52:55], v[16:19]
    ds_read_b64_tr_b16 v[48:49], v9 offset:15360
    ds_read_b64_tr_b16 v[50:51], v9 offset:16640
    s_waitcnt lgkmcnt(12)
    v_mfma_f32_16x16x32_bf16 v[20:23], v[24:27], v[56:59], v[20:23]
    ds_read_b64_tr_b16 v[52:53], v9 offset:15400
    ds_read_b64_tr_b16 v[54:55], v9 offset:16680
    s_waitcnt lgkmcnt(12)
    v_mfma_f32_16x16x32_bf16 v[12:15], v[24:27], v[60:63], v[12:15]
    ds_read_b64_tr_b16 v[56:57], v9 offset:20480
    ds_read_b64_tr_b16 v[58:59], v9 offset:21760
    s_waitcnt lgkmcnt(12)
    v_mfma_f32_16x16x32_bf16 v[16:19], v[24:27], v[64:67], v[16:19]
    ds_read_b64_tr_b16 v[60:61], v9 offset:20520
    ds_read_b64_tr_b16 v[62:63], v9 offset:21800
    s_waitcnt lgkmcnt(12)
    v_mfma_f32_16x16x32_bf16 v[12:15], v[24:27], v[68:71], v[12:15]
    ds_read_b64_tr_b16 v[64:65], v11 offset:20480
    ds_read_b64_tr_b16 v[66:67], v11 offset:21760
    s_waitcnt lgkmcnt(12)
    v_mfma_f32_16x16x32_bf16 v[16:19], v[24:27], v[72:75], v[16:19]
    ds_read_b64_tr_b16 v[68:69], v9 offset:25600
    ds_read_b64_tr_b16 v[70:71], v9 offset:26880
    s_waitcnt lgkmcnt(12)
    v_mfma_f32_16x16x32_bf16 v[20:23], v[24:27], v[44:47], v[20:23]
    ds_read_b64_tr_b16 v[72:73], v9 offset:25640
    ds_read_b64_tr_b16 v[74:75], v9 offset:26920
    s_waitcnt lgkmcnt(12)
    v_mfma_f32_16x16x32_bf16 v[12:15], v[24:27], v[48:51], v[12:15]
    ds_read_b64_tr_b16 v[44:45], v9 offset:30720
    ds_read_b64_tr_b16 v[46:47], v9 offset:32000
    s_waitcnt lgkmcnt(12)
    v_mfma_f32_16x16x32_bf16 v[16:19], v[24:27], v[52:55], v[16:19]
    ds_read_b64_tr_b16 v[48:49], v9 offset:30760
    ds_read_b64_tr_b16 v[50:51], v9 offset:32040
    s_waitcnt lgkmcnt(12)
    v_mfma_f32_16x16x32_bf16 v[12:15], v[24:27], v[56:59], v[12:15]
    ds_read_b64_tr_b16 v[52:53], v11 offset:30720
    ds_read_b64_tr_b16 v[54:55], v11 offset:32000
    s_waitcnt lgkmcnt(12)
    v_mfma_f32_16x16x32_bf16 v[16:19], v[24:27], v[60:63], v[16:19]
    ds_read_b64_tr_b16 v[56:57], v9 offset:35840
    ds_read_b64_tr_b16 v[58:59], v9 offset:37120
    s_waitcnt lgkmcnt(12)
    v_mfma_f32_16x16x32_bf16 v[20:23], v[24:27], v[64:67], v[20:23]
    ds_read_b64_tr_b16 v[60:61], v9 offset:35880
    ds_read_b64_tr_b16 v[62:63], v9 offset:37160
    s_waitcnt lgkmcnt(12)
    v_mfma_f32_16x16x32_bf16 v[12:15], v[24:27], v[68:71], v[12:15]
    ds_read_b64_tr_b16 v[64:65], v9 offset:40960
    ds_read_b64_tr_b16 v[66:67], v9 offset:42240
    s_waitcnt lgkmcnt(12)
    v_mfma_f32_16x16x32_bf16 v[16:19], v[24:27], v[72:75], v[16:19]
    ds_read_b64_tr_b16 v[68:69], v9 offset:41000
    ds_read_b64_tr_b16 v[70:71], v9 offset:42280
    s_waitcnt lgkmcnt(12)
    v_mfma_f32_16x16x32_bf16 v[12:15], v[24:27], v[44:47], v[12:15]
    ds_read_b64_tr_b16 v[72:73], v11 offset:40960
    ds_read_b64_tr_b16 v[74:75], v11 offset:42240
    s_waitcnt lgkmcnt(12)
    v_mfma_f32_16x16x32_bf16 v[16:19], v[24:27], v[48:51], v[16:19]
    ds_read_b64_tr_b16 v[44:45], v9 offset:46080
    ds_read_b64_tr_b16 v[46:47], v9 offset:47360
    s_waitcnt lgkmcnt(12)
    v_mfma_f32_16x16x32_bf16 v[20:23], v[24:27], v[52:55], v[20:23]
    ds_read_b64_tr_b16 v[48:49], v9 offset:46120
    ds_read_b64_tr_b16 v[50:51], v9 offset:47400
    s_waitcnt lgkmcnt(12)
    v_mfma_f32_16x16x32_bf16 v[12:15], v[24:27], v[56:59], v[12:15]
    s_waitcnt lgkmcnt(10)
    v_mfma_f32_16x16x32_bf16 v[16:19], v[24:27], v[60:63], v[16:19]
    s_waitcnt lgkmcnt(8)
    v_mfma_f32_16x16x32_bf16 v[12:15], v[24:27], v[64:67], v[12:15]
    s_waitcnt lgkmcnt(6)
    v_mfma_f32_16x16x32_bf16 v[16:19], v[24:27], v[68:71], v[16:19]
    s_waitcnt lgkmcnt(4)
    v_mfma_f32_16x16x32_bf16 v[20:23], v[24:27], v[72:75], v[20:23]
    s_waitcnt lgkmcnt(2)
    v_mfma_f32_16x16x32_bf16 v[12:15], v[24:27], v[44:47], v[12:15]
    s_waitcnt lgkmcnt(0)
    v_mfma_f32_16x16x32_bf16 v[16:19], v[24:27], v[48:51], v[16:19]
    v_and_b32 v40, 15, v1
    v_lshlrev_b32 v40, 2, v40
    s_lshl_b32 s27, s57, 7
    v_add_u32 v41, s27, v40
    s_lshl_b32 s27, s57, 6
    v_add_u32 v42, s27, v40
    s_nop 3
    ds_write_b32 v41, v12 offset:26112
    ds_write_b32 v41, v16 offset:26176
    ds_write_b32 v42, v20 offset:26368

    s_waitcnt lgkmcnt(0)
    s_mov_b64 exec, 1
    ds_add_u32 v3, v30 offset:30744
    s_mov_b64 exec, -1
    s_branch KV_JOIN
KV_RG0:
    s_lshl_b32 s29, s66, 4
    s_add_u32 s29, s29, s25
    s_lshl_b32 s30, s29, 7
    s_add_u32 s30, s30, 14942208
    s_lshl_b32 s29, s29, 11
    s_add_u32 s29, s29, 12582912

LS_33:
    ds_read_b32 v34, v29 offset:30720
    s_waitcnt lgkmcnt(0)
    v_readfirstlane_b32 s27, v34
    s_nop 1
    s_cmp_ge_u32 s27, 1
    s_cbranch_scc1 LS_33_D
    s_sleep 2
    s_branch LS_33

LS_33_D:
    ds_read_b128 v[96:99], v44 offset:16384
    ds_read_b128 v[100:103], v44 offset:17408
    ds_read_b128 v[104:107], v44 offset:18432
    ds_read_b128 v[108:111], v44 offset:19456
    s_waitcnt lgkmcnt(0)
    v_add_f32 v176, v176, v96
    v_add_f32 v177, v177, v97
    v_add_f32 v178, v178, v98
    v_add_f32 v179, v179, v99
    v_add_f32 v180, v180, v100
    v_add_f32 v181, v181, v101
    v_add_f32 v182, v182, v102
    v_add_f32 v183, v183, v103
    v_add_f32 v184, v184, v104
    v_add_f32 v185, v185, v105
    v_add_f32 v186, v186, v106
    v_add_f32 v187, v187, v107
    v_add_f32 v188, v188, v108
    v_add_f32 v189, v189, v109
    v_add_f32 v190, v190, v110
    v_add_f32 v191, v191, v111
    v_cvt_pk_bf16_f32 v112, v176, v177
    v_cvt_pk_bf16_f32 v113, v178, v179
    v_cvt_pk_bf16_f32 v114, v180, v181
    v_cvt_pk_bf16_f32 v115, v182, v183
    v_cvt_pk_bf16_f32 v116, v184, v185
    v_cvt_pk_bf16_f32 v117, v186, v187
    v_cvt_pk_bf16_f32 v118, v188, v189
    v_cvt_pk_bf16_f32 v119, v190, v191
    buffer_store_dwordx4 v[112:115], v2, s[40:43], s29 offen sc1
    buffer_store_dwordx4 v[116:119], v2, s[40:43], s29 offen offset:1024 sc1

    s_mov_b32 s27, 14974976
    buffer_load_dwordx4 v[48:51], v2, s[40:43], s27 offen sc1
    buffer_load_dwordx4 v[52:55], v2, s[40:43], s27 offen offset:1024 sc1
    s_waitcnt vmcnt(2)
    s_mov_b64 exec, 1
    buffer_store_dwordx2 v[32:33], v3, s[40:43], s30 offen sc1
    s_mov_b64 exec, -1

    s_waitcnt vmcnt(1)
    s_mov_b32 s79, 200000
RF_34:
    v_cmp_ne_u64 vcc, s[58:59], v[48:49]
    v_cmp_ne_u64 s[60:61], s[58:59], v[50:51]
    v_cmp_ne_u64 s[62:63], s[58:59], v[52:53]
    s_or_b64 s[60:61], s[60:61], vcc
    v_cmp_ne_u64 vcc, s[58:59], v[54:55]
    s_or_b64 s[60:61], s[60:61], s[62:63]
    s_nop 0
    s_or_b64 s[60:61], s[60:61], vcc
    s_cbranch_scc0 RFOK_35
    s_sub_u32 s79, s79, 1
    s_cbranch_scc1 RFOK_35
    s_sleep 16

    s_mov_b32 s27, 14974976
    buffer_load_dwordx4 v[48:51], v2, s[40:43], s27 offen sc1
    buffer_load_dwordx4 v[52:55], v2, s[40:43], s27 offen offset:1024 sc1
    s_waitcnt vmcnt(0)
    s_branch RF_34
RFOK_35:
    s_waitcnt lgkmcnt(0)
    s_mov_b64 exec, 1
    ds_add_u32 v3, v30 offset:30732
    s_mov_b64 exec, -1
KV_JOIN:
LS_36:
    ds_read_b32 v34, v3 offset:30732
    s_waitcnt lgkmcnt(0)
    v_readfirstlane_b32 s27, v34
    s_nop 1
    s_cmp_ge_u32 s27, 1
    s_cbranch_scc1 LS_36_D
    s_sleep 2
    s_branch LS_36

LS_36_D:
    s_add_u32 s27, s72, 0
    buffer_load_dwordx4 v[56:59], v2, s[40:43], s27 offen sc1
    s_add_u32 s27, s72, 1024
    buffer_load_dwordx4 v[60:63], v2, s[40:43], s27 offen sc1
    s_add_u32 s27, s72, 2048
    buffer_load_dwordx4 v[64:67], v2, s[40:43], s27 offen sc1
    s_add_u32 s27, s72, 3072
    buffer_load_dwordx4 v[68:71], v2, s[40:43], s27 offen sc1
    s_add_u32 s27, s72, 4096
    buffer_load_dwordx4 v[72:75], v2, s[40:43], s27 offen sc1
    s_add_u32 s27, s72, 40960
    buffer_load_dwordx4 v[76:79], v2, s[40:43], s27 offen sc1
    s_add_u32 s27, s72, 41984
    buffer_load_dwordx4 v[80:83], v2, s[40:43], s27 offen sc1
    s_add_u32 s27, s72, 43008
    buffer_load_dwordx4 v[84:87], v2, s[40:43], s27 offen sc1
    s_add_u32 s27, s72, 44032
    buffer_load_dwordx4 v[88:91], v2, s[40:43], s27 offen sc1
    s_add_u32 s27, s72, 45056
    buffer_load_dwordx4 v[92:95], v2, s[40:43], s27 offen sc1
    s_add_u32 s27, s72, 81920
    buffer_load_dwordx4 v[96:99], v2, s[40:43], s27 offen sc1
    s_add_u32 s27, s72, 82944
    buffer_load_dwordx4 v[100:103], v2, s[40:43], s27 offen sc1
    s_add_u32 s27, s72, 83968
    buffer_load_dwordx4 v[104:107], v2, s[40:43], s27 offen sc1
    s_add_u32 s27, s72, 84992
    buffer_load_dwordx4 v[108:111], v2, s[40:43], s27 offen sc1
    s_add_u32 s27, s72, 86016
    buffer_load_dwordx4 v[112:115], v2, s[40:43], s27 offen sc1
    s_add_u32 s27, s72, 122880
    buffer_load_dwordx4 v[116:119], v2, s[40:43], s27 offen sc1
    s_add_u32 s27, s72, 123904
    buffer_load_dwordx4 v[120:123], v2, s[40:43], s27 offen sc1
    s_add_u32 s27, s72, 124928
    buffer_load_dwordx4 v[124:127], v2, s[40:43], s27 offen sc1
    s_add_u32 s27, s72, 125952
    buffer_load_dwordx4 v[128:131], v2, s[40:43], s27 offen sc1
    s_add_u32 s27, s72, 126976
    buffer_load_dwordx4 v[132:135], v2, s[40:43], s27 offen sc1
    s_add_u32 s27, s73, 0
    buffer_load_dwordx4 v[136:139], v2, s[40:43], s27 offen sc1
    s_add_u32 s27, s73, 1024
    buffer_load_dwordx4 v[140:143], v2, s[40:43], s27 offen sc1
    s_add_u32 s27, s73, 2048
    buffer_load_dwordx4 v[144:147], v2, s[40:43], s27 offen sc1
    s_add_u32 s27, s73, 3072
    buffer_load_dwordx4 v[148:151], v2, s[40:43], s27 offen sc1
    s_add_u32 s27, s73, 4096
    buffer_load_dwordx4 v[152:155], v2, s[40:43], s27 offen sc1
    s_add_u32 s27, s73, 40960
    buffer_load_dwordx4 v[156:159], v2, s[40:43], s27 offen sc1
    s_add_u32 s27, s73, 41984
    buffer_load_dwordx4 v[160:163], v2, s[40:43], s27 offen sc1
    s_add_u32 s27, s73, 43008
    buffer_load_dwordx4 v[164:167], v2, s[40:43], s27 offen sc1
    s_add_u32 s27, s73, 44032
    buffer_load_dwordx4 v[168:171], v2, s[40:43], s27 offen sc1
    s_add_u32 s27, s73, 45056
    buffer_load_dwordx4 v[172:175], v2, s[40:43], s27 offen sc1
LS_37:
    ds_read_b32 v34, v3 offset:30744
    s_waitcnt lgkmcnt(0)
    v_readfirstlane_b32 s27, v34
    s_nop 1
    s_cmp_ge_u32 s27, 2
    s_cbranch_scc1 LS_37_D
    s_sleep 2
    s_branch LS_37

LS_37_D:
    s_add_u32 s65, s72, 163840
    s_mul_i32 s67, s83, 81920
    s_add_u32 s67, s67, s82
    s_add_u32 s67, s67, 1966080
    s_and_b32 s69, s83, 3
    s_mul_i32 s69, s69, 40960
    s_add_u32 s69, s69, s82
    s_add_u32 s69, s69, 2621440

    s_lshl_b32 s76, s24, 12
    s_add_u32 m0, s76, 32768
    s_add_u32 s27, s65, 40960
    buffer_load_dwordx4 v2, s[40:43], s27 offen sc1 lds
    s_add_u32 m0, s76, 33792
    s_add_u32 s27, s65, 41984
    buffer_load_dwordx4 v2, s[40:43], s27 offen sc1 lds
    s_add_u32 m0, s76, 34816
    s_add_u32 s27, s65, 43008
    buffer_load_dwordx4 v2, s[40:43], s27 offen sc1 lds
    s_add_u32 m0, s76, 35840
    s_add_u32 s27, s65, 44032
    buffer_load_dwordx4 v2, s[40:43], s27 offen sc1 lds
LS_38:
    ds_read_b32 v34, v3 offset:30740
    s_waitcnt lgkmcnt(0)
    v_readfirstlane_b32 s27, v34
    s_nop 1
    s_cmp_ge_u32 s27, 4
    s_cbranch_scc1 LS_38_D
    s_sleep 2
    s_branch LS_38

LS_38_D:
    s_add_u32 m0, s76, 49152
    s_add_u32 s27, s65, 45056
    buffer_load_dwordx4 v2, s[40:43], s27 offen sc1 lds
    s_add_u32 m0, s76, 50176
    s_add_u32 s27, s67, 0
    buffer_load_dwordx4 v2, s[40:43], s27 offen sc1 lds
    s_add_u32 m0, s76, 51200
    s_add_u32 s27, s67, 1024
    buffer_load_dwordx4 v2, s[40:43], s27 offen sc1 lds
    s_add_u32 m0, s76, 52224
    s_add_u32 s27, s67, 2048
    buffer_load_dwordx4 v2, s[40:43], s27 offen sc1 lds
    s_add_u32 m0, s76, 65536
    s_add_u32 s27, s67, 3072
    buffer_load_dwordx4 v2, s[40:43], s27 offen sc1 lds
    s_add_u32 m0, s76, 66560
    s_add_u32 s27, s67, 4096
    buffer_load_dwordx4 v2, s[40:43], s27 offen sc1 lds
    s_add_u32 m0, s76, 67584
    s_add_u32 s27, s67, 40960
    buffer_load_dwordx4 v2, s[40:43], s27 offen sc1 lds
    s_add_u32 m0, s76, 68608
    s_add_u32 s27, s67, 41984
    buffer_load_dwordx4 v2, s[40:43], s27 offen sc1 lds
    s_add_u32 m0, s76, 81920
    s_add_u32 s27, s67, 43008
    buffer_load_dwordx4 v2, s[40:43], s27 offen sc1 lds
    s_add_u32 m0, s76, 82944
    s_add_u32 s27, s67, 44032
    buffer_load_dwordx4 v2, s[40:43], s27 offen sc1 lds
    s_add_u32 m0, s76, 83968
    s_add_u32 s27, s67, 45056
    buffer_load_dwordx4 v2, s[40:43], s27 offen sc1 lds
    s_add_u32 m0, s76, 84992
    s_add_u32 s27, s69, 0
    buffer_load_dwordx4 v2, s[40:43], s27 offen sc1 lds
    s_add_u32 m0, s76, 131072
    s_add_u32 s27, s69, 1024
    buffer_load_dwordx4 v2, s[40:43], s27 offen sc1 lds
    s_add_u32 m0, s76, 132096
    s_add_u32 s27, s69, 2048
    buffer_load_dwordx4 v2, s[40:43], s27 offen sc1 lds
    s_add_u32 m0, s76, 133120
    s_add_u32 s27, s69, 3072
    buffer_load_dwordx4 v2, s[40:43], s27 offen sc1 lds
    s_add_u32 m0, s76, 134144
    s_add_u32 s27, s69, 4096
    buffer_load_dwordx4 v2, s[40:43], s27 offen sc1 lds
    s_mov_b32 s75, 30740
    s_mov_b32 s71, 30748
    s_branch P2_E
Q_TAIL:
    s_setprio 0
    s_add_u32 s30, s75, 0
    s_cmp_ge_u32 s30, 5
    s_cselect_b32 s29, 5, 0
    s_sub_u32 s30, s30, s29
    s_mul_i32 s30, s30, 491520
    s_add_u32 m0, s66, 0
    s_nop 0
    buffer_load_dwordx4 v25, s[36:39], s30 offen lds
    s_add_u32 m0, s66, 4096
    s_nop 0
    buffer_load_dwordx4 v26, s[36:39], s30 offen lds
    s_add_u32 m0, s66, 8192
    s_nop 0
    buffer_load_dwordx4 v27, s[36:39], s30 offen lds
    s_add_u32 m0, s66, 12288
    s_nop 0
    buffer_load_dwordx4 v28, s[36:39], s30 offen lds
    s_add_u32 m0, s66, 16384
    s_nop 0
    buffer_load_dwordx4 v29, s[36:39], s30 offen lds
    s_add_u32 s30, s75, 1
    s_cmp_ge_u32 s30, 5
    s_cselect_b32 s29, 5, 0
    s_sub_u32 s30, s30, s29
    s_mul_i32 s30, s30, 491520
    s_add_u32 m0, s66, 20480
    s_nop 0
    buffer_load_dwordx4 v25, s[36:39], s30 offen lds
    s_add_u32 m0, s66, 24576
    s_nop 0
    buffer_load_dwordx4 v26, s[36:39], s30 offen lds
    s_add_u32 m0, s66, 28672
    s_nop 0
    buffer_load_dwordx4 v27, s[36:39], s30 offen lds
    s_add_u32 m0, s66, 32768
    s_nop 0
    buffer_load_dwordx4 v28, s[36:39], s30 offen lds
    s_add_u32 m0, s66, 36864
    s_nop 0
    buffer_load_dwordx4 v29, s[36:39], s30 offen lds
    s_add_u32 s30, s75, 2
    s_cmp_ge_u32 s30, 5
    s_cselect_b32 s29, 5, 0
    s_sub_u32 s30, s30, s29
    s_mul_i32 s30, s30, 491520
    s_add_u32 m0, s66, 40960
    s_nop 0
    buffer_load_dwordx4 v25, s[36:39], s30 offen lds
    s_add_u32 m0, s66, 45056
    s_nop 0
    buffer_load_dwordx4 v26, s[36:39], s30 offen lds
    s_add_u32 m0, s66, 49152
    s_nop 0
    buffer_load_dwordx4 v27, s[36:39], s30 offen lds
    s_add_u32 m0, s66, 53248
    s_nop 0
    buffer_load_dwordx4 v28, s[36:39], s30 offen lds
    s_add_u32 m0, s66, 57344
    s_nop 0
    buffer_load_dwordx4 v29, s[36:39], s30 offen lds
    s_add_u32 s30, s75, 3
    s_cmp_ge_u32 s30, 5
    s_cselect_b32 s29, 5, 0
    s_sub_u32 s30, s30, s29
    s_mul_i32 s30, s30, 491520
    s_add_u32 m0, s66, 61440
    s_nop 0
    buffer_load_dwordx4 v25, s[36:39], s30 offen lds
    s_add_u32 m0, s66, 65536
    s_nop 0
    buffer_load_dwordx4 v26, s[36:39], s30 offen lds
    s_add_u32 m0, s66, 69632
    s_nop 0
    buffer_load_dwordx4 v27, s[36:39], s30 offen lds
    v_bfe_u32 v40, v1, 2, 3
    v_lshrrev_b32 v41, 5, v1
    v_lshl_add_u32 v40, v41, 4, v40
    v_mul_u32_u24 v40, 160, v40

    v_mov_b32 v7, 1
    v_add_u32 v40, 61440, v40
    v_and_b32 v41, 3, v1
    v_lshl_add_u32 v12, v41, 3, v40
    v_add_u32 v13, 51200, v12
    v_mul_u32_u24 v42, 40, v41
    v_add3_u32 v14, v42, v40, 32
    v_add_u32 v15, 51200, v14
    s_waitcnt vmcnt(0)

    s_waitcnt lgkmcnt(0)
    s_mov_b64 exec, 1
    ds_add_u32 v3, v7 offset:30728
    s_mov_b64 exec, -1
LS_47:
    ds_read_b32 v40, v3 offset:30728
    s_waitcnt lgkmcnt(0)
    v_readfirstlane_b32 s27, v40
    s_nop 1
    s_cmp_ge_u32 s27, 8
    s_cbranch_scc1 LS_47_D
    s_sleep 2
    s_branch LS_47

LS_47_D:
    s_setprio 0
    ds_read_b64_tr_b16 v[56:57], v12 offset:0
    ds_read_b64_tr_b16 v[58:59], v12 offset:1280
    ds_read_b64_tr_b16 v[60:61], v12 offset:40
    ds_read_b64_tr_b16 v[62:63], v12 offset:1320
    ds_read_b64_tr_b16 v[64:65], v12 offset:80
    ds_read_b64_tr_b16 v[66:67], v12 offset:1360
    ds_read_b64_tr_b16 v[68:69], v12 offset:120
    ds_read_b64_tr_b16 v[70:71], v12 offset:1400
    ds_read_b64_tr_b16 v[72:73], v14 offset:0
    ds_read_b64_tr_b16 v[74:75], v14 offset:1280
    s_waitcnt lgkmcnt(8)
    v_mfma_f32_16x16x32_bf16 v[16:19], v[56:59], v[96:99], 0
    ds_read_b64_tr_b16 v[76:77], v12 offset:5120
    v_mfma_f32_16x16x32_bf16 v[20:23], v[56:59], v[100:103], 0
    ds_read_b64_tr_b16 v[78:79], v12 offset:6400
    s_waitcnt lgkmcnt(8)
    v_mfma_f32_16x16x32_bf16 v[24:27], v[60:63], v[96:99], 0
    ds_read_b64_tr_b16 v[80:81], v12 offset:5160
    v_mfma_f32_16x16x32_bf16 v[28:31], v[60:63], v[100:103], 0
    ds_read_b64_tr_b16 v[82:83], v12 offset:6440
    s_waitcnt lgkmcnt(8)
    v_mfma_f32_16x16x32_bf16 v[32:35], v[64:67], v[96:99], 0
    ds_read_b64_tr_b16 v[84:85], v12 offset:5200
    v_mfma_f32_16x16x32_bf16 v[36:39], v[64:67], v[100:103], 0
    ds_read_b64_tr_b16 v[86:87], v12 offset:6480
    s_waitcnt lgkmcnt(8)
    v_mfma_f32_16x16x32_bf16 v[40:43], v[68:71], v[96:99], 0
    ds_read_b64_tr_b16 v[88:89], v12 offset:5240
    v_mfma_f32_16x16x32_bf16 v[44:47], v[68:71], v[100:103], 0
    ds_read_b64_tr_b16 v[90:91], v12 offset:6520
    s_waitcnt lgkmcnt(8)
    v_mfma_f32_16x16x32_bf16 v[48:51], v[72:75], v[96:99], 0
    ds_read_b64_tr_b16 v[92:93], v14 offset:5120
    v_mfma_f32_16x16x32_bf16 v[52:55], v[72:75], v[100:103], 0
    ds_read_b64_tr_b16 v[94:95], v14 offset:6400
    s_waitcnt lgkmcnt(8)
    v_mfma_f32_16x16x32_bf16 v[16:19], v[76:79], v[104:107], v[16:19]
    ds_read_b64_tr_b16 v[56:57], v12 offset:10240
    v_mfma_f32_16x16x32_bf16 v[20:23], v[76:79], v[108:111], v[20:23]
    ds_read_b64_tr_b16 v[58:59], v12 offset:11520
    s_waitcnt lgkmcnt(8)
    v_mfma_f32_16x16x32_bf16 v[24:27], v[80:83], v[104:107], v[24:27]
    ds_read_b64_tr_b16 v[60:61], v12 offset:10280
    v_mfma_f32_16x16x32_bf16 v[28:31], v[80:83], v[108:111], v[28:31]
    ds_read_b64_tr_b16 v[62:63], v12 offset:11560
    s_waitcnt lgkmcnt(8)
    v_mfma_f32_16x16x32_bf16 v[32:35], v[84:87], v[104:107], v[32:35]
    ds_read_b64_tr_b16 v[64:65], v12 offset:10320
    v_mfma_f32_16x16x32_bf16 v[36:39], v[84:87], v[108:111], v[36:39]
    ds_read_b64_tr_b16 v[66:67], v12 offset:11600
    s_waitcnt lgkmcnt(8)
    v_mfma_f32_16x16x32_bf16 v[40:43], v[88:91], v[104:107], v[40:43]
    ds_read_b64_tr_b16 v[68:69], v12 offset:10360
    v_mfma_f32_16x16x32_bf16 v[44:47], v[88:91], v[108:111], v[44:47]
    ds_read_b64_tr_b16 v[70:71], v12 offset:11640
    s_waitcnt lgkmcnt(8)
    v_mfma_f32_16x16x32_bf16 v[48:51], v[92:95], v[104:107], v[48:51]
    ds_read_b64_tr_b16 v[72:73], v14 offset:10240
    v_mfma_f32_16x16x32_bf16 v[52:55], v[92:95], v[108:111], v[52:55]
    ds_read_b64_tr_b16 v[74:75], v14 offset:11520
    s_waitcnt lgkmcnt(8)
    v_mfma_f32_16x16x32_bf16 v[16:19], v[56:59], v[112:115], v[16:19]
    ds_read_b64_tr_b16 v[76:77], v12 offset:15360
    v_mfma_f32_16x16x32_bf16 v[20:23], v[56:59], v[116:119], v[20:23]
    ds_read_b64_tr_b16 v[78:79], v12 offset:16640
    s_waitcnt lgkmcnt(8)
    v_mfma_f32_16x16x32_bf16 v[24:27], v[60:63], v[112:115], v[24:27]
    ds_read_b64_tr_b16 v[80:81], v12 offset:15400
    v_mfma_f32_16x16x32_bf16 v[28:31], v[60:63], v[116:119], v[28:31]
    ds_read_b64_tr_b16 v[82:83], v12 offset:16680
    s_waitcnt lgkmcnt(8)
    v_mfma_f32_16x16x32_bf16 v[32:35], v[64:67], v[112:115], v[32:35]
    ds_read_b64_tr_b16 v[84:85], v12 offset:15440
    v_mfma_f32_16x16x32_bf16 v[36:39], v[64:67], v[116:119], v[36:39]
    ds_read_b64_tr_b16 v[86:87], v12 offset:16720
    s_waitcnt lgkmcnt(8)
    v_mfma_f32_16x16x32_bf16 v[40:43], v[68:71], v[112:115], v[40:43]
    ds_read_b64_tr_b16 v[88:89], v12 offset:15480
    v_mfma_f32_16x16x32_bf16 v[44:47], v[68:71], v[116:119], v[44:47]
    ds_read_b64_tr_b16 v[90:91], v12 offset:16760
    s_waitcnt lgkmcnt(8)
    v_mfma_f32_16x16x32_bf16 v[48:51], v[72:75], v[112:115], v[48:51]
    ds_read_b64_tr_b16 v[92:93], v14 offset:15360
    v_mfma_f32_16x16x32_bf16 v[52:55], v[72:75], v[116:119], v[52:55]
    ds_read_b64_tr_b16 v[94:95], v14 offset:16640
    s_waitcnt lgkmcnt(8)
    v_mfma_f32_16x16x32_bf16 v[16:19], v[76:79], v[120:123], v[16:19]
    ds_read_b64_tr_b16 v[56:57], v12 offset:20480
    v_mfma_f32_16x16x32_bf16 v[20:23], v[76:79], v[124:127], v[20:23]
    ds_read_b64_tr_b16 v[58:59], v12 offset:21760
    s_waitcnt lgkmcnt(8)
    v_mfma_f32_16x16x32_bf16 v[24:27], v[80:83], v[120:123], v[24:27]
    ds_read_b64_tr_b16 v[60:61], v12 offset:20520
    v_mfma_f32_16x16x32_bf16 v[28:31], v[80:83], v[124:127], v[28:31]
    ds_read_b64_tr_b16 v[62:63], v12 offset:21800
    s_waitcnt lgkmcnt(8)
    v_mfma_f32_16x16x32_bf16 v[32:35], v[84:87], v[120:123], v[32:35]
    ds_read_b64_tr_b16 v[64:65], v12 offset:20560
    v_mfma_f32_16x16x32_bf16 v[36:39], v[84:87], v[124:127], v[36:39]
    ds_read_b64_tr_b16 v[66:67], v12 offset:21840
    s_waitcnt lgkmcnt(8)
    v_mfma_f32_16x16x32_bf16 v[40:43], v[88:91], v[120:123], v[40:43]
    ds_read_b64_tr_b16 v[68:69], v12 offset:20600
    v_mfma_f32_16x16x32_bf16 v[44:47], v[88:91], v[124:127], v[44:47]
    ds_read_b64_tr_b16 v[70:71], v12 offset:21880
    s_waitcnt lgkmcnt(8)
    v_mfma_f32_16x16x32_bf16 v[48:51], v[92:95], v[120:123], v[48:51]
    ds_read_b64_tr_b16 v[72:73], v14 offset:20480
    v_mfma_f32_16x16x32_bf16 v[52:55], v[92:95], v[124:127], v[52:55]
    ds_read_b64_tr_b16 v[74:75], v14 offset:21760
    s_waitcnt lgkmcnt(8)
    v_mfma_f32_16x16x32_bf16 v[16:19], v[56:59], v[128:131], v[16:19]
    ds_read_b64_tr_b16 v[76:77], v12 offset:25600
    v_mfma_f32_16x16x32_bf16 v[20:23], v[56:59], v[132:135], v[20:23]
    ds_read_b64_tr_b16 v[78:79], v12 offset:26880
    s_waitcnt lgkmcnt(8)
    v_mfma_f32_16x16x32_bf16 v[24:27], v[60:63], v[128:131], v[24:27]
    ds_read_b64_tr_b16 v[80:81], v12 offset:25640
    v_mfma_f32_16x16x32_bf16 v[28:31], v[60:63], v[132:135], v[28:31]
    ds_read_b64_tr_b16 v[82:83], v12 offset:26920
    s_waitcnt lgkmcnt(8)
    v_mfma_f32_16x16x32_bf16 v[32:35], v[64:67], v[128:131], v[32:35]
    ds_read_b64_tr_b16 v[84:85], v12 offset:25680
    v_mfma_f32_16x16x32_bf16 v[36:39], v[64:67], v[132:135], v[36:39]
    ds_read_b64_tr_b16 v[86:87], v12 offset:26960
    s_waitcnt lgkmcnt(8)
    v_mfma_f32_16x16x32_bf16 v[40:43], v[68:71], v[128:131], v[40:43]
    ds_read_b64_tr_b16 v[88:89], v12 offset:25720
    v_mfma_f32_16x16x32_bf16 v[44:47], v[68:71], v[132:135], v[44:47]
    ds_read_b64_tr_b16 v[90:91], v12 offset:27000
    s_waitcnt lgkmcnt(8)
    v_mfma_f32_16x16x32_bf16 v[48:51], v[72:75], v[128:131], v[48:51]
    ds_read_b64_tr_b16 v[92:93], v14 offset:25600
    v_mfma_f32_16x16x32_bf16 v[52:55], v[72:75], v[132:135], v[52:55]
    ds_read_b64_tr_b16 v[94:95], v14 offset:26880
    s_waitcnt lgkmcnt(8)
    v_mfma_f32_16x16x32_bf16 v[16:19], v[76:79], v[136:139], v[16:19]
    ds_read_b64_tr_b16 v[56:57], v12 offset:30720
    v_mfma_f32_16x16x32_bf16 v[20:23], v[76:79], v[140:143], v[20:23]
    ds_read_b64_tr_b16 v[58:59], v12 offset:32000
    s_waitcnt lgkmcnt(8)
    v_mfma_f32_16x16x32_bf16 v[24:27], v[80:83], v[136:139], v[24:27]
    ds_read_b64_tr_b16 v[60:61], v12 offset:30760
    v_mfma_f32_16x16x32_bf16 v[28:31], v[80:83], v[140:143], v[28:31]
    ds_read_b64_tr_b16 v[62:63], v12 offset:32040
    s_waitcnt lgkmcnt(8)
    v_mfma_f32_16x16x32_bf16 v[32:35], v[84:87], v[136:139], v[32:35]
    ds_read_b64_tr_b16 v[64:65], v12 offset:30800
    v_mfma_f32_16x16x32_bf16 v[36:39], v[84:87], v[140:143], v[36:39]
    ds_read_b64_tr_b16 v[66:67], v12 offset:32080
    s_waitcnt lgkmcnt(8)
    v_mfma_f32_16x16x32_bf16 v[40:43], v[88:91], v[136:139], v[40:43]
    ds_read_b64_tr_b16 v[68:69], v12 offset:30840
    v_mfma_f32_16x16x32_bf16 v[44:47], v[88:91], v[140:143], v[44:47]
    ds_read_b64_tr_b16 v[70:71], v12 offset:32120
    s_waitcnt lgkmcnt(8)
    v_mfma_f32_16x16x32_bf16 v[48:51], v[92:95], v[136:139], v[48:51]
    ds_read_b64_tr_b16 v[72:73], v14 offset:30720
    v_mfma_f32_16x16x32_bf16 v[52:55], v[92:95], v[140:143], v[52:55]
    ds_read_b64_tr_b16 v[74:75], v14 offset:32000
    s_waitcnt lgkmcnt(8)
    v_mfma_f32_16x16x32_bf16 v[16:19], v[56:59], v[144:147], v[16:19]
    ds_read_b64_tr_b16 v[76:77], v12 offset:35840
    v_mfma_f32_16x16x32_bf16 v[20:23], v[56:59], v[148:151], v[20:23]
    ds_read_b64_tr_b16 v[78:79], v12 offset:37120
    s_waitcnt lgkmcnt(8)
    v_mfma_f32_16x16x32_bf16 v[24:27], v[60:63], v[144:147], v[24:27]
    ds_read_b64_tr_b16 v[80:81], v12 offset:35880
    v_mfma_f32_16x16x32_bf16 v[28:31], v[60:63], v[148:151], v[28:31]
    ds_read_b64_tr_b16 v[82:83], v12 offset:37160
    s_waitcnt lgkmcnt(8)
    v_mfma_f32_16x16x32_bf16 v[32:35], v[64:67], v[144:147], v[32:35]
    ds_read_b64_tr_b16 v[84:85], v12 offset:35920
    v_mfma_f32_16x16x32_bf16 v[36:39], v[64:67], v[148:151], v[36:39]
    ds_read_b64_tr_b16 v[86:87], v12 offset:37200
    s_waitcnt lgkmcnt(8)
    v_mfma_f32_16x16x32_bf16 v[40:43], v[68:71], v[144:147], v[40:43]
    ds_read_b64_tr_b16 v[88:89], v12 offset:35960
    v_mfma_f32_16x16x32_bf16 v[44:47], v[68:71], v[148:151], v[44:47]
    ds_read_b64_tr_b16 v[90:91], v12 offset:37240
    s_waitcnt lgkmcnt(8)
    v_mfma_f32_16x16x32_bf16 v[48:51], v[72:75], v[144:147], v[48:51]
    ds_read_b64_tr_b16 v[92:93], v14 offset:35840
    v_mfma_f32_16x16x32_bf16 v[52:55], v[72:75], v[148:151], v[52:55]
    ds_read_b64_tr_b16 v[94:95], v14 offset:37120
    s_waitcnt lgkmcnt(8)
    v_mfma_f32_16x16x32_bf16 v[16:19], v[76:79], v[152:155], v[16:19]
    ds_read_b64_tr_b16 v[56:57], v12 offset:40960
    v_mfma_f32_16x16x32_bf16 v[20:23], v[76:79], v[156:159], v[20:23]
    ds_read_b64_tr_b16 v[58:59], v12 offset:42240
    s_waitcnt lgkmcnt(8)
    v_mfma_f32_16x16x32_bf16 v[24:27], v[80:83], v[152:155], v[24:27]
    ds_read_b64_tr_b16 v[60:61], v12 offset:41000
    v_mfma_f32_16x16x32_bf16 v[28:31], v[80:83], v[156:159], v[28:31]
    ds_read_b64_tr_b16 v[62:63], v12 offset:42280
    s_waitcnt lgkmcnt(8)
    v_mfma_f32_16x16x32_bf16 v[32:35], v[84:87], v[152:155], v[32:35]
    ds_read_b64_tr_b16 v[64:65], v12 offset:41040
    v_mfma_f32_16x16x32_bf16 v[36:39], v[84:87], v[156:159], v[36:39]
    ds_read_b64_tr_b16 v[66:67], v12 offset:42320
    s_waitcnt lgkmcnt(8)
    v_mfma_f32_16x16x32_bf16 v[40:43], v[88:91], v[152:155], v[40:43]
    ds_read_b64_tr_b16 v[68:69], v12 offset:41080
    v_mfma_f32_16x16x32_bf16 v[44:47], v[88:91], v[156:159], v[44:47]
    ds_read_b64_tr_b16 v[70:71], v12 offset:42360
    s_waitcnt lgkmcnt(8)
    v_mfma_f32_16x16x32_bf16 v[48:51], v[92:95], v[152:155], v[48:51]
    ds_read_b64_tr_b16 v[72:73], v14 offset:40960
    v_mfma_f32_16x16x32_bf16 v[52:55], v[92:95], v[156:159], v[52:55]
    ds_read_b64_tr_b16 v[74:75], v14 offset:42240
    s_waitcnt lgkmcnt(8)
    v_mfma_f32_16x16x32_bf16 v[16:19], v[56:59], v[160:163], v[16:19]
    ds_read_b64_tr_b16 v[76:77], v12 offset:46080
    v_mfma_f32_16x16x32_bf16 v[20:23], v[56:59], v[164:167], v[20:23]
    ds_read_b64_tr_b16 v[78:79], v12 offset:47360
    s_waitcnt lgkmcnt(8)
    v_mfma_f32_16x16x32_bf16 v[24:27], v[60:63], v[160:163], v[24:27]
    ds_read_b64_tr_b16 v[80:81], v12 offset:46120
    v_mfma_f32_16x16x32_bf16 v[28:31], v[60:63], v[164:167], v[28:31]
    ds_read_b64_tr_b16 v[82:83], v12 offset:47400
    s_waitcnt lgkmcnt(8)
    v_mfma_f32_16x16x32_bf16 v[32:35], v[64:67], v[160:163], v[32:35]
    ds_read_b64_tr_b16 v[84:85], v12 offset:46160
    v_mfma_f32_16x16x32_bf16 v[36:39], v[64:67], v[164:167], v[36:39]
    ds_read_b64_tr_b16 v[86:87], v12 offset:47440
    s_waitcnt lgkmcnt(8)
    v_mfma_f32_16x16x32_bf16 v[40:43], v[68:71], v[160:163], v[40:43]
    ds_read_b64_tr_b16 v[88:89], v12 offset:46200
    v_mfma_f32_16x16x32_bf16 v[44:47], v[68:71], v[164:167], v[44:47]
    ds_read_b64_tr_b16 v[90:91], v12 offset:47480
    s_waitcnt lgkmcnt(8)
    v_mfma_f32_16x16x32_bf16 v[48:51], v[72:75], v[160:163], v[48:51]
    ds_read_b64_tr_b16 v[92:93], v14 offset:46080
    v_mfma_f32_16x16x32_bf16 v[52:55], v[72:75], v[164:167], v[52:55]
    ds_read_b64_tr_b16 v[94:95], v14 offset:47360
    s_waitcnt lgkmcnt(8)
    v_mfma_f32_16x16x32_bf16 v[16:19], v[76:79], v[168:171], v[16:19]
    ds_read_b64_tr_b16 v[56:57], v13 offset:0
    v_mfma_f32_16x16x32_bf16 v[20:23], v[76:79], v[172:175], v[20:23]
    ds_read_b64_tr_b16 v[58:59], v13 offset:1280
    s_waitcnt lgkmcnt(8)
    v_mfma_f32_16x16x32_bf16 v[24:27], v[80:83], v[168:171], v[24:27]
    ds_read_b64_tr_b16 v[60:61], v13 offset:40
    v_mfma_f32_16x16x32_bf16 v[28:31], v[80:83], v[172:175], v[28:31]
    ds_read_b64_tr_b16 v[62:63], v13 offset:1320
    s_waitcnt lgkmcnt(8)
    v_mfma_f32_16x16x32_bf16 v[32:35], v[84:87], v[168:171], v[32:35]
    ds_read_b64_tr_b16 v[64:65], v13 offset:80
    v_mfma_f32_16x16x32_bf16 v[36:39], v[84:87], v[172:175], v[36:39]
    ds_read_b64_tr_b16 v[66:67], v13 offset:1360
    s_waitcnt lgkmcnt(8)
    v_mfma_f32_16x16x32_bf16 v[40:43], v[88:91], v[168:171], v[40:43]
    ds_read_b64_tr_b16 v[68:69], v13 offset:120
    v_mfma_f32_16x16x32_bf16 v[44:47], v[88:91], v[172:175], v[44:47]
    ds_read_b64_tr_b16 v[70:71], v13 offset:1400
    s_waitcnt lgkmcnt(8)
    v_mfma_f32_16x16x32_bf16 v[48:51], v[92:95], v[168:171], v[48:51]
    ds_read_b64_tr_b16 v[72:73], v15 offset:0
    v_mfma_f32_16x16x32_bf16 v[52:55], v[92:95], v[172:175], v[52:55]
    ds_read_b64_tr_b16 v[74:75], v15 offset:1280
    s_waitcnt lgkmcnt(8)
    v_mfma_f32_16x16x32_bf16 v[16:19], v[56:59], v[176:179], v[16:19]
    ds_read_b64_tr_b16 v[76:77], v13 offset:5120
    v_mfma_f32_16x16x32_bf16 v[20:23], v[56:59], v[180:183], v[20:23]
    ds_read_b64_tr_b16 v[78:79], v13 offset:6400
    s_waitcnt lgkmcnt(8)
    v_mfma_f32_16x16x32_bf16 v[24:27], v[60:63], v[176:179], v[24:27]
    ds_read_b64_tr_b16 v[80:81], v13 offset:5160
    v_mfma_f32_16x16x32_bf16 v[28:31], v[60:63], v[180:183], v[28:31]
    ds_read_b64_tr_b16 v[82:83], v13 offset:6440
    s_waitcnt lgkmcnt(8)
    v_mfma_f32_16x16x32_bf16 v[32:35], v[64:67], v[176:179], v[32:35]
    ds_read_b64_tr_b16 v[84:85], v13 offset:5200
    v_mfma_f32_16x16x32_bf16 v[36:39], v[64:67], v[180:183], v[36:39]
    ds_read_b64_tr_b16 v[86:87], v13 offset:6480
    s_waitcnt lgkmcnt(8)
    v_mfma_f32_16x16x32_bf16 v[40:43], v[68:71], v[176:179], v[40:43]
    ds_read_b64_tr_b16 v[88:89], v13 offset:5240
    v_mfma_f32_16x16x32_bf16 v[44:47], v[68:71], v[180:183], v[44:47]
    ds_read_b64_tr_b16 v[90:91], v13 offset:6520
    s_waitcnt lgkmcnt(8)
    v_mfma_f32_16x16x32_bf16 v[48:51], v[72:75], v[176:179], v[48:51]
    ds_read_b64_tr_b16 v[92:93], v15 offset:5120
    v_mfma_f32_16x16x32_bf16 v[52:55], v[72:75], v[180:183], v[52:55]
    ds_read_b64_tr_b16 v[94:95], v15 offset:6400
    s_waitcnt lgkmcnt(8)
    v_mfma_f32_16x16x32_bf16 v[16:19], v[76:79], v[184:187], v[16:19]
    ds_read_b64_tr_b16 v[56:57], v13 offset:10240
    v_mfma_f32_16x16x32_bf16 v[20:23], v[76:79], v[188:191], v[20:23]
    ds_read_b64_tr_b16 v[58:59], v13 offset:11520
    s_waitcnt lgkmcnt(8)
    v_mfma_f32_16x16x32_bf16 v[24:27], v[80:83], v[184:187], v[24:27]
    ds_read_b64_tr_b16 v[60:61], v13 offset:10280
    v_mfma_f32_16x16x32_bf16 v[28:31], v[80:83], v[188:191], v[28:31]
    ds_read_b64_tr_b16 v[62:63], v13 offset:11560
    s_waitcnt lgkmcnt(8)
    v_mfma_f32_16x16x32_bf16 v[32:35], v[84:87], v[184:187], v[32:35]
    ds_read_b64_tr_b16 v[64:65], v13 offset:10320
    v_mfma_f32_16x16x32_bf16 v[36:39], v[84:87], v[188:191], v[36:39]
    ds_read_b64_tr_b16 v[66:67], v13 offset:11600
    s_waitcnt lgkmcnt(8)
    v_mfma_f32_16x16x32_bf16 v[40:43], v[88:91], v[184:187], v[40:43]
    ds_read_b64_tr_b16 v[68:69], v13 offset:10360
    v_mfma_f32_16x16x32_bf16 v[44:47], v[88:91], v[188:191], v[44:47]
    ds_read_b64_tr_b16 v[70:71], v13 offset:11640
    s_waitcnt lgkmcnt(8)
    v_mfma_f32_16x16x32_bf16 v[48:51], v[92:95], v[184:187], v[48:51]
    ds_read_b64_tr_b16 v[72:73], v15 offset:10240
    v_mfma_f32_16x16x32_bf16 v[52:55], v[92:95], v[188:191], v[52:55]
    ds_read_b64_tr_b16 v[74:75], v15 offset:11520
    s_waitcnt lgkmcnt(8)
    v_mfma_f32_16x16x32_bf16 v[16:19], v[56:59], v[192:195], v[16:19]
    ds_read_b64_tr_b16 v[76:77], v13 offset:15360
    v_mfma_f32_16x16x32_bf16 v[20:23], v[56:59], v[196:199], v[20:23]
    ds_read_b64_tr_b16 v[78:79], v13 offset:16640
    s_waitcnt lgkmcnt(8)
    v_mfma_f32_16x16x32_bf16 v[24:27], v[60:63], v[192:195], v[24:27]
    ds_read_b64_tr_b16 v[80:81], v13 offset:15400
    v_mfma_f32_16x16x32_bf16 v[28:31], v[60:63], v[196:199], v[28:31]
    ds_read_b64_tr_b16 v[82:83], v13 offset:16680
    s_waitcnt lgkmcnt(8)
    v_mfma_f32_16x16x32_bf16 v[32:35], v[64:67], v[192:195], v[32:35]
    ds_read_b64_tr_b16 v[84:85], v13 offset:15440
    v_mfma_f32_16x16x32_bf16 v[36:39], v[64:67], v[196:199], v[36:39]
    ds_read_b64_tr_b16 v[86:87], v13 offset:16720
    s_waitcnt lgkmcnt(8)
    v_mfma_f32_16x16x32_bf16 v[40:43], v[68:71], v[192:195], v[40:43]
    ds_read_b64_tr_b16 v[88:89], v13 offset:15480
    v_mfma_f32_16x16x32_bf16 v[44:47], v[68:71], v[196:199], v[44:47]
    ds_read_b64_tr_b16 v[90:91], v13 offset:16760
    s_waitcnt lgkmcnt(8)
    v_mfma_f32_16x16x32_bf16 v[48:51], v[72:75], v[192:195], v[48:51]
    ds_read_b64_tr_b16 v[92:93], v15 offset:15360
    v_mfma_f32_16x16x32_bf16 v[52:55], v[72:75], v[196:199], v[52:55]
    ds_read_b64_tr_b16 v[94:95], v15 offset:16640
    s_waitcnt lgkmcnt(8)
    v_mfma_f32_16x16x32_bf16 v[16:19], v[76:79], v[200:203], v[16:19]
    ds_read_b64_tr_b16 v[56:57], v13 offset:20480
    v_mfma_f32_16x16x32_bf16 v[20:23], v[76:79], v[204:207], v[20:23]
    ds_read_b64_tr_b16 v[58:59], v13 offset:21760
    s_waitcnt lgkmcnt(8)
    v_mfma_f32_16x16x32_bf16 v[24:27], v[80:83], v[200:203], v[24:27]
    ds_read_b64_tr_b16 v[60:61], v13 offset:20520
    v_mfma_f32_16x16x32_bf16 v[28:31], v[80:83], v[204:207], v[28:31]
    ds_read_b64_tr_b16 v[62:63], v13 offset:21800
    s_waitcnt lgkmcnt(8)
    v_mfma_f32_16x16x32_bf16 v[32:35], v[84:87], v[200:203], v[32:35]
    ds_read_b64_tr_b16 v[64:65], v13 offset:20560
    v_mfma_f32_16x16x32_bf16 v[36:39], v[84:87], v[204:207], v[36:39]
    ds_read_b64_tr_b16 v[66:67], v13 offset:21840
    s_waitcnt lgkmcnt(8)
    v_mfma_f32_16x16x32_bf16 v[40:43], v[88:91], v[200:203], v[40:43]
    ds_read_b64_tr_b16 v[68:69], v13 offset:20600
    v_mfma_f32_16x16x32_bf16 v[44:47], v[88:91], v[204:207], v[44:47]
    ds_read_b64_tr_b16 v[70:71], v13 offset:21880
    s_waitcnt lgkmcnt(8)
    v_mfma_f32_16x16x32_bf16 v[48:51], v[92:95], v[200:203], v[48:51]
    ds_read_b64_tr_b16 v[72:73], v15 offset:20480
    v_mfma_f32_16x16x32_bf16 v[52:55], v[92:95], v[204:207], v[52:55]
    ds_read_b64_tr_b16 v[74:75], v15 offset:21760
    s_waitcnt lgkmcnt(8)
    v_mfma_f32_16x16x32_bf16 v[16:19], v[56:59], v[208:211], v[16:19]
    ds_read_b64_tr_b16 v[76:77], v13 offset:25600
    v_mfma_f32_16x16x32_bf16 v[20:23], v[56:59], v[212:215], v[20:23]
    ds_read_b64_tr_b16 v[78:79], v13 offset:26880
    s_waitcnt lgkmcnt(8)
    v_mfma_f32_16x16x32_bf16 v[24:27], v[60:63], v[208:211], v[24:27]
    ds_read_b64_tr_b16 v[80:81], v13 offset:25640
    v_mfma_f32_16x16x32_bf16 v[28:31], v[60:63], v[212:215], v[28:31]
    ds_read_b64_tr_b16 v[82:83], v13 offset:26920
    s_waitcnt lgkmcnt(8)
    v_mfma_f32_16x16x32_bf16 v[32:35], v[64:67], v[208:211], v[32:35]
    ds_read_b64_tr_b16 v[84:85], v13 offset:25680
    v_mfma_f32_16x16x32_bf16 v[36:39], v[64:67], v[212:215], v[36:39]
    ds_read_b64_tr_b16 v[86:87], v13 offset:26960
    s_waitcnt lgkmcnt(8)
    v_mfma_f32_16x16x32_bf16 v[40:43], v[68:71], v[208:211], v[40:43]
    ds_read_b64_tr_b16 v[88:89], v13 offset:25720
    v_mfma_f32_16x16x32_bf16 v[44:47], v[68:71], v[212:215], v[44:47]
    ds_read_b64_tr_b16 v[90:91], v13 offset:27000
    s_waitcnt lgkmcnt(8)
    v_mfma_f32_16x16x32_bf16 v[48:51], v[72:75], v[208:211], v[48:51]
    ds_read_b64_tr_b16 v[92:93], v15 offset:25600
    v_mfma_f32_16x16x32_bf16 v[52:55], v[72:75], v[212:215], v[52:55]
    ds_read_b64_tr_b16 v[94:95], v15 offset:26880
    s_waitcnt lgkmcnt(8)
    v_mfma_f32_16x16x32_bf16 v[16:19], v[76:79], v[216:219], v[16:19]
    ds_read_b64_tr_b16 v[56:57], v13 offset:30720
    v_mfma_f32_16x16x32_bf16 v[20:23], v[76:79], v[220:223], v[20:23]
    ds_read_b64_tr_b16 v[58:59], v13 offset:32000
    s_waitcnt lgkmcnt(8)
    v_mfma_f32_16x16x32_bf16 v[24:27], v[80:83], v[216:219], v[24:27]
    ds_read_b64_tr_b16 v[60:61], v13 offset:30760
    v_mfma_f32_16x16x32_bf16 v[28:31], v[80:83], v[220:223], v[28:31]
    ds_read_b64_tr_b16 v[62:63], v13 offset:32040
    s_waitcnt lgkmcnt(8)
    v_mfma_f32_16x16x32_bf16 v[32:35], v[84:87], v[216:219], v[32:35]
    ds_read_b64_tr_b16 v[64:65], v13 offset:30800
    v_mfma_f32_16x16x32_bf16 v[36:39], v[84:87], v[220:223], v[36:39]
    ds_read_b64_tr_b16 v[66:67], v13 offset:32080
    s_waitcnt lgkmcnt(8)
    v_mfma_f32_16x16x32_bf16 v[40:43], v[88:91], v[216:219], v[40:43]
    ds_read_b64_tr_b16 v[68:69], v13 offset:30840
    v_mfma_f32_16x16x32_bf16 v[44:47], v[88:91], v[220:223], v[44:47]
    ds_read_b64_tr_b16 v[70:71], v13 offset:32120
    s_waitcnt lgkmcnt(8)
    v_mfma_f32_16x16x32_bf16 v[48:51], v[92:95], v[216:219], v[48:51]
    ds_read_b64_tr_b16 v[72:73], v15 offset:30720
    v_mfma_f32_16x16x32_bf16 v[52:55], v[92:95], v[220:223], v[52:55]
    ds_read_b64_tr_b16 v[74:75], v15 offset:32000
    s_waitcnt lgkmcnt(8)
    v_mfma_f32_16x16x32_bf16 v[16:19], v[56:59], v[224:227], v[16:19]
    ds_read_b64_tr_b16 v[76:77], v13 offset:35840
    v_mfma_f32_16x16x32_bf16 v[20:23], v[56:59], v[228:231], v[20:23]
    ds_read_b64_tr_b16 v[78:79], v13 offset:37120
    s_waitcnt lgkmcnt(8)
    v_mfma_f32_16x16x32_bf16 v[24:27], v[60:63], v[224:227], v[24:27]
    ds_read_b64_tr_b16 v[80:81], v13 offset:35880
    v_mfma_f32_16x16x32_bf16 v[28:31], v[60:63], v[228:231], v[28:31]
    ds_read_b64_tr_b16 v[82:83], v13 offset:37160
    s_waitcnt lgkmcnt(8)
    v_mfma_f32_16x16x32_bf16 v[32:35], v[64:67], v[224:227], v[32:35]
    ds_read_b64_tr_b16 v[84:85], v13 offset:35920
    v_mfma_f32_16x16x32_bf16 v[36:39], v[64:67], v[228:231], v[36:39]
    ds_read_b64_tr_b16 v[86:87], v13 offset:37200
    s_waitcnt lgkmcnt(8)
    v_mfma_f32_16x16x32_bf16 v[40:43], v[68:71], v[224:227], v[40:43]
    ds_read_b64_tr_b16 v[88:89], v13 offset:35960
    v_mfma_f32_16x16x32_bf16 v[44:47], v[68:71], v[228:231], v[44:47]
    ds_read_b64_tr_b16 v[90:91], v13 offset:37240
    s_waitcnt lgkmcnt(8)
    v_mfma_f32_16x16x32_bf16 v[48:51], v[72:75], v[224:227], v[48:51]
    ds_read_b64_tr_b16 v[92:93], v15 offset:35840
    v_mfma_f32_16x16x32_bf16 v[52:55], v[72:75], v[228:231], v[52:55]
    ds_read_b64_tr_b16 v[94:95], v15 offset:37120
    s_lshl_b32 s27, s26, 1
    s_lshr_b32 s29, s57, 1
    s_add_u32 s27, s27, s29
    s_lshl_b32 s27, s27, 11
    s_add_u32 s27, s27, 14942208
    v_and_b32 v96, 15, v1
    v_lshlrev_b32 v96, 7, v96
    buffer_load_dwordx2 v[98:99], v96, s[40:43], s27 offen sc1

    s_waitcnt lgkmcnt(8)
    v_mfma_f32_16x16x32_bf16 v[16:19], v[76:79], v[232:235], v[16:19]
    ds_read_b64_tr_b16 v[56:57], v13 offset:40960
    v_mfma_f32_16x16x32_bf16 v[20:23], v[76:79], v[236:239], v[20:23]
    ds_read_b64_tr_b16 v[58:59], v13 offset:42240
    s_waitcnt lgkmcnt(8)
    v_mfma_f32_16x16x32_bf16 v[24:27], v[80:83], v[232:235], v[24:27]
    ds_read_b64_tr_b16 v[60:61], v13 offset:41000
    v_mfma_f32_16x16x32_bf16 v[28:31], v[80:83], v[236:239], v[28:31]
    ds_read_b64_tr_b16 v[62:63], v13 offset:42280
    s_waitcnt lgkmcnt(8)
    v_mfma_f32_16x16x32_bf16 v[32:35], v[84:87], v[232:235], v[32:35]
    ds_read_b64_tr_b16 v[64:65], v13 offset:41040
    v_mfma_f32_16x16x32_bf16 v[36:39], v[84:87], v[236:239], v[36:39]
    ds_read_b64_tr_b16 v[66:67], v13 offset:42320
    s_waitcnt lgkmcnt(8)
    v_mfma_f32_16x16x32_bf16 v[40:43], v[88:91], v[232:235], v[40:43]
    ds_read_b64_tr_b16 v[68:69], v13 offset:41080
    v_mfma_f32_16x16x32_bf16 v[44:47], v[88:91], v[236:239], v[44:47]
    ds_read_b64_tr_b16 v[70:71], v13 offset:42360
    s_waitcnt lgkmcnt(8)
    v_mfma_f32_16x16x32_bf16 v[48:51], v[92:95], v[232:235], v[48:51]
    ds_read_b64_tr_b16 v[72:73], v15 offset:40960
    v_mfma_f32_16x16x32_bf16 v[52:55], v[92:95], v[236:239], v[52:55]
    ds_read_b64_tr_b16 v[74:75], v15 offset:42240
    s_waitcnt lgkmcnt(8)
    v_mfma_f32_16x16x32_bf16 v[16:19], v[56:59], v[240:243], v[16:19]
    ds_read_b64_tr_b16 v[76:77], v13 offset:46080
    v_mfma_f32_16x16x32_bf16 v[20:23], v[56:59], v[244:247], v[20:23]
    ds_read_b64_tr_b16 v[78:79], v13 offset:47360
    s_waitcnt lgkmcnt(8)
    v_mfma_f32_16x16x32_bf16 v[24:27], v[60:63], v[240:243], v[24:27]
    ds_read_b64_tr_b16 v[80:81], v13 offset:46120
    v_mfma_f32_16x16x32_bf16 v[28:31], v[60:63], v[244:247], v[28:31]
    ds_read_b64_tr_b16 v[82:83], v13 offset:47400
    s_waitcnt lgkmcnt(8)
    v_mfma_f32_16x16x32_bf16 v[32:35], v[64:67], v[240:243], v[32:35]
    ds_read_b64_tr_b16 v[84:85], v13 offset:46160
    v_mfma_f32_16x16x32_bf16 v[36:39], v[64:67], v[244:247], v[36:39]
    ds_read_b64_tr_b16 v[86:87], v13 offset:47440
    s_waitcnt lgkmcnt(8)
    v_mfma_f32_16x16x32_bf16 v[40:43], v[68:71], v[240:243], v[40:43]
    ds_read_b64_tr_b16 v[88:89], v13 offset:46200
    v_mfma_f32_16x16x32_bf16 v[44:47], v[68:71], v[244:247], v[44:47]
    ds_read_b64_tr_b16 v[90:91], v13 offset:47480
    s_waitcnt lgkmcnt(8)
    v_mfma_f32_16x16x32_bf16 v[48:51], v[72:75], v[240:243], v[48:51]
    ds_read_b64_tr_b16 v[92:93], v15 offset:46080
    v_mfma_f32_16x16x32_bf16 v[52:55], v[72:75], v[244:247], v[52:55]
    ds_read_b64_tr_b16 v[94:95], v15 offset:47360
    s_waitcnt lgkmcnt(8)
    v_mfma_f32_16x16x32_bf16 v[16:19], v[76:79], v[248:251], v[16:19]
    v_mfma_f32_16x16x32_bf16 v[20:23], v[76:79], v[252:255], v[20:23]
    s_waitcnt lgkmcnt(6)
    v_mfma_f32_16x16x32_bf16 v[24:27], v[80:83], v[248:251], v[24:27]
    v_mfma_f32_16x16x32_bf16 v[28:31], v[80:83], v[252:255], v[28:31]
    s_waitcnt lgkmcnt(4)
    v_mfma_f32_16x16x32_bf16 v[32:35], v[84:87], v[248:251], v[32:35]
    v_mfma_f32_16x16x32_bf16 v[36:39], v[84:87], v[252:255], v[36:39]
    s_waitcnt lgkmcnt(2)
    v_mfma_f32_16x16x32_bf16 v[40:43], v[88:91], v[248:251], v[40:43]
    v_mfma_f32_16x16x32_bf16 v[44:47], v[88:91], v[252:255], v[44:47]
    s_waitcnt lgkmcnt(0)
    v_mfma_f32_16x16x32_bf16 v[48:51], v[92:95], v[248:251], v[48:51]
    v_mfma_f32_16x16x32_bf16 v[52:55], v[92:95], v[252:255], v[52:55]
    s_waitcnt lgkmcnt(0)
    s_mov_b64 exec, 1
    ds_add_u32 v3, v7 offset:30740
    s_mov_b64 exec, -1
    s_setprio 3
    s_lshl_b32 s66, s26, 1
    s_lshr_b32 s27, s57, 1
    s_add_u32 s66, s66, s27
    s_lshl_b32 s64, s66, 15
    s_and_b32 s30, s57, 1
    s_lshl_b32 s30, s30, 10
    s_add_u32 s64, s64, s30
    s_add_u32 s64, s64, 12582912
    s_lshl_b32 s65, s66, 11
    s_add_u32 s65, s65, 14942208
    s_mov_b32 s79, 200000
    s_waitcnt vmcnt(0)
    s_branch KV_CHK

KV_POLL:
    s_sleep 3
    buffer_load_dwordx2 v[98:99], v96, s[40:43], s65 offen sc1
    s_waitcnt vmcnt(0)
KV_CHK:
    v_cmp_ne_u64 vcc, s[58:59], v[98:99]
    s_nop 1
    s_cmp_eq_u64 vcc, 0
    s_cbranch_scc1 KV_GOT
    s_sub_u32 s79, s79, 1
    s_cbranch_scc0 KV_POLL

KV_GOT:
    buffer_load_dwordx4 v[192:195], v2, s[40:43], s64 offen offset:0 sc1
    buffer_load_dwordx4 v[196:199], v2, s[40:43], s64 offen offset:2048 sc1
    s_add_u32 s64, s64, 4096
    buffer_load_dwordx4 v[200:203], v2, s[40:43], s64 offen offset:0 sc1
    buffer_load_dwordx4 v[204:207], v2, s[40:43], s64 offen offset:2048 sc1
    s_add_u32 s64, s64, 4096
    buffer_load_dwordx4 v[208:211], v2, s[40:43], s64 offen offset:0 sc1
    buffer_load_dwordx4 v[212:215], v2, s[40:43], s64 offen offset:2048 sc1
    s_add_u32 s64, s64, 4096
    buffer_load_dwordx4 v[216:219], v2, s[40:43], s64 offen offset:0 sc1
    buffer_load_dwordx4 v[220:223], v2, s[40:43], s64 offen offset:2048 sc1
    s_add_u32 s64, s64, 4096
    buffer_load_dwordx4 v[224:227], v2, s[40:43], s64 offen offset:0 sc1
    buffer_load_dwordx4 v[228:231], v2, s[40:43], s64 offen offset:2048 sc1
    s_add_u32 s64, s64, 4096
    buffer_load_dwordx4 v[232:235], v2, s[40:43], s64 offen offset:0 sc1
    buffer_load_dwordx4 v[236:239], v2, s[40:43], s64 offen offset:2048 sc1
    s_add_u32 s64, s64, 4096
    buffer_load_dwordx4 v[240:243], v2, s[40:43], s64 offen offset:0 sc1
    buffer_load_dwordx4 v[244:247], v2, s[40:43], s64 offen offset:2048 sc1
    s_add_u32 s64, s64, 4096
    buffer_load_dwordx4 v[248:251], v2, s[40:43], s64 offen offset:0 sc1
    buffer_load_dwordx4 v[252:255], v2, s[40:43], s64 offen offset:2048 sc1
    s_add_u32 s64, s64, 4096
    v_and_b32 v12, 0x30, v1
    s_mov_b32 s68, 1.0
    s_mov_b32 s69, 1.0
    s_mov_b32 s62, 897988541
    s_mov_b32 s63, 897988541

LS_48:
    ds_read_b32 v13, v3 offset:30744
    s_waitcnt lgkmcnt(0)
    v_readfirstlane_b32 s27, v13
    s_nop 1
    s_cmp_ge_u32 s27, 2
    s_cbranch_scc1 LS_48_D
    s_sleep 2
    s_branch LS_48

LS_48_D:
    ds_read_b128 v[56:59], v12 offset:26112
    ds_read_b128 v[60:63], v12 offset:26176
    ds_read_b128 v[64:67], v12 offset:26240
    ds_read_b128 v[68:71], v12 offset:26304
    ds_read_b128 v[72:75], v12 offset:26368
    ds_read_b128 v[76:79], v12 offset:26432
    v_mov_b32 v80, v4
    v_mov_b32 v81, v4
    v_mov_b32 v82, v5
    v_mov_b32 v83, v5
    v_mov_b32 v84, v6
    v_mov_b32 v85, v6
    v_mov_b32 v86, v8
    v_mov_b32 v87, v8
    v_mov_b32 v88, v9
    v_mov_b32 v89, v9
    v_mov_b32 v90, v10
    v_mov_b32 v91, v10
    s_waitcnt lgkmcnt(0)
    v_add_f32 v72, v72, v76
    v_add_f32 v73, v73, v77
    v_add_f32 v74, v74, v78
    v_add_f32 v75, v75, v79
    v_pk_fma_f32 v[16:17], v[80:81], v[56:57], v[16:17] neg_lo:[1,0,0] neg_hi:[1,0,0]
    v_pk_mul_f32 v[92:93], v[16:17], v[84:85]
    v_pk_fma_f32 v[16:17], v[16:17], v[82:83], s[68:69]
    v_exp_f32_e64 v92, v92 clamp
    v_exp_f32_e64 v93, v93 clamp
    v_max_f32 v16, v16, v92
    v_max_f32 v17, v17, v93
    v_pk_add_f32 v[16:17], v[16:17], s[62:63]
    v_cvt_pk_bf16_f32 v16, v16, v17

    v_pk_fma_f32 v[18:19], v[80:81], v[58:59], v[18:19] neg_lo:[1,0,0] neg_hi:[1,0,0]
    v_pk_mul_f32 v[94:95], v[18:19], v[84:85]
    v_pk_fma_f32 v[18:19], v[18:19], v[82:83], s[68:69]
    v_exp_f32_e64 v94, v94 clamp
    v_exp_f32_e64 v95, v95 clamp
    v_max_f32 v18, v18, v94
    v_max_f32 v19, v19, v95
    v_pk_add_f32 v[18:19], v[18:19], s[62:63]
    v_cvt_pk_bf16_f32 v17, v18, v19

    v_pk_fma_f32 v[20:21], v[86:87], v[56:57], v[20:21] neg_lo:[1,0,0] neg_hi:[1,0,0]
    v_pk_mul_f32 v[92:93], v[20:21], v[90:91]
    v_pk_fma_f32 v[20:21], v[20:21], v[88:89], s[68:69]
    v_exp_f32_e64 v92, v92 clamp
    v_exp_f32_e64 v93, v93 clamp
    v_max_f32 v20, v20, v92
    v_max_f32 v21, v21, v93
    v_pk_add_f32 v[20:21], v[20:21], s[62:63]
    v_cvt_pk_bf16_f32 v18, v20, v21

    v_pk_fma_f32 v[22:23], v[86:87], v[58:59], v[22:23] neg_lo:[1,0,0] neg_hi:[1,0,0]
    v_pk_mul_f32 v[94:95], v[22:23], v[90:91]
    v_pk_fma_f32 v[22:23], v[22:23], v[88:89], s[68:69]
    v_exp_f32_e64 v94, v94 clamp
    v_exp_f32_e64 v95, v95 clamp
    v_max_f32 v22, v22, v94
    v_max_f32 v23, v23, v95
    v_pk_add_f32 v[22:23], v[22:23], s[62:63]
    v_cvt_pk_bf16_f32 v19, v22, v23

    v_pk_fma_f32 v[24:25], v[80:81], v[60:61], v[24:25] neg_lo:[1,0,0] neg_hi:[1,0,0]
    v_pk_mul_f32 v[92:93], v[24:25], v[84:85]
    v_pk_fma_f32 v[24:25], v[24:25], v[82:83], s[68:69]
    v_exp_f32_e64 v92, v92 clamp
    v_exp_f32_e64 v93, v93 clamp
    v_max_f32 v24, v24, v92
    v_max_f32 v25, v25, v93
    v_pk_add_f32 v[24:25], v[24:25], s[62:63]
    v_cvt_pk_bf16_f32 v20, v24, v25

    v_pk_fma_f32 v[26:27], v[80:81], v[62:63], v[26:27] neg_lo:[1,0,0] neg_hi:[1,0,0]
    v_pk_mul_f32 v[94:95], v[26:27], v[84:85]
    v_pk_fma_f32 v[26:27], v[26:27], v[82:83], s[68:69]
    v_exp_f32_e64 v94, v94 clamp
    v_exp_f32_e64 v95, v95 clamp
    v_max_f32 v26, v26, v94
    v_max_f32 v27, v27, v95
    v_pk_add_f32 v[26:27], v[26:27], s[62:63]
    v_cvt_pk_bf16_f32 v21, v26, v27

    v_pk_fma_f32 v[28:29], v[86:87], v[60:61], v[28:29] neg_lo:[1,0,0] neg_hi:[1,0,0]
    v_pk_mul_f32 v[92:93], v[28:29], v[90:91]
    v_pk_fma_f32 v[28:29], v[28:29], v[88:89], s[68:69]
    v_exp_f32_e64 v92, v92 clamp
    v_exp_f32_e64 v93, v93 clamp
    v_max_f32 v28, v28, v92
    v_max_f32 v29, v29, v93
    v_pk_add_f32 v[28:29], v[28:29], s[62:63]
    v_cvt_pk_bf16_f32 v22, v28, v29

    v_pk_fma_f32 v[30:31], v[86:87], v[62:63], v[30:31] neg_lo:[1,0,0] neg_hi:[1,0,0]
    v_pk_mul_f32 v[94:95], v[30:31], v[90:91]
    v_pk_fma_f32 v[30:31], v[30:31], v[88:89], s[68:69]
    v_exp_f32_e64 v94, v94 clamp
    v_exp_f32_e64 v95, v95 clamp
    v_max_f32 v30, v30, v94
    v_max_f32 v31, v31, v95
    v_pk_add_f32 v[30:31], v[30:31], s[62:63]
    v_cvt_pk_bf16_f32 v23, v30, v31

    v_pk_fma_f32 v[32:33], v[80:81], v[64:65], v[32:33] neg_lo:[1,0,0] neg_hi:[1,0,0]
    v_pk_mul_f32 v[92:93], v[32:33], v[84:85]
    v_pk_fma_f32 v[32:33], v[32:33], v[82:83], s[68:69]
    v_exp_f32_e64 v92, v92 clamp
    v_exp_f32_e64 v93, v93 clamp
    v_max_f32 v32, v32, v92
    v_max_f32 v33, v33, v93
    v_pk_add_f32 v[32:33], v[32:33], s[62:63]
    v_cvt_pk_bf16_f32 v24, v32, v33

    v_pk_fma_f32 v[34:35], v[80:81], v[66:67], v[34:35] neg_lo:[1,0,0] neg_hi:[1,0,0]
    v_pk_mul_f32 v[94:95], v[34:35], v[84:85]
    v_pk_fma_f32 v[34:35], v[34:35], v[82:83], s[68:69]
    v_exp_f32_e64 v94, v94 clamp
    v_exp_f32_e64 v95, v95 clamp
    v_max_f32 v34, v34, v94
    v_max_f32 v35, v35, v95
    v_pk_add_f32 v[34:35], v[34:35], s[62:63]
    v_cvt_pk_bf16_f32 v25, v34, v35

    v_pk_fma_f32 v[36:37], v[86:87], v[64:65], v[36:37] neg_lo:[1,0,0] neg_hi:[1,0,0]
    v_pk_mul_f32 v[92:93], v[36:37], v[90:91]
    v_pk_fma_f32 v[36:37], v[36:37], v[88:89], s[68:69]
    v_exp_f32_e64 v92, v92 clamp
    v_exp_f32_e64 v93, v93 clamp
    v_max_f32 v36, v36, v92
    v_max_f32 v37, v37, v93
    v_pk_add_f32 v[36:37], v[36:37], s[62:63]
    v_cvt_pk_bf16_f32 v26, v36, v37

    v_pk_fma_f32 v[38:39], v[86:87], v[66:67], v[38:39] neg_lo:[1,0,0] neg_hi:[1,0,0]
    v_pk_mul_f32 v[94:95], v[38:39], v[90:91]
    v_pk_fma_f32 v[38:39], v[38:39], v[88:89], s[68:69]
    v_exp_f32_e64 v94, v94 clamp
    v_exp_f32_e64 v95, v95 clamp
    v_max_f32 v38, v38, v94
    v_max_f32 v39, v39, v95
    v_pk_add_f32 v[38:39], v[38:39], s[62:63]
    v_cvt_pk_bf16_f32 v27, v38, v39

    v_pk_fma_f32 v[40:41], v[80:81], v[68:69], v[40:41] neg_lo:[1,0,0] neg_hi:[1,0,0]
    v_pk_mul_f32 v[92:93], v[40:41], v[84:85]
    v_pk_fma_f32 v[40:41], v[40:41], v[82:83], s[68:69]
    v_exp_f32_e64 v92, v92 clamp
    v_exp_f32_e64 v93, v93 clamp
    v_max_f32 v40, v40, v92
    v_max_f32 v41, v41, v93
    v_pk_add_f32 v[40:41], v[40:41], s[62:63]
    v_cvt_pk_bf16_f32 v28, v40, v41

    v_pk_fma_f32 v[42:43], v[80:81], v[70:71], v[42:43] neg_lo:[1,0,0] neg_hi:[1,0,0]
    v_pk_mul_f32 v[94:95], v[42:43], v[84:85]
    v_pk_fma_f32 v[42:43], v[42:43], v[82:83], s[68:69]
    v_exp_f32_e64 v94, v94 clamp
    v_exp_f32_e64 v95, v95 clamp
    v_max_f32 v42, v42, v94
    v_max_f32 v43, v43, v95
    v_pk_add_f32 v[42:43], v[42:43], s[62:63]
    v_cvt_pk_bf16_f32 v29, v42, v43

    v_pk_fma_f32 v[44:45], v[86:87], v[68:69], v[44:45] neg_lo:[1,0,0] neg_hi:[1,0,0]
    v_pk_mul_f32 v[92:93], v[44:45], v[90:91]
    v_pk_fma_f32 v[44:45], v[44:45], v[88:89], s[68:69]
    v_exp_f32_e64 v92, v92 clamp
    v_exp_f32_e64 v93, v93 clamp
    v_max_f32 v44, v44, v92
    v_max_f32 v45, v45, v93
    v_pk_add_f32 v[44:45], v[44:45], s[62:63]
    v_cvt_pk_bf16_f32 v30, v44, v45

    v_pk_fma_f32 v[46:47], v[86:87], v[70:71], v[46:47] neg_lo:[1,0,0] neg_hi:[1,0,0]
    v_pk_mul_f32 v[94:95], v[46:47], v[90:91]
    v_pk_fma_f32 v[46:47], v[46:47], v[88:89], s[68:69]
    v_exp_f32_e64 v94, v94 clamp
    v_exp_f32_e64 v95, v95 clamp
    v_max_f32 v46, v46, v94
    v_max_f32 v47, v47, v95
    v_pk_add_f32 v[46:47], v[46:47], s[62:63]
    v_cvt_pk_bf16_f32 v31, v46, v47

    v_pk_fma_f32 v[48:49], v[80:81], v[72:73], v[48:49] neg_lo:[1,0,0] neg_hi:[1,0,0]
    v_pk_mul_f32 v[92:93], v[48:49], v[84:85]
    v_pk_fma_f32 v[48:49], v[48:49], v[82:83], s[68:69]
    v_exp_f32_e64 v92, v92 clamp
    v_exp_f32_e64 v93, v93 clamp
    v_max_f32 v48, v48, v92
    v_max_f32 v49, v49, v93
    v_pk_add_f32 v[48:49], v[48:49], s[62:63]
    v_cvt_pk_bf16_f32 v32, v48, v49

    v_pk_fma_f32 v[50:51], v[80:81], v[74:75], v[50:51] neg_lo:[1,0,0] neg_hi:[1,0,0]
    v_pk_mul_f32 v[94:95], v[50:51], v[84:85]
    v_pk_fma_f32 v[50:51], v[50:51], v[82:83], s[68:69]
    v_exp_f32_e64 v94, v94 clamp
    v_exp_f32_e64 v95, v95 clamp
    v_max_f32 v50, v50, v94
    v_max_f32 v51, v51, v95
    v_pk_add_f32 v[50:51], v[50:51], s[62:63]
    v_cvt_pk_bf16_f32 v33, v50, v51

    v_pk_fma_f32 v[52:53], v[86:87], v[72:73], v[52:53] neg_lo:[1,0,0] neg_hi:[1,0,0]
    v_pk_mul_f32 v[92:93], v[52:53], v[90:91]
    v_pk_fma_f32 v[52:53], v[52:53], v[88:89], s[68:69]
    v_exp_f32_e64 v92, v92 clamp
    v_exp_f32_e64 v93, v93 clamp
    v_max_f32 v52, v52, v92
    v_max_f32 v53, v53, v93
    v_pk_add_f32 v[52:53], v[52:53], s[62:63]
    v_cvt_pk_bf16_f32 v34, v52, v53

    v_pk_fma_f32 v[54:55], v[86:87], v[74:75], v[54:55] neg_lo:[1,0,0] neg_hi:[1,0,0]
    v_pk_mul_f32 v[94:95], v[54:55], v[90:91]
    v_pk_fma_f32 v[54:55], v[54:55], v[88:89], s[68:69]
    v_exp_f32_e64 v94, v94 clamp
    v_exp_f32_e64 v95, v95 clamp
    v_max_f32 v54, v54, v94
    v_max_f32 v55, v55, v95
    v_pk_add_f32 v[54:55], v[54:55], s[62:63]
    v_cvt_pk_bf16_f32 v35, v54, v55

    v_bfe_u32 v112, v1, 2, 2
    v_lshrrev_b32 v113, 4, v1
    v_cmp_eq_u32 vcc, v112, v113
    v_and_b32 v112, 1, v1
    v_lshlrev_b32 v112, 4, v112
    v_mov_b32 v113, 0x3f80
    v_lshlrev_b32 v113, v112, v113
    v_cndmask_b32 v113, 0, v113, vcc
    v_and_b32 v112, 2, v1
    v_cmp_eq_u32 vcc, 0, v112
    v_mov_b32 v116, 0
    v_mov_b32 v117, 0
    v_cndmask_b32 v114, 0, v113, vcc
    v_cndmask_b32 v115, v113, 0, vcc
    v_mov_b32 v112, 0
    v_mov_b32 v113, 0
    s_nop 1

    s_waitcnt vmcnt(14)
    v_mfma_f32_16x16x32_bf16 v[96:99], v[114:117], v[192:195], 0
    v_mfma_f32_16x16x32_bf16 v[100:103], v[112:115], v[192:195], 0
    v_mfma_f32_16x16x32_bf16 v[96:99], v[114:117], v[196:199], v[96:99]
    v_mfma_f32_16x16x32_bf16 v[100:103], v[112:115], v[196:199], v[100:103]
    s_waitcnt vmcnt(12)
    v_mfma_f32_16x16x32_bf16 v[96:99], v[114:117], v[200:203], v[96:99]
    v_mfma_f32_16x16x32_bf16 v[100:103], v[112:115], v[200:203], v[100:103]
    v_mfma_f32_16x16x32_bf16 v[96:99], v[114:117], v[204:207], v[96:99]
    v_mfma_f32_16x16x32_bf16 v[100:103], v[112:115], v[204:207], v[100:103]
    s_waitcnt vmcnt(10)
    v_mfma_f32_16x16x32_bf16 v[96:99], v[114:117], v[208:211], v[96:99]
    v_mfma_f32_16x16x32_bf16 v[100:103], v[112:115], v[208:211], v[100:103]
    v_mfma_f32_16x16x32_bf16 v[96:99], v[114:117], v[212:215], v[96:99]
    v_mfma_f32_16x16x32_bf16 v[100:103], v[112:115], v[212:215], v[100:103]
    s_waitcnt vmcnt(8)
    v_mfma_f32_16x16x32_bf16 v[96:99], v[114:117], v[216:219], v[96:99]
    v_mfma_f32_16x16x32_bf16 v[100:103], v[112:115], v[216:219], v[100:103]
    v_mfma_f32_16x16x32_bf16 v[96:99], v[114:117], v[220:223], v[96:99]
    v_mfma_f32_16x16x32_bf16 v[100:103], v[112:115], v[220:223], v[100:103]
    s_waitcnt vmcnt(6)
    v_mfma_f32_16x16x32_bf16 v[96:99], v[114:117], v[224:227], v[96:99]
    v_mfma_f32_16x16x32_bf16 v[100:103], v[112:115], v[224:227], v[100:103]
    v_mfma_f32_16x16x32_bf16 v[96:99], v[114:117], v[228:231], v[96:99]
    v_mfma_f32_16x16x32_bf16 v[100:103], v[112:115], v[228:231], v[100:103]
    s_waitcnt vmcnt(4)
    v_mfma_f32_16x16x32_bf16 v[96:99], v[114:117], v[232:235], v[96:99]
    v_mfma_f32_16x16x32_bf16 v[100:103], v[112:115], v[232:235], v[100:103]
    v_mfma_f32_16x16x32_bf16 v[96:99], v[114:117], v[236:239], v[96:99]
    v_mfma_f32_16x16x32_bf16 v[100:103], v[112:115], v[236:239], v[100:103]
    s_waitcnt vmcnt(2)
    v_mfma_f32_16x16x32_bf16 v[96:99], v[114:117], v[240:243], v[96:99]
    v_mfma_f32_16x16x32_bf16 v[100:103], v[112:115], v[240:243], v[100:103]
    v_mfma_f32_16x16x32_bf16 v[96:99], v[114:117], v[244:247], v[96:99]
    v_mfma_f32_16x16x32_bf16 v[100:103], v[112:115], v[244:247], v[100:103]
    s_waitcnt vmcnt(0)
    v_mfma_f32_16x16x32_bf16 v[96:99], v[114:117], v[248:251], v[96:99]
    v_mfma_f32_16x16x32_bf16 v[100:103], v[112:115], v[248:251], v[100:103]
    v_mfma_f32_16x16x32_bf16 v[96:99], v[114:117], v[252:255], v[96:99]
    v_mfma_f32_16x16x32_bf16 v[100:103], v[112:115], v[252:255], v[100:103]
    s_nop 5
    s_lshl_b32 s27, s57, 10
    v_lshl_add_u32 v104, v1, 3, s27
    v_cvt_pk_bf16_f32 v108, v96, v97
    v_cvt_pk_bf16_f32 v109, v98, v99
    v_cvt_pk_bf16_f32 v110, v100, v101
    v_cvt_pk_bf16_f32 v111, v102, v103
    ds_write_b64 v104, v[108:109] offset:26624
    ds_write_b64 v104, v[110:111] offset:27136
    s_waitcnt lgkmcnt(0)
    s_mov_b64 exec, 1
    ds_add_u32 v3, v7 offset:30736
    s_mov_b64 exec, -1
    v_lshlrev_b32 v68, 3, v1
    v_and_b32 v69, 15, v1
    v_lshlrev_b32 v70, 3, v69
    v_lshrrev_b32 v71, 2, v69
    v_add_u32 v71, 8, v71
    v_and_b32 v72, 3, v1
    v_cmp_eq_u32 vcc, 0, v72
    v_and_b32 v73, 0x30, v1
    s_nop 0
    v_cndmask_b32 v71, 0, v71, vcc
    v_add_u32 v73, v73, v71
    v_lshlrev_b32 v73, 3, v73
    v_lshlrev_b32 v71, 3, v71

    v_mov_b32 v36, v16
    v_mov_b32 v37, v17
    v_mov_b32 v38, v32
    v_mov_b32 v39, v33
    v_mov_b32 v40, v18
    v_mov_b32 v41, v19
    v_mov_b32 v42, v34
    v_mov_b32 v43, v35
    v_mov_b32 v44, v20
    v_mov_b32 v45, v21
    v_mov_b32 v46, v32
    v_mov_b32 v47, v33
    v_mov_b32 v48, v22
    v_mov_b32 v49, v23
    v_mov_b32 v50, v34
    v_mov_b32 v51, v35
    v_mov_b32 v52, v24
    v_mov_b32 v53, v25
    v_mov_b32 v54, v32
    v_mov_b32 v55, v33
    v_mov_b32 v56, v26
    v_mov_b32 v57, v27
    v_mov_b32 v58, v34
    v_mov_b32 v59, v35
    v_mov_b32 v60, v28
    v_mov_b32 v61, v29
    v_mov_b32 v62, v32
    v_mov_b32 v63, v33
    v_mov_b32 v64, v30
    v_mov_b32 v65, v31
    v_mov_b32 v66, v34
    v_mov_b32 v67, v35
    v_mov_b32 v178, 0
    v_mov_b32 v18, 0
    v_mov_b32 v179, 0
    v_mov_b32 v19, 0
    v_mov_b32 v182, 0
    v_mov_b32 v22, 0
    v_mov_b32 v183, 0
    v_mov_b32 v23, 0
    v_mov_b32 v186, 0
    v_mov_b32 v26, 0
    v_mov_b32 v187, 0
    v_mov_b32 v27, 0
    v_mov_b32 v190, 0
    v_mov_b32 v30, 0
    v_mov_b32 v191, 0
    v_mov_b32 v31, 0
LS_49:
    ds_read_b32 v11, v3 offset:30736
    s_waitcnt lgkmcnt(0)
    v_readfirstlane_b32 s27, v11
    s_nop 1
    s_cmp_ge_u32 s27, 4
    s_cbranch_scc1 LS_49_D
    s_sleep 2
    s_branch LS_49

LS_49_D:
    ds_read_b64 v[176:177], v68 offset:26624
    ds_read_b64 v[16:17], v73 offset:27648
    ds_read_b64 v[180:181], v68 offset:27136
    ds_read_b64 v[20:21], v73 offset:27680
    ds_read_b64 v[184:185], v68 offset:28672
    ds_read_b64 v[24:25], v73 offset:29696
    ds_read_b64 v[188:189], v68 offset:29184
    ds_read_b64 v[28:29], v73 offset:29728
    s_mov_b32 exec_lo, 0xffff
    s_mov_b32 exec_hi, 0x0
    ds_read_b64 v[178:179], v70 offset:28160
    ds_read_b64 v[18:19], v71 offset:28416
    s_mov_b32 exec_lo, 0xffff0000
    s_mov_b32 exec_hi, 0x0
    ds_read_b64 v[182:183], v70 offset:28288
    ds_read_b64 v[22:23], v71 offset:28576
    s_mov_b32 exec_lo, 0x0
    s_mov_b32 exec_hi, 0xffff
    ds_read_b64 v[186:187], v70 offset:30208
    ds_read_b64 v[26:27], v71 offset:30464
    s_mov_b32 exec_lo, 0x0
    s_mov_b32 exec_hi, 0xffff0000
    ds_read_b64 v[190:191], v70 offset:30336
    ds_read_b64 v[30:31], v71 offset:30624
    s_mov_b64 exec, -1
    s_waitcnt lgkmcnt(0)
    v_mfma_f32_16x16x32_bf16 v[224:227], v[16:19], v[36:39], 0
    v_mfma_f32_16x16x32_bf16 v[192:195], v[176:179], v[36:39], 0
    v_mfma_f32_16x16x32_bf16 v[228:231], v[16:19], v[40:43], 0
    v_mfma_f32_16x16x32_bf16 v[196:199], v[176:179], v[40:43], 0
    v_mfma_f32_16x16x32_bf16 v[232:235], v[20:23], v[44:47], 0
    v_mfma_f32_16x16x32_bf16 v[200:203], v[180:183], v[44:47], 0
    v_mfma_f32_16x16x32_bf16 v[236:239], v[20:23], v[48:51], 0
    v_mfma_f32_16x16x32_bf16 v[204:207], v[180:183], v[48:51], 0
    v_mfma_f32_16x16x32_bf16 v[240:243], v[24:27], v[52:55], 0
    v_mfma_f32_16x16x32_bf16 v[208:211], v[184:187], v[52:55], 0
    v_mfma_f32_16x16x32_bf16 v[244:247], v[24:27], v[56:59], 0
    v_mfma_f32_16x16x32_bf16 v[212:215], v[184:187], v[56:59], 0
    v_mfma_f32_16x16x32_bf16 v[248:251], v[28:31], v[60:63], 0
    v_mfma_f32_16x16x32_bf16 v[216:219], v[188:191], v[60:63], 0
    v_mfma_f32_16x16x32_bf16 v[252:255], v[28:31], v[64:67], 0
    v_mfma_f32_16x16x32_bf16 v[220:223], v[188:191], v[64:67], 0
    s_lshl_b32 s27, s26, 1
    s_add_u32 s27, s27, 48
    s_lshl_b32 s27, s27, 7
    s_lshl_b32 s29, s25, 3
    s_lshl_b32 s30, s57, 1
    s_add_u32 s29, s29, s30
    s_add_u32 s64, s27, s29
    s_lshl_b32 s64, s64, 10
    s_add_u32 s65, s64, 131072
    s_lshr_b32 s27, s26, 1
    s_add_u32 s27, s27, 64
    s_lshl_b32 s27, s27, 7
    s_add_u32 s66, s27, s29
    s_lshl_b32 s66, s66, 10
    s_and_b32 s27, s26, 1
    s_lshl_b32 s27, s27, 9
    s_add_u32 s66, s66, s27
    v_and_b32 v69, 31, v1
    v_lshrrev_b32 v70, 5, v1
    v_lshlrev_b32 v70, 10, v70
    v_lshl_add_u32 v69, v69, 4, v70

    v_add_f32 v226, 897988541, v225
    v_rcp_f32 v226, v226
    s_nop 0
    v_mul_f32 v192, v192, v226
    v_mul_f32 v193, v193, v226
    v_mul_f32 v194, v194, v226
    v_mul_f32 v195, v195, v226
    v_mul_f32 v224, v224, v226
    v_cvt_pk_bf16_f32 v36, v192, v193
    v_cvt_pk_bf16_f32 v37, v194, v195

    v_add_f32 v230, 897988541, v229
    v_rcp_f32 v230, v230
    s_nop 0
    v_mul_f32 v196, v196, v230
    v_mul_f32 v197, v197, v230
    v_mul_f32 v198, v198, v230
    v_mul_f32 v199, v199, v230
    v_mul_f32 v228, v228, v230
    v_cvt_pk_bf16_f32 v40, v196, v197
    v_cvt_pk_bf16_f32 v41, v198, v199

    v_add_f32 v234, 897988541, v233
    v_rcp_f32 v234, v234
    s_nop 0
    v_mul_f32 v200, v200, v234
    v_mul_f32 v201, v201, v234
    v_mul_f32 v202, v202, v234
    v_mul_f32 v203, v203, v234
    v_mul_f32 v232, v232, v234
    v_cvt_pk_bf16_f32 v38, v200, v201
    v_cvt_pk_bf16_f32 v39, v202, v203

    v_cvt_pk_bf16_f32 v52, v224, v232
    buffer_store_dwordx4 v[36:39], v2, s[40:43], s64 offen offset:0 sc1
    v_add_f32 v238, 897988541, v237
    v_rcp_f32 v238, v238
    s_nop 0
    v_mul_f32 v204, v204, v238
    v_mul_f32 v205, v205, v238
    v_mul_f32 v206, v206, v238
    v_mul_f32 v207, v207, v238
    v_mul_f32 v236, v236, v238
    v_cvt_pk_bf16_f32 v42, v204, v205
    v_cvt_pk_bf16_f32 v43, v206, v207

    v_cvt_pk_bf16_f32 v54, v228, v236
    buffer_store_dwordx4 v[40:43], v2, s[40:43], s64 offen offset:1024 sc1
    v_add_f32 v242, 897988541, v241
    v_rcp_f32 v242, v242
    s_nop 0
    v_mul_f32 v208, v208, v242
    v_mul_f32 v209, v209, v242
    v_mul_f32 v210, v210, v242
    v_mul_f32 v211, v211, v242
    v_mul_f32 v240, v240, v242
    v_cvt_pk_bf16_f32 v44, v208, v209
    v_cvt_pk_bf16_f32 v45, v210, v211

    v_add_f32 v246, 897988541, v245
    v_rcp_f32 v246, v246
    s_nop 0
    v_mul_f32 v212, v212, v246
    v_mul_f32 v213, v213, v246
    v_mul_f32 v214, v214, v246
    v_mul_f32 v215, v215, v246
    v_mul_f32 v244, v244, v246
    v_cvt_pk_bf16_f32 v48, v212, v213
    v_cvt_pk_bf16_f32 v49, v214, v215

    v_add_f32 v250, 897988541, v249
    v_rcp_f32 v250, v250
    s_nop 0
    v_mul_f32 v216, v216, v250
    v_mul_f32 v217, v217, v250
    v_mul_f32 v218, v218, v250
    v_mul_f32 v219, v219, v250
    v_mul_f32 v248, v248, v250
    v_cvt_pk_bf16_f32 v46, v216, v217
    v_cvt_pk_bf16_f32 v47, v218, v219

    v_cvt_pk_bf16_f32 v53, v240, v248
    buffer_store_dwordx4 v[44:47], v2, s[40:43], s65 offen offset:0 sc1
    v_add_f32 v254, 897988541, v253
    v_rcp_f32 v254, v254
    s_nop 0
    v_mul_f32 v220, v220, v254
    v_mul_f32 v221, v221, v254
    v_mul_f32 v222, v222, v254
    v_mul_f32 v223, v223, v254
    v_mul_f32 v252, v252, v254
    v_cvt_pk_bf16_f32 v50, v220, v221
    v_cvt_pk_bf16_f32 v51, v222, v223

    v_cvt_pk_bf16_f32 v55, v244, v252
    buffer_store_dwordx4 v[48:51], v2, s[40:43], s65 offen offset:1024 sc1
    s_nop 1
    v_permlane32_swap_b32 v52, v54
    v_permlane32_swap_b32 v53, v55
    s_nop 1
    buffer_store_dwordx4 v[52:55], v69, s[40:43], s66 offen sc1
    s_waitcnt lgkmcnt(0)
    s_mov_b64 exec, 1
    ds_add_u32 v3, v7 offset:30752
    s_mov_b64 exec, -1
    s_lshl_b32 s62, s25, 3
    s_add_u32 s62, s62, s26
    s_lshl_b32 s62, s62, 7
    s_add_u32 s62, s62, 14811136

    s_waitcnt vmcnt(0)
    s_mov_b64 exec, 1
    ds_add_rtn_u32 v6, v3, v7 offset:30756
    s_mov_b64 exec, -1
    s_waitcnt lgkmcnt(0)
    v_readfirstlane_b32 s27, v6
    s_nop 1
    s_cmp_lg_u32 s27, 3
    s_cbranch_scc1 Q_NOFLAG

    v_mov_b32 v4, s58
    v_mov_b32 v5, s59
    s_mov_b64 exec, 1
    buffer_store_dwordx2 v[4:5], v3, s[40:43], s62 offen sc1
    s_mov_b64 exec, -1

Q_NOFLAG:
LS_50:
    ds_read_b32 v11, v3 offset:30732
    s_waitcnt lgkmcnt(0)
    v_readfirstlane_b32 s27, v11
    s_nop 1
    s_cmp_ge_u32 s27, 1
    s_cbranch_scc1 LS_50_D
    s_sleep 2
    s_branch LS_50

LS_50_D:
    s_add_u32 s65, s72, 163840
    s_mul_i32 s67, s83, 81920
    s_add_u32 s67, s67, s82
    s_add_u32 s67, s67, 1966080
    s_and_b32 s69, s83, 3
    s_mul_i32 s69, s69, 40960
    s_add_u32 s69, s69, s82
    s_add_u32 s69, s69, 2621440

    s_add_u32 s27, s67, 1024
    buffer_load_dwordx4 v[120:123], v2, s[40:43], s27 offen sc1
    s_add_u32 s27, s67, 2048
    buffer_load_dwordx4 v[124:127], v2, s[40:43], s27 offen sc1
    s_add_u32 s27, s67, 3072
    buffer_load_dwordx4 v[128:131], v2, s[40:43], s27 offen sc1
    s_add_u32 s27, s67, 4096
    buffer_load_dwordx4 v[132:135], v2, s[40:43], s27 offen sc1
    s_add_u32 s27, s67, 40960
    buffer_load_dwordx4 v[136:139], v2, s[40:43], s27 offen sc1
    s_add_u32 s27, s67, 41984
    buffer_load_dwordx4 v[140:143], v2, s[40:43], s27 offen sc1
    s_add_u32 s27, s67, 43008
    buffer_load_dwordx4 v[144:147], v2, s[40:43], s27 offen sc1
    s_add_u32 s27, s67, 44032
    buffer_load_dwordx4 v[148:151], v2, s[40:43], s27 offen sc1
    s_add_u32 s27, s67, 45056
    buffer_load_dwordx4 v[152:155], v2, s[40:43], s27 offen sc1
    s_setprio 0
    s_mov_b32 s75, 30740
    s_mov_b32 s71, 30748
P2_L:
    s_add_u32 s27, s65, 0
    buffer_load_dwordx4 v[76:79], v2, s[40:43], s27 offen sc1
    s_add_u32 s27, s65, 1024
    buffer_load_dwordx4 v[80:83], v2, s[40:43], s27 offen sc1
    s_add_u32 s27, s65, 2048
    buffer_load_dwordx4 v[84:87], v2, s[40:43], s27 offen sc1
    s_lshr_b32 s60, s80, 1
    s_lshl_b32 s60, s60, 3
    s_add_u32 s60, s60, s83
    s_lshl_b32 s60, s60, 9
    s_add_u32 s60, s60, 14680192
    s_lshr_b32 s29, s80, 1
    s_lshl_b32 s29, s29, 10
    s_add_u32 s29, s29, 14811136
    s_lshl_b32 s27, s83, 7
    s_add_u32 s61, s29, s27
    s_and_b32 s68, s83, 3
    s_lshl_b32 s27, s68, 8
    s_add_u32 s62, s29, s27
    s_add_u32 s63, s62, 128
    s_cmp_ge_u32 s24, 4
    s_cselect_b32 s62, s61, s62
    s_cselect_b32 s63, s61, s63
    v_mov_b32 v4, s61
    v_mov_b32 v3, s60
    v_cmp_lt_u32 vcc, 31, v1
    v_writelane_b32 v4, s62, 1
    v_writelane_b32 v4, s63, 2
    s_lshl_b32 s30, s80, 12
    s_add_u32 s64, s74, 524288
    s_add_u32 s65, s72, 163840
    v_cndmask_b32 v4, v4, v3, vcc
    s_lshl_b32 s66, s83, 18
    s_add_u32 s66, s66, s30
    s_add_u32 s66, s66, 6291456
    s_mul_i32 s67, s83, 81920
    s_add_u32 s67, s67, s82
    s_add_u32 s67, s67, 1966080
    s_lshl_b32 s68, s68, 17
    s_add_u32 s68, s68, s30
    s_add_u32 s68, s68, 8388608
    s_cmp_ge_u32 s24, 4
    s_cselect_b32 s68, 2130706432, s68
    s_mov_b32 s79, 200000
    s_mov_b32 s61, 0
    v_and_b32 v5, 15, v1
    s_lshl_b32 s27, s80, 6
    s_and_b32 s29, s24, 1
    s_lshl_b32 s30, s29, 5
    s_add_u32 s27, s27, s30
    v_add_u32 v5, s27, v5
    v_mul_u32_u24 v5, 1280, v5
    v_lshrrev_b32 v3, 4, v1
    v_lshl_add_u32 v5, v3, 3, v5
    s_mul_i32 s27, s81, 160
    v_add_u32 v5, s27, v5
    s_lshr_b32 s52, s24, 1
    s_lshl_b32 s56, s52, 10
    s_lshl_b32 s52, s52, 5
    s_add_u32 s53, s52, 20480
    s_bfe_u32 s57, s24, 0x10001
    s_mul_i32 s54, s57, 20480
    s_add_u32 s54, s54, 128
    s_cmp_ge_u32 s24, 4
    s_cselect_b32 s54, 2130706432, s54
    s_mul_i32 s55, s24, 10240
    s_add_u32 s55, s55, 32768
    s_mul_i32 s29, s29, 5120
    s_add_u32 s29, s29, 32768
    s_add_u32 s56, s56, s29
    s_lshl_b32 s57, s57, 3
    s_add_u32 s57, s57, s29
    s_add_u32 s57, s57, 4096

    s_mov_b32 s48, s18
    s_mov_b32 s49, s19
    s_mov_b32 s50, 2621440
    s_mov_b32 s51, 0x20000
    s_add_u32 s27, s65, 3072
    buffer_load_dwordx4 v[88:91], v2, s[40:43], s27 offen sc1
    s_add_u32 s27, s65, 4096
    buffer_load_dwordx4 v[92:95], v2, s[40:43], s27 offen sc1
    buffer_load_dwordx2 v[6:7], v4, s[40:43], 0 offen sc1
    s_add_u32 s27, s65, 40960
    buffer_load_dwordx4 v[96:99], v2, s[40:43], s27 offen sc1
    s_add_u32 s27, s65, 41984
    buffer_load_dwordx4 v[100:103], v2, s[40:43], s27 offen sc1
    s_add_u32 s27, s65, 43008
    buffer_load_dwordx4 v[104:107], v2, s[40:43], s27 offen sc1
    s_add_u32 s27, s65, 44032
    buffer_load_dwordx4 v[108:111], v2, s[40:43], s27 offen sc1
    s_add_u32 s27, s65, 45056
    buffer_load_dwordx4 v[112:115], v2, s[40:43], s27 offen sc1
    s_add_u32 s27, s67, 0
    buffer_load_dwordx4 v[116:119], v2, s[40:43], s27 offen sc1
    v_mov_b32 v176, 0
    v_mov_b32 v177, 0
    v_mov_b32 v178, 0
    v_mov_b32 v179, 0
    v_mov_b32 v180, 0
    v_mov_b32 v181, 0
    v_mov_b32 v182, 0
    v_mov_b32 v183, 0
    v_mov_b32 v184, 0
    v_mov_b32 v185, 0
    v_mov_b32 v186, 0
    v_mov_b32 v187, 0
    v_mov_b32 v188, 0
    v_mov_b32 v189, 0
    v_mov_b32 v190, 0
    v_mov_b32 v191, 0
    v_mov_b32 v192, 0
    v_mov_b32 v193, 0
    v_mov_b32 v194, 0
    v_mov_b32 v195, 0
    v_mov_b32 v196, 0
    v_mov_b32 v197, 0
    v_mov_b32 v198, 0
    v_mov_b32 v199, 0
    v_mov_b32 v200, 0
    v_mov_b32 v201, 0
    v_mov_b32 v202, 0
    v_mov_b32 v203, 0
    v_mov_b32 v204, 0
    v_mov_b32 v205, 0
    v_mov_b32 v206, 0
    v_mov_b32 v207, 0
    v_mov_b32 v208, 0
    v_mov_b32 v209, 0
    v_mov_b32 v210, 0
    v_mov_b32 v211, 0
    v_mov_b32 v212, 0
    v_mov_b32 v213, 0
    v_mov_b32 v214, 0
    v_mov_b32 v215, 0
    v_mov_b32 v216, 0
    v_mov_b32 v217, 0
    v_mov_b32 v218, 0
    v_mov_b32 v219, 0
    v_mov_b32 v220, 0
    v_mov_b32 v221, 0
    v_mov_b32 v222, 0
    v_mov_b32 v223, 0
    v_mov_b32 v224, 0
    v_mov_b32 v225, 0
    v_mov_b32 v226, 0
    v_mov_b32 v227, 0
    v_mov_b32 v228, 0
    v_mov_b32 v229, 0
    v_mov_b32 v230, 0
    v_mov_b32 v231, 0
    v_mov_b32 v232, 0
    v_mov_b32 v233, 0
    v_mov_b32 v234, 0
    v_mov_b32 v235, 0
    v_mov_b32 v236, 0
    v_mov_b32 v237, 0
    v_mov_b32 v238, 0
    v_mov_b32 v239, 0
    v_mov_b32 v240, 0
    v_mov_b32 v241, 0
    v_mov_b32 v242, 0
    v_mov_b32 v243, 0
    v_mov_b32 v244, 0
    v_mov_b32 v245, 0
    v_mov_b32 v246, 0
    v_mov_b32 v247, 0
    v_mov_b32 v248, 0
    v_mov_b32 v249, 0
    v_mov_b32 v250, 0
    v_mov_b32 v251, 0
    v_mov_b32 v252, 0
    v_mov_b32 v253, 0
    v_mov_b32 v254, 0
    v_mov_b32 v255, 0
    s_waitcnt vmcnt(6)
    s_branch P2_CHK
P2_E:
    s_lshr_b32 s60, s80, 1
    s_lshl_b32 s60, s60, 3
    s_add_u32 s60, s60, s83
    s_lshl_b32 s60, s60, 9
    s_add_u32 s60, s60, 14680064
    s_xor_b32 s61, s60, 2048
    v_mov_b32 v4, s60
    v_writelane_b32 v4, s61, 1
    s_mov_b32 s79, 200000

P2_EP:
    buffer_load_dwordx2 v[6:7], v4, s[40:43], 0 offen sc1
    s_waitcnt vmcnt(0)
    v_cmp_ne_u64 vcc, s[58:59], v[6:7]
    s_nop 1
    s_cmp_eq_u64 vcc, 0
    s_cbranch_scc1 P2_EG
    s_sub_u32 s79, s79, 1
    s_cbranch_scc1 P2_EG
    s_sleep 4
    s_branch P2_EP

P2_EG:
    s_add_u32 s27, s74, 0
    buffer_load_dwordx4 v[8:11], v2, s[40:43], s27 offen offset:0 sc1
    buffer_load_dwordx4 v[12:15], v2, s[40:43], s27 offen offset:1024 sc1
    buffer_load_dwordx4 v[16:19], v2, s[40:43], s27 offen offset:2048 sc1
    buffer_load_dwordx4 v[20:23], v2, s[40:43], s27 offen offset:3072 sc1
    s_add_u32 s27, s74, 131072
    buffer_load_dwordx4 v[24:27], v2, s[40:43], s27 offen offset:0 sc1
    buffer_load_dwordx4 v[28:31], v2, s[40:43], s27 offen offset:1024 sc1
    buffer_load_dwordx4 v[32:35], v2, s[40:43], s27 offen offset:2048 sc1
    buffer_load_dwordx4 v[36:39], v2, s[40:43], s27 offen offset:3072 sc1
    s_add_u32 s27, s74, 262144
    buffer_load_dwordx4 v[40:43], v2, s[40:43], s27 offen offset:0 sc1
    buffer_load_dwordx4 v[44:47], v2, s[40:43], s27 offen offset:1024 sc1
    buffer_load_dwordx4 v[48:51], v2, s[40:43], s27 offen offset:2048 sc1
    buffer_load_dwordx4 v[52:55], v2, s[40:43], s27 offen offset:3072 sc1
    s_lshr_b32 s60, s80, 1
    s_lshl_b32 s60, s60, 3
    s_add_u32 s60, s60, s83
    s_lshl_b32 s60, s60, 9
    s_add_u32 s60, s60, 14680192
    s_lshr_b32 s29, s80, 1
    s_lshl_b32 s29, s29, 10
    s_add_u32 s29, s29, 14811136
    s_lshl_b32 s27, s83, 7
    s_add_u32 s61, s29, s27
    s_and_b32 s68, s83, 3
    s_lshl_b32 s27, s68, 8
    s_add_u32 s62, s29, s27
    s_add_u32 s63, s62, 128
    s_cmp_ge_u32 s24, 4
    s_cselect_b32 s62, s61, s62
    s_cselect_b32 s63, s61, s63
    v_mov_b32 v4, s61
    v_mov_b32 v3, s60
    v_cmp_lt_u32 vcc, 31, v1
    v_writelane_b32 v4, s62, 1
    v_writelane_b32 v4, s63, 2
    s_lshl_b32 s30, s80, 12
    s_add_u32 s64, s74, 524288
    s_add_u32 s65, s72, 163840
    v_cndmask_b32 v4, v4, v3, vcc
    s_lshl_b32 s66, s83, 18
    s_add_u32 s66, s66, s30
    s_add_u32 s66, s66, 6291456
    s_mul_i32 s67, s83, 81920
    s_add_u32 s67, s67, s82
    s_add_u32 s67, s67, 1966080
    s_lshl_b32 s68, s68, 17
    s_add_u32 s68, s68, s30
    s_add_u32 s68, s68, 8388608
    s_cmp_ge_u32 s24, 4
    s_cselect_b32 s68, 2130706432, s68
    s_mov_b32 s79, 200000
    s_mov_b32 s61, 0
    v_and_b32 v5, 15, v1
    s_lshl_b32 s27, s80, 6
    s_and_b32 s29, s24, 1
    s_lshl_b32 s30, s29, 5
    s_add_u32 s27, s27, s30
    v_add_u32 v5, s27, v5
    v_mul_u32_u24 v5, 1280, v5
    v_lshrrev_b32 v3, 4, v1
    v_lshl_add_u32 v5, v3, 3, v5
    s_mul_i32 s27, s81, 160
    v_add_u32 v5, s27, v5
    s_lshr_b32 s52, s24, 1
    s_lshl_b32 s56, s52, 10
    s_lshl_b32 s52, s52, 5
    s_add_u32 s53, s52, 20480
    s_bfe_u32 s57, s24, 0x10001
    s_mul_i32 s54, s57, 20480
    s_add_u32 s54, s54, 128
    s_cmp_ge_u32 s24, 4
    s_cselect_b32 s54, 2130706432, s54
    s_mul_i32 s55, s24, 10240
    s_add_u32 s55, s55, 32768
    s_mul_i32 s29, s29, 5120
    s_add_u32 s29, s29, 32768
    s_add_u32 s56, s56, s29
    s_lshl_b32 s57, s57, 3
    s_add_u32 s57, s57, s29
    s_add_u32 s57, s57, 4096

    s_mov_b32 s48, s18
    s_mov_b32 s49, s19
    s_mov_b32 s50, 2621440
    s_mov_b32 s51, 0x20000
    s_add_u32 s27, s76, 32768
    v_add_u32 v3, s27, v2
    s_waitcnt vmcnt(8)
    v_mfma_f32_16x16x32_bf16 v[176:179], v[56:59], v[8:11], 0
    v_mfma_f32_16x16x32_bf16 v[196:199], v[56:59], v[12:15], 0
    v_mfma_f32_16x16x32_bf16 v[216:219], v[56:59], v[16:19], 0
    v_mfma_f32_16x16x32_bf16 v[236:239], v[56:59], v[20:23], 0
    v_mfma_f32_16x16x32_bf16 v[180:183], v[60:63], v[8:11], 0
    v_mfma_f32_16x16x32_bf16 v[200:203], v[60:63], v[12:15], 0
    v_mfma_f32_16x16x32_bf16 v[220:223], v[60:63], v[16:19], 0
    v_mfma_f32_16x16x32_bf16 v[240:243], v[60:63], v[20:23], 0
    v_mfma_f32_16x16x32_bf16 v[184:187], v[64:67], v[8:11], 0
    v_mfma_f32_16x16x32_bf16 v[204:207], v[64:67], v[12:15], 0
    v_mfma_f32_16x16x32_bf16 v[224:227], v[64:67], v[16:19], 0
    v_mfma_f32_16x16x32_bf16 v[244:247], v[64:67], v[20:23], 0
    v_mfma_f32_16x16x32_bf16 v[188:191], v[68:71], v[8:11], 0
    v_mfma_f32_16x16x32_bf16 v[208:211], v[68:71], v[12:15], 0
    v_mfma_f32_16x16x32_bf16 v[228:231], v[68:71], v[16:19], 0
    v_mfma_f32_16x16x32_bf16 v[248:251], v[68:71], v[20:23], 0
    v_mfma_f32_16x16x32_bf16 v[192:195], v[72:75], v[8:11], 0
    v_mfma_f32_16x16x32_bf16 v[212:215], v[72:75], v[12:15], 0
    v_mfma_f32_16x16x32_bf16 v[232:235], v[72:75], v[16:19], 0
    v_mfma_f32_16x16x32_bf16 v[252:255], v[72:75], v[20:23], 0
    s_add_u32 s70, s74, 393216
    buffer_load_dwordx4 v[8:11], v2, s[40:43], s70 offen offset:0 sc1
    buffer_load_dwordx4 v[12:15], v2, s[40:43], s70 offen offset:1024 sc1
    buffer_load_dwordx4 v[16:19], v2, s[40:43], s70 offen offset:2048 sc1
    buffer_load_dwordx4 v[20:23], v2, s[40:43], s70 offen offset:3072 sc1
    s_add_u32 s27, s73, 81920
    buffer_load_dwordx4 v[56:59], v2, s[40:43], s27 offen sc1
    s_add_u32 s27, s73, 82944
    buffer_load_dwordx4 v[60:63], v2, s[40:43], s27 offen sc1
    s_add_u32 s27, s73, 83968
    buffer_load_dwordx4 v[64:67], v2, s[40:43], s27 offen sc1
    s_add_u32 s27, s73, 84992
    buffer_load_dwordx4 v[68:71], v2, s[40:43], s27 offen sc1
    s_add_u32 s27, s73, 86016
    buffer_load_dwordx4 v[72:75], v2, s[40:43], s27 offen sc1
    s_waitcnt vmcnt(13)
    v_mfma_f32_16x16x32_bf16 v[176:179], v[76:79], v[24:27], v[176:179]
    v_mfma_f32_16x16x32_bf16 v[196:199], v[76:79], v[28:31], v[196:199]
    v_mfma_f32_16x16x32_bf16 v[216:219], v[76:79], v[32:35], v[216:219]
    v_mfma_f32_16x16x32_bf16 v[236:239], v[76:79], v[36:39], v[236:239]
    v_mfma_f32_16x16x32_bf16 v[180:183], v[80:83], v[24:27], v[180:183]
    v_mfma_f32_16x16x32_bf16 v[200:203], v[80:83], v[28:31], v[200:203]
    v_mfma_f32_16x16x32_bf16 v[220:223], v[80:83], v[32:35], v[220:223]
    v_mfma_f32_16x16x32_bf16 v[240:243], v[80:83], v[36:39], v[240:243]
    v_mfma_f32_16x16x32_bf16 v[184:187], v[84:87], v[24:27], v[184:187]
    v_mfma_f32_16x16x32_bf16 v[204:207], v[84:87], v[28:31], v[204:207]
    v_mfma_f32_16x16x32_bf16 v[224:227], v[84:87], v[32:35], v[224:227]
    v_mfma_f32_16x16x32_bf16 v[244:247], v[84:87], v[36:39], v[244:247]
    v_mfma_f32_16x16x32_bf16 v[188:191], v[88:91], v[24:27], v[188:191]
    v_mfma_f32_16x16x32_bf16 v[208:211], v[88:91], v[28:31], v[208:211]
    v_mfma_f32_16x16x32_bf16 v[228:231], v[88:91], v[32:35], v[228:231]
    v_mfma_f32_16x16x32_bf16 v[248:251], v[88:91], v[36:39], v[248:251]
    v_mfma_f32_16x16x32_bf16 v[192:195], v[92:95], v[24:27], v[192:195]
    v_mfma_f32_16x16x32_bf16 v[212:215], v[92:95], v[28:31], v[212:215]
    v_mfma_f32_16x16x32_bf16 v[232:235], v[92:95], v[32:35], v[232:235]
    v_mfma_f32_16x16x32_bf16 v[252:255], v[92:95], v[36:39], v[252:255]
    s_add_u32 s70, s77, 0
    buffer_load_dwordx4 v[24:27], v2, s[40:43], s70 offen offset:0 sc1
    buffer_load_dwordx4 v[28:31], v2, s[40:43], s70 offen offset:1024 sc1
    buffer_load_dwordx4 v[32:35], v2, s[40:43], s70 offen offset:2048 sc1
    buffer_load_dwordx4 v[36:39], v2, s[40:43], s70 offen offset:3072 sc1
    s_add_u32 s27, s73, 122880
    buffer_load_dwordx4 v[76:79], v2, s[40:43], s27 offen sc1
    s_add_u32 s27, s73, 123904
    buffer_load_dwordx4 v[80:83], v2, s[40:43], s27 offen sc1
    s_add_u32 s27, s73, 124928
    buffer_load_dwordx4 v[84:87], v2, s[40:43], s27 offen sc1
    s_add_u32 s27, s73, 125952
    buffer_load_dwordx4 v[88:91], v2, s[40:43], s27 offen sc1
    s_add_u32 s27, s73, 126976
    buffer_load_dwordx4 v[92:95], v2, s[40:43], s27 offen sc1
    s_waitcnt vmcnt(18)
    v_mfma_f32_16x16x32_bf16 v[176:179], v[96:99], v[40:43], v[176:179]
    v_mfma_f32_16x16x32_bf16 v[196:199], v[96:99], v[44:47], v[196:199]
    v_mfma_f32_16x16x32_bf16 v[216:219], v[96:99], v[48:51], v[216:219]
    v_mfma_f32_16x16x32_bf16 v[236:239], v[96:99], v[52:55], v[236:239]
    v_mfma_f32_16x16x32_bf16 v[180:183], v[100:103], v[40:43], v[180:183]
    v_mfma_f32_16x16x32_bf16 v[200:203], v[100:103], v[44:47], v[200:203]
    v_mfma_f32_16x16x32_bf16 v[220:223], v[100:103], v[48:51], v[220:223]
    v_mfma_f32_16x16x32_bf16 v[240:243], v[100:103], v[52:55], v[240:243]
    v_mfma_f32_16x16x32_bf16 v[184:187], v[104:107], v[40:43], v[184:187]
    v_mfma_f32_16x16x32_bf16 v[204:207], v[104:107], v[44:47], v[204:207]
    v_mfma_f32_16x16x32_bf16 v[224:227], v[104:107], v[48:51], v[224:227]
    v_mfma_f32_16x16x32_bf16 v[244:247], v[104:107], v[52:55], v[244:247]
    v_mfma_f32_16x16x32_bf16 v[188:191], v[108:111], v[40:43], v[188:191]
    v_mfma_f32_16x16x32_bf16 v[208:211], v[108:111], v[44:47], v[208:211]
    v_mfma_f32_16x16x32_bf16 v[228:231], v[108:111], v[48:51], v[228:231]
    v_mfma_f32_16x16x32_bf16 v[248:251], v[108:111], v[52:55], v[248:251]
    v_mfma_f32_16x16x32_bf16 v[192:195], v[112:115], v[40:43], v[192:195]
    v_mfma_f32_16x16x32_bf16 v[212:215], v[112:115], v[44:47], v[212:215]
    v_mfma_f32_16x16x32_bf16 v[232:235], v[112:115], v[48:51], v[232:235]
    v_mfma_f32_16x16x32_bf16 v[252:255], v[112:115], v[52:55], v[252:255]
    s_add_u32 s70, s77, 131072
    buffer_load_dwordx4 v[40:43], v2, s[40:43], s70 offen offset:0 sc1
    buffer_load_dwordx4 v[44:47], v2, s[40:43], s70 offen offset:1024 sc1
    buffer_load_dwordx4 v[48:51], v2, s[40:43], s70 offen offset:2048 sc1
    buffer_load_dwordx4 v[52:55], v2, s[40:43], s70 offen offset:3072 sc1
    ds_read_b128 v[96:99], v3 offset:0
    ds_read_b128 v[100:103], v3 offset:1024
    ds_read_b128 v[104:107], v3 offset:2048
    ds_read_b128 v[108:111], v3 offset:3072
    ds_read_b128 v[112:115], v3 offset:16384
    s_waitcnt vmcnt(18)
    v_mfma_f32_16x16x32_bf16 v[176:179], v[116:119], v[8:11], v[176:179]
    v_mfma_f32_16x16x32_bf16 v[196:199], v[116:119], v[12:15], v[196:199]
    v_mfma_f32_16x16x32_bf16 v[216:219], v[116:119], v[16:19], v[216:219]
    v_mfma_f32_16x16x32_bf16 v[236:239], v[116:119], v[20:23], v[236:239]
    v_mfma_f32_16x16x32_bf16 v[180:183], v[120:123], v[8:11], v[180:183]
    v_mfma_f32_16x16x32_bf16 v[200:203], v[120:123], v[12:15], v[200:203]
    v_mfma_f32_16x16x32_bf16 v[220:223], v[120:123], v[16:19], v[220:223]
    v_mfma_f32_16x16x32_bf16 v[240:243], v[120:123], v[20:23], v[240:243]
    v_mfma_f32_16x16x32_bf16 v[184:187], v[124:127], v[8:11], v[184:187]
    v_mfma_f32_16x16x32_bf16 v[204:207], v[124:127], v[12:15], v[204:207]
    v_mfma_f32_16x16x32_bf16 v[224:227], v[124:127], v[16:19], v[224:227]
    v_mfma_f32_16x16x32_bf16 v[244:247], v[124:127], v[20:23], v[244:247]
    v_mfma_f32_16x16x32_bf16 v[188:191], v[128:131], v[8:11], v[188:191]
    v_mfma_f32_16x16x32_bf16 v[208:211], v[128:131], v[12:15], v[208:211]
    v_mfma_f32_16x16x32_bf16 v[228:231], v[128:131], v[16:19], v[228:231]
    v_mfma_f32_16x16x32_bf16 v[248:251], v[128:131], v[20:23], v[248:251]
    v_mfma_f32_16x16x32_bf16 v[192:195], v[132:135], v[8:11], v[192:195]
    v_mfma_f32_16x16x32_bf16 v[212:215], v[132:135], v[12:15], v[212:215]
    v_mfma_f32_16x16x32_bf16 v[232:235], v[132:135], v[16:19], v[232:235]
    v_mfma_f32_16x16x32_bf16 v[252:255], v[132:135], v[20:23], v[252:255]
    s_add_u32 s70, s77, 262144
    buffer_load_dwordx4 v[8:11], v2, s[40:43], s70 offen offset:0 sc1
    buffer_load_dwordx4 v[12:15], v2, s[40:43], s70 offen offset:1024 sc1
    buffer_load_dwordx4 v[16:19], v2, s[40:43], s70 offen offset:2048 sc1
    buffer_load_dwordx4 v[20:23], v2, s[40:43], s70 offen offset:3072 sc1
    ds_read_b128 v[116:119], v3 offset:17408
    ds_read_b128 v[120:123], v3 offset:18432
    ds_read_b128 v[124:127], v3 offset:19456
    ds_read_b128 v[128:131], v3 offset:32768
    ds_read_b128 v[132:135], v3 offset:33792
    s_waitcnt vmcnt(13)
    v_mfma_f32_16x16x32_bf16 v[176:179], v[136:139], v[24:27], v[176:179]
    v_mfma_f32_16x16x32_bf16 v[196:199], v[136:139], v[28:31], v[196:199]
    v_mfma_f32_16x16x32_bf16 v[216:219], v[136:139], v[32:35], v[216:219]
    v_mfma_f32_16x16x32_bf16 v[236:239], v[136:139], v[36:39], v[236:239]
    v_mfma_f32_16x16x32_bf16 v[180:183], v[140:143], v[24:27], v[180:183]
    v_mfma_f32_16x16x32_bf16 v[200:203], v[140:143], v[28:31], v[200:203]
    v_mfma_f32_16x16x32_bf16 v[220:223], v[140:143], v[32:35], v[220:223]
    v_mfma_f32_16x16x32_bf16 v[240:243], v[140:143], v[36:39], v[240:243]
    v_mfma_f32_16x16x32_bf16 v[184:187], v[144:147], v[24:27], v[184:187]
    v_mfma_f32_16x16x32_bf16 v[204:207], v[144:147], v[28:31], v[204:207]
    v_mfma_f32_16x16x32_bf16 v[224:227], v[144:147], v[32:35], v[224:227]
    v_mfma_f32_16x16x32_bf16 v[244:247], v[144:147], v[36:39], v[244:247]
    v_mfma_f32_16x16x32_bf16 v[188:191], v[148:151], v[24:27], v[188:191]
    v_mfma_f32_16x16x32_bf16 v[208:211], v[148:151], v[28:31], v[208:211]
    v_mfma_f32_16x16x32_bf16 v[228:231], v[148:151], v[32:35], v[228:231]
    v_mfma_f32_16x16x32_bf16 v[248:251], v[148:151], v[36:39], v[248:251]
    v_mfma_f32_16x16x32_bf16 v[192:195], v[152:155], v[24:27], v[192:195]
    v_mfma_f32_16x16x32_bf16 v[212:215], v[152:155], v[28:31], v[212:215]
    v_mfma_f32_16x16x32_bf16 v[232:235], v[152:155], v[32:35], v[232:235]
    v_mfma_f32_16x16x32_bf16 v[252:255], v[152:155], v[36:39], v[252:255]
    s_add_u32 s70, s77, 393216
    buffer_load_dwordx4 v[24:27], v2, s[40:43], s70 offen offset:0 sc1
    buffer_load_dwordx4 v[28:31], v2, s[40:43], s70 offen offset:1024 sc1
    buffer_load_dwordx4 v[32:35], v2, s[40:43], s70 offen offset:2048 sc1
    buffer_load_dwordx4 v[36:39], v2, s[40:43], s70 offen offset:3072 sc1
    ds_read_b128 v[136:139], v3 offset:34816
    ds_read_b128 v[140:143], v3 offset:35840
    ds_read_b128 v[144:147], v3 offset:49152
    ds_read_b128 v[148:151], v3 offset:50176
    ds_read_b128 v[152:155], v3 offset:51200
    s_waitcnt vmcnt(8)
    v_mfma_f32_16x16x32_bf16 v[176:179], v[156:159], v[40:43], v[176:179]
    v_mfma_f32_16x16x32_bf16 v[196:199], v[156:159], v[44:47], v[196:199]
    v_mfma_f32_16x16x32_bf16 v[216:219], v[156:159], v[48:51], v[216:219]
    v_mfma_f32_16x16x32_bf16 v[236:239], v[156:159], v[52:55], v[236:239]
    v_mfma_f32_16x16x32_bf16 v[180:183], v[160:163], v[40:43], v[180:183]
    v_mfma_f32_16x16x32_bf16 v[200:203], v[160:163], v[44:47], v[200:203]
    v_mfma_f32_16x16x32_bf16 v[220:223], v[160:163], v[48:51], v[220:223]
    v_mfma_f32_16x16x32_bf16 v[240:243], v[160:163], v[52:55], v[240:243]
    v_mfma_f32_16x16x32_bf16 v[184:187], v[164:167], v[40:43], v[184:187]
    v_mfma_f32_16x16x32_bf16 v[204:207], v[164:167], v[44:47], v[204:207]
    v_mfma_f32_16x16x32_bf16 v[224:227], v[164:167], v[48:51], v[224:227]
    v_mfma_f32_16x16x32_bf16 v[244:247], v[164:167], v[52:55], v[244:247]
    v_mfma_f32_16x16x32_bf16 v[188:191], v[168:171], v[40:43], v[188:191]
    v_mfma_f32_16x16x32_bf16 v[208:211], v[168:171], v[44:47], v[208:211]
    v_mfma_f32_16x16x32_bf16 v[228:231], v[168:171], v[48:51], v[228:231]
    v_mfma_f32_16x16x32_bf16 v[248:251], v[168:171], v[52:55], v[248:251]
    v_mfma_f32_16x16x32_bf16 v[192:195], v[172:175], v[40:43], v[192:195]
    v_mfma_f32_16x16x32_bf16 v[212:215], v[172:175], v[44:47], v[212:215]
    v_mfma_f32_16x16x32_bf16 v[232:235], v[172:175], v[48:51], v[232:235]
    v_mfma_f32_16x16x32_bf16 v[252:255], v[172:175], v[52:55], v[252:255]
    s_waitcnt vmcnt(4)
    v_mfma_f32_16x16x32_bf16 v[176:179], v[56:59], v[8:11], v[176:179]
    v_mfma_f32_16x16x32_bf16 v[196:199], v[56:59], v[12:15], v[196:199]
    v_mfma_f32_16x16x32_bf16 v[216:219], v[56:59], v[16:19], v[216:219]
    v_mfma_f32_16x16x32_bf16 v[236:239], v[56:59], v[20:23], v[236:239]
    v_mfma_f32_16x16x32_bf16 v[180:183], v[60:63], v[8:11], v[180:183]
    v_mfma_f32_16x16x32_bf16 v[200:203], v[60:63], v[12:15], v[200:203]
    v_mfma_f32_16x16x32_bf16 v[220:223], v[60:63], v[16:19], v[220:223]
    v_mfma_f32_16x16x32_bf16 v[240:243], v[60:63], v[20:23], v[240:243]
    v_mfma_f32_16x16x32_bf16 v[184:187], v[64:67], v[8:11], v[184:187]
    v_mfma_f32_16x16x32_bf16 v[204:207], v[64:67], v[12:15], v[204:207]
    v_mfma_f32_16x16x32_bf16 v[224:227], v[64:67], v[16:19], v[224:227]
    v_mfma_f32_16x16x32_bf16 v[244:247], v[64:67], v[20:23], v[244:247]
    v_mfma_f32_16x16x32_bf16 v[188:191], v[68:71], v[8:11], v[188:191]
    v_mfma_f32_16x16x32_bf16 v[208:211], v[68:71], v[12:15], v[208:211]
    v_mfma_f32_16x16x32_bf16 v[228:231], v[68:71], v[16:19], v[228:231]
    v_mfma_f32_16x16x32_bf16 v[248:251], v[68:71], v[20:23], v[248:251]
    v_mfma_f32_16x16x32_bf16 v[192:195], v[72:75], v[8:11], v[192:195]
    v_mfma_f32_16x16x32_bf16 v[212:215], v[72:75], v[12:15], v[212:215]
    v_mfma_f32_16x16x32_bf16 v[232:235], v[72:75], v[16:19], v[232:235]
    v_mfma_f32_16x16x32_bf16 v[252:255], v[72:75], v[20:23], v[252:255]
    buffer_load_dwordx2 v[6:7], v4, s[40:43], 0 offen sc1
    s_waitcnt vmcnt(1)
    v_mfma_f32_16x16x32_bf16 v[176:179], v[76:79], v[24:27], v[176:179]
    v_mfma_f32_16x16x32_bf16 v[196:199], v[76:79], v[28:31], v[196:199]
    v_mfma_f32_16x16x32_bf16 v[216:219], v[76:79], v[32:35], v[216:219]
    v_mfma_f32_16x16x32_bf16 v[236:239], v[76:79], v[36:39], v[236:239]
    v_mfma_f32_16x16x32_bf16 v[180:183], v[80:83], v[24:27], v[180:183]
    v_mfma_f32_16x16x32_bf16 v[200:203], v[80:83], v[28:31], v[200:203]
    v_mfma_f32_16x16x32_bf16 v[220:223], v[80:83], v[32:35], v[220:223]
    v_mfma_f32_16x16x32_bf16 v[240:243], v[80:83], v[36:39], v[240:243]
    v_mfma_f32_16x16x32_bf16 v[184:187], v[84:87], v[24:27], v[184:187]
    v_mfma_f32_16x16x32_bf16 v[204:207], v[84:87], v[28:31], v[204:207]
    v_mfma_f32_16x16x32_bf16 v[224:227], v[84:87], v[32:35], v[224:227]
    v_mfma_f32_16x16x32_bf16 v[244:247], v[84:87], v[36:39], v[244:247]
    v_mfma_f32_16x16x32_bf16 v[188:191], v[88:91], v[24:27], v[188:191]
    v_mfma_f32_16x16x32_bf16 v[208:211], v[88:91], v[28:31], v[208:211]
    v_mfma_f32_16x16x32_bf16 v[228:231], v[88:91], v[32:35], v[228:231]
    v_mfma_f32_16x16x32_bf16 v[248:251], v[88:91], v[36:39], v[248:251]
    v_mfma_f32_16x16x32_bf16 v[192:195], v[92:95], v[24:27], v[192:195]
    v_mfma_f32_16x16x32_bf16 v[212:215], v[92:95], v[28:31], v[212:215]
    v_mfma_f32_16x16x32_bf16 v[232:235], v[92:95], v[32:35], v[232:235]
    v_mfma_f32_16x16x32_bf16 v[252:255], v[92:95], v[36:39], v[252:255]
    s_add_u32 s70, s65, 0
    buffer_load_dwordx4 v[76:79], v2, s[40:43], s70 offen offset:0 sc1
    buffer_load_dwordx4 v[80:83], v2, s[40:43], s70 offen offset:1024 sc1
    buffer_load_dwordx4 v[84:87], v2, s[40:43], s70 offen offset:2048 sc1
    buffer_load_dwordx4 v[88:91], v2, s[40:43], s70 offen offset:3072 sc1
    s_add_u32 s70, s70, 4096
    buffer_load_dwordx4 v[92:95], v2, s[40:43], s70 offen offset:0 sc1
    ds_read_b128 v[72:75], v3 offset:52224
    v_mov_b32 v172, s71
    v_mov_b32 v173, 1
    s_waitcnt lgkmcnt(0)
    s_mov_b64 exec, 1
    ds_add_u32 v172, v173 offset:0
    s_mov_b64 exec, -1
    v_add_u32 v3, 98304, v3
    s_waitcnt vmcnt(5)
    s_branch P2_CHK
P2_POLL:
    s_sleep 3
    buffer_load_dwordx2 v[6:7], v4, s[40:43], 0 offen sc1
    s_waitcnt vmcnt(0)
P2_CHK:
    v_cmp_ne_u64 vcc, s[58:59], v[6:7]
    s_sub_u32 s79, s79, 1
    s_cselect_b32 s79, 0, s79
    s_nop 0
    s_cselect_b64 vcc, 0, vcc
    s_or_b32 s62, vcc_lo, vcc_hi
    s_or_b32 s62, s62, s61
    s_cbranch_scc0 P2_ALL
    s_and_b32 s62, s61, 2
    s_or_b32 s62, s62, vcc_lo
    s_cbranch_scc0 P2_O
    s_and_b32 s62, s61, 1
    s_or_b32 s62, s62, vcc_hi
    s_cbranch_scc1 P2_POLL

    s_add_u32 s27, s64, 0
    buffer_load_dwordx4 v[8:11], v2, s[40:43], s27 offen offset:0 sc1
    buffer_load_dwordx4 v[12:15], v2, s[40:43], s27 offen offset:1024 sc1
    buffer_load_dwordx4 v[16:19], v2, s[40:43], s27 offen offset:2048 sc1
    buffer_load_dwordx4 v[20:23], v2, s[40:43], s27 offen offset:3072 sc1
    s_add_u32 s27, s64, 131072
    buffer_load_dwordx4 v[24:27], v2, s[40:43], s27 offen offset:0 sc1
    buffer_load_dwordx4 v[28:31], v2, s[40:43], s27 offen offset:1024 sc1
    buffer_load_dwordx4 v[32:35], v2, s[40:43], s27 offen offset:2048 sc1
    buffer_load_dwordx4 v[36:39], v2, s[40:43], s27 offen offset:3072 sc1
    s_waitcnt vmcnt(4)
    v_mfma_f32_16x16x32_bf16 v[176:179], v[76:79], v[8:11], v[176:179]
    v_mfma_f32_16x16x32_bf16 v[196:199], v[76:79], v[12:15], v[196:199]
    v_mfma_f32_16x16x32_bf16 v[216:219], v[76:79], v[16:19], v[216:219]
    v_mfma_f32_16x16x32_bf16 v[236:239], v[76:79], v[20:23], v[236:239]
    v_mfma_f32_16x16x32_bf16 v[180:183], v[80:83], v[8:11], v[180:183]
    v_mfma_f32_16x16x32_bf16 v[200:203], v[80:83], v[12:15], v[200:203]
    v_mfma_f32_16x16x32_bf16 v[220:223], v[80:83], v[16:19], v[220:223]
    v_mfma_f32_16x16x32_bf16 v[240:243], v[80:83], v[20:23], v[240:243]
    v_mfma_f32_16x16x32_bf16 v[184:187], v[84:87], v[8:11], v[184:187]
    v_mfma_f32_16x16x32_bf16 v[204:207], v[84:87], v[12:15], v[204:207]
    v_mfma_f32_16x16x32_bf16 v[224:227], v[84:87], v[16:19], v[224:227]
    v_mfma_f32_16x16x32_bf16 v[244:247], v[84:87], v[20:23], v[244:247]
    v_mfma_f32_16x16x32_bf16 v[188:191], v[88:91], v[8:11], v[188:191]
    v_mfma_f32_16x16x32_bf16 v[208:211], v[88:91], v[12:15], v[208:211]
    v_mfma_f32_16x16x32_bf16 v[228:231], v[88:91], v[16:19], v[228:231]
    v_mfma_f32_16x16x32_bf16 v[248:251], v[88:91], v[20:23], v[248:251]
    v_mfma_f32_16x16x32_bf16 v[192:195], v[92:95], v[8:11], v[192:195]
    v_mfma_f32_16x16x32_bf16 v[212:215], v[92:95], v[12:15], v[212:215]
    v_mfma_f32_16x16x32_bf16 v[232:235], v[92:95], v[16:19], v[232:235]
    v_mfma_f32_16x16x32_bf16 v[252:255], v[92:95], v[20:23], v[252:255]
    buffer_load_dwordx2 v[6:7], v4, s[40:43], 0 offen sc1
    s_waitcnt vmcnt(1)
    v_mfma_f32_16x16x32_bf16 v[176:179], v[96:99], v[24:27], v[176:179]
    v_mfma_f32_16x16x32_bf16 v[196:199], v[96:99], v[28:31], v[196:199]
    v_mfma_f32_16x16x32_bf16 v[216:219], v[96:99], v[32:35], v[216:219]
    v_mfma_f32_16x16x32_bf16 v[236:239], v[96:99], v[36:39], v[236:239]
    v_mfma_f32_16x16x32_bf16 v[180:183], v[100:103], v[24:27], v[180:183]
    v_mfma_f32_16x16x32_bf16 v[200:203], v[100:103], v[28:31], v[200:203]
    v_mfma_f32_16x16x32_bf16 v[220:223], v[100:103], v[32:35], v[220:223]
    v_mfma_f32_16x16x32_bf16 v[240:243], v[100:103], v[36:39], v[240:243]
    v_mfma_f32_16x16x32_bf16 v[184:187], v[104:107], v[24:27], v[184:187]
    v_mfma_f32_16x16x32_bf16 v[204:207], v[104:107], v[28:31], v[204:207]
    v_mfma_f32_16x16x32_bf16 v[224:227], v[104:107], v[32:35], v[224:227]
    v_mfma_f32_16x16x32_bf16 v[244:247], v[104:107], v[36:39], v[244:247]
    v_mfma_f32_16x16x32_bf16 v[188:191], v[108:111], v[24:27], v[188:191]
    v_mfma_f32_16x16x32_bf16 v[208:211], v[108:111], v[28:31], v[208:211]
    v_mfma_f32_16x16x32_bf16 v[228:231], v[108:111], v[32:35], v[228:231]
    v_mfma_f32_16x16x32_bf16 v[248:251], v[108:111], v[36:39], v[248:251]
    v_mfma_f32_16x16x32_bf16 v[192:195], v[112:115], v[24:27], v[192:195]
    v_mfma_f32_16x16x32_bf16 v[212:215], v[112:115], v[28:31], v[212:215]
    v_mfma_f32_16x16x32_bf16 v[232:235], v[112:115], v[32:35], v[232:235]
    v_mfma_f32_16x16x32_bf16 v[252:255], v[112:115], v[36:39], v[252:255]
    s_or_b32 s61, s61, 1
    s_cmp_eq_u32 s61, 3
    s_cbranch_scc1 P2_FIN
    s_waitcnt vmcnt(0)
    s_branch P2_CHK
P2_O:
    s_add_u32 s27, s66, 0
    buffer_load_dwordx4 v[40:43], v2, s[40:43], s27 offen offset:0 sc1
    buffer_load_dwordx4 v[44:47], v2, s[40:43], s27 offen offset:1024 sc1
    buffer_load_dwordx4 v[48:51], v2, s[40:43], s27 offen offset:2048 sc1
    buffer_load_dwordx4 v[52:55], v2, s[40:43], s27 offen offset:3072 sc1
    s_add_u32 s27, s66, 131072
    buffer_load_dwordx4 v[56:59], v2, s[40:43], s27 offen offset:0 sc1
    buffer_load_dwordx4 v[60:63], v2, s[40:43], s27 offen offset:1024 sc1
    buffer_load_dwordx4 v[64:67], v2, s[40:43], s27 offen offset:2048 sc1
    buffer_load_dwordx4 v[68:71], v2, s[40:43], s27 offen offset:3072 sc1
    s_add_u32 s27, s68, 0
    buffer_load_dwordx4 v[156:159], v2, s[40:43], s27 offen offset:0 sc1
    buffer_load_dwordx4 v[160:163], v2, s[40:43], s27 offen offset:1024 sc1
    buffer_load_dwordx4 v[164:167], v2, s[40:43], s27 offen offset:2048 sc1
    buffer_load_dwordx4 v[168:171], v2, s[40:43], s27 offen offset:3072 sc1
    s_waitcnt vmcnt(8)
    v_mfma_f32_16x16x32_bf16 v[176:179], v[116:119], v[40:43], v[176:179]
    v_mfma_f32_16x16x32_bf16 v[196:199], v[116:119], v[44:47], v[196:199]
    v_mfma_f32_16x16x32_bf16 v[216:219], v[116:119], v[48:51], v[216:219]
    v_mfma_f32_16x16x32_bf16 v[236:239], v[116:119], v[52:55], v[236:239]
    v_mfma_f32_16x16x32_bf16 v[180:183], v[120:123], v[40:43], v[180:183]
    v_mfma_f32_16x16x32_bf16 v[200:203], v[120:123], v[44:47], v[200:203]
    v_mfma_f32_16x16x32_bf16 v[220:223], v[120:123], v[48:51], v[220:223]
    v_mfma_f32_16x16x32_bf16 v[240:243], v[120:123], v[52:55], v[240:243]
    v_mfma_f32_16x16x32_bf16 v[184:187], v[124:127], v[40:43], v[184:187]
    v_mfma_f32_16x16x32_bf16 v[204:207], v[124:127], v[44:47], v[204:207]
    v_mfma_f32_16x16x32_bf16 v[224:227], v[124:127], v[48:51], v[224:227]
    v_mfma_f32_16x16x32_bf16 v[244:247], v[124:127], v[52:55], v[244:247]
    v_mfma_f32_16x16x32_bf16 v[188:191], v[128:131], v[40:43], v[188:191]
    v_mfma_f32_16x16x32_bf16 v[208:211], v[128:131], v[44:47], v[208:211]
    v_mfma_f32_16x16x32_bf16 v[228:231], v[128:131], v[48:51], v[228:231]
    v_mfma_f32_16x16x32_bf16 v[248:251], v[128:131], v[52:55], v[248:251]
    v_mfma_f32_16x16x32_bf16 v[192:195], v[132:135], v[40:43], v[192:195]
    v_mfma_f32_16x16x32_bf16 v[212:215], v[132:135], v[44:47], v[212:215]
    v_mfma_f32_16x16x32_bf16 v[232:235], v[132:135], v[48:51], v[232:235]
    v_mfma_f32_16x16x32_bf16 v[252:255], v[132:135], v[52:55], v[252:255]
    s_cmp_ge_u32 s24, 4
    s_cbranch_scc1 WB_51
    ds_read_b128 v[116:119], v3 offset:0
    ds_read_b128 v[120:123], v3 offset:1024
    ds_read_b128 v[124:127], v3 offset:2048
    ds_read_b128 v[128:131], v3 offset:3072
WB_51:
    buffer_load_dwordx2 v[6:7], v4, s[40:43], 0 offen sc1
    s_waitcnt vmcnt(5)
    v_mfma_f32_16x16x32_bf16 v[176:179], v[136:139], v[56:59], v[176:179]
    v_mfma_f32_16x16x32_bf16 v[196:199], v[136:139], v[60:63], v[196:199]
    v_mfma_f32_16x16x32_bf16 v[216:219], v[136:139], v[64:67], v[216:219]
    v_mfma_f32_16x16x32_bf16 v[236:239], v[136:139], v[68:71], v[236:239]
    v_mfma_f32_16x16x32_bf16 v[180:183], v[140:143], v[56:59], v[180:183]
    v_mfma_f32_16x16x32_bf16 v[200:203], v[140:143], v[60:63], v[200:203]
    v_mfma_f32_16x16x32_bf16 v[220:223], v[140:143], v[64:67], v[220:223]
    v_mfma_f32_16x16x32_bf16 v[240:243], v[140:143], v[68:71], v[240:243]
    v_mfma_f32_16x16x32_bf16 v[184:187], v[144:147], v[56:59], v[184:187]
    v_mfma_f32_16x16x32_bf16 v[204:207], v[144:147], v[60:63], v[204:207]
    v_mfma_f32_16x16x32_bf16 v[224:227], v[144:147], v[64:67], v[224:227]
    v_mfma_f32_16x16x32_bf16 v[244:247], v[144:147], v[68:71], v[244:247]
    v_mfma_f32_16x16x32_bf16 v[188:191], v[148:151], v[56:59], v[188:191]
    v_mfma_f32_16x16x32_bf16 v[208:211], v[148:151], v[60:63], v[208:211]
    v_mfma_f32_16x16x32_bf16 v[228:231], v[148:151], v[64:67], v[228:231]
    v_mfma_f32_16x16x32_bf16 v[248:251], v[148:151], v[68:71], v[248:251]
    v_mfma_f32_16x16x32_bf16 v[192:195], v[152:155], v[56:59], v[192:195]
    v_mfma_f32_16x16x32_bf16 v[212:215], v[152:155], v[60:63], v[212:215]
    v_mfma_f32_16x16x32_bf16 v[232:235], v[152:155], v[64:67], v[232:235]
    v_mfma_f32_16x16x32_bf16 v[252:255], v[152:155], v[68:71], v[252:255]
    s_cmp_ge_u32 s24, 4
    s_cbranch_scc1 P2_OE
    s_waitcnt vmcnt(1) lgkmcnt(0)
    v_mfma_f32_16x16x32_bf16 v[176:179], v[72:75], v[156:159], v[176:179]
    v_mfma_f32_16x16x32_bf16 v[196:199], v[72:75], v[160:163], v[196:199]
    v_mfma_f32_16x16x32_bf16 v[216:219], v[72:75], v[164:167], v[216:219]
    v_mfma_f32_16x16x32_bf16 v[236:239], v[72:75], v[168:171], v[236:239]
    v_mfma_f32_16x16x32_bf16 v[180:183], v[116:119], v[156:159], v[180:183]
    v_mfma_f32_16x16x32_bf16 v[200:203], v[116:119], v[160:163], v[200:203]
    v_mfma_f32_16x16x32_bf16 v[220:223], v[116:119], v[164:167], v[220:223]
    v_mfma_f32_16x16x32_bf16 v[240:243], v[116:119], v[168:171], v[240:243]
    v_mfma_f32_16x16x32_bf16 v[184:187], v[120:123], v[156:159], v[184:187]
    v_mfma_f32_16x16x32_bf16 v[204:207], v[120:123], v[160:163], v[204:207]
    v_mfma_f32_16x16x32_bf16 v[224:227], v[120:123], v[164:167], v[224:227]
    v_mfma_f32_16x16x32_bf16 v[244:247], v[120:123], v[168:171], v[244:247]
    v_mfma_f32_16x16x32_bf16 v[188:191], v[124:127], v[156:159], v[188:191]
    v_mfma_f32_16x16x32_bf16 v[208:211], v[124:127], v[160:163], v[208:211]
    v_mfma_f32_16x16x32_bf16 v[228:231], v[124:127], v[164:167], v[228:231]
    v_mfma_f32_16x16x32_bf16 v[248:251], v[124:127], v[168:171], v[248:251]
    v_mfma_f32_16x16x32_bf16 v[192:195], v[128:131], v[156:159], v[192:195]
    v_mfma_f32_16x16x32_bf16 v[212:215], v[128:131], v[160:163], v[212:215]
    v_mfma_f32_16x16x32_bf16 v[232:235], v[128:131], v[164:167], v[232:235]
    v_mfma_f32_16x16x32_bf16 v[252:255], v[128:131], v[168:171], v[252:255]
P2_OE:
    s_or_b32 s61, s61, 2
    s_cmp_eq_u32 s61, 3
    s_cbranch_scc1 P2_FIN
    s_waitcnt vmcnt(0)
    s_branch P2_CHK
P2_ALL:
    s_add_u32 s27, s64, 0
    buffer_load_dwordx4 v[8:11], v2, s[40:43], s27 offen offset:0 sc1
    buffer_load_dwordx4 v[12:15], v2, s[40:43], s27 offen offset:1024 sc1
    buffer_load_dwordx4 v[16:19], v2, s[40:43], s27 offen offset:2048 sc1
    buffer_load_dwordx4 v[20:23], v2, s[40:43], s27 offen offset:3072 sc1
    s_add_u32 s27, s64, 131072
    buffer_load_dwordx4 v[24:27], v2, s[40:43], s27 offen offset:0 sc1
    buffer_load_dwordx4 v[28:31], v2, s[40:43], s27 offen offset:1024 sc1
    buffer_load_dwordx4 v[32:35], v2, s[40:43], s27 offen offset:2048 sc1
    buffer_load_dwordx4 v[36:39], v2, s[40:43], s27 offen offset:3072 sc1
    s_waitcnt vmcnt(4)
    v_mfma_f32_16x16x32_bf16 v[176:179], v[76:79], v[8:11], v[176:179]
    v_mfma_f32_16x16x32_bf16 v[196:199], v[76:79], v[12:15], v[196:199]
    s_add_u32 s70, s66, 0
    buffer_load_dwordx4 v[40:43], v2, s[40:43], s70 offen offset:0 sc1
    v_mfma_f32_16x16x32_bf16 v[216:219], v[76:79], v[16:19], v[216:219]
    v_mfma_f32_16x16x32_bf16 v[236:239], v[76:79], v[20:23], v[236:239]
    buffer_load_dwordx4 v[44:47], v2, s[40:43], s70 offen offset:1024 sc1
    v_mfma_f32_16x16x32_bf16 v[180:183], v[80:83], v[8:11], v[180:183]
    v_mfma_f32_16x16x32_bf16 v[200:203], v[80:83], v[12:15], v[200:203]
    buffer_load_dwordx4 v[48:51], v2, s[40:43], s70 offen offset:2048 sc1
    v_mfma_f32_16x16x32_bf16 v[220:223], v[80:83], v[16:19], v[220:223]
    v_mfma_f32_16x16x32_bf16 v[240:243], v[80:83], v[20:23], v[240:243]
    buffer_load_dwordx4 v[52:55], v2, s[40:43], s70 offen offset:3072 sc1
    v_mfma_f32_16x16x32_bf16 v[184:187], v[84:87], v[8:11], v[184:187]
    v_mfma_f32_16x16x32_bf16 v[204:207], v[84:87], v[12:15], v[204:207]
    s_add_u32 s70, s66, 131072
    buffer_load_dwordx4 v[56:59], v2, s[40:43], s70 offen offset:0 sc1
    v_mfma_f32_16x16x32_bf16 v[224:227], v[84:87], v[16:19], v[224:227]
    v_mfma_f32_16x16x32_bf16 v[244:247], v[84:87], v[20:23], v[244:247]
    buffer_load_dwordx4 v[60:63], v2, s[40:43], s70 offen offset:1024 sc1
    v_mfma_f32_16x16x32_bf16 v[188:191], v[88:91], v[8:11], v[188:191]
    v_mfma_f32_16x16x32_bf16 v[208:211], v[88:91], v[12:15], v[208:211]
    buffer_load_dwordx4 v[64:67], v2, s[40:43], s70 offen offset:2048 sc1
    v_mfma_f32_16x16x32_bf16 v[228:231], v[88:91], v[16:19], v[228:231]
    v_mfma_f32_16x16x32_bf16 v[248:251], v[88:91], v[20:23], v[248:251]
    buffer_load_dwordx4 v[68:71], v2, s[40:43], s70 offen offset:3072 sc1
    v_mfma_f32_16x16x32_bf16 v[192:195], v[92:95], v[8:11], v[192:195]
    v_mfma_f32_16x16x32_bf16 v[212:215], v[92:95], v[12:15], v[212:215]
    v_mfma_f32_16x16x32_bf16 v[232:235], v[92:95], v[16:19], v[232:235]
    v_mfma_f32_16x16x32_bf16 v[252:255], v[92:95], v[20:23], v[252:255]
    s_waitcnt vmcnt(8)
    s_cmp_ge_u32 s24, 4
    s_cbranch_scc1 WB_52
    s_mov_b32 s70, s68
    buffer_load_dwordx4 v[156:159], v2, s[40:43], s70 offen offset:0 sc1
    buffer_load_dwordx4 v[160:163], v2, s[40:43], s70 offen offset:1024 sc1
    buffer_load_dwordx4 v[164:167], v2, s[40:43], s70 offen offset:2048 sc1
    buffer_load_dwordx4 v[168:171], v2, s[40:43], s70 offen offset:3072 sc1
WB_52:
    v_mfma_f32_16x16x32_bf16 v[176:179], v[96:99], v[24:27], v[176:179]
    v_mfma_f32_16x16x32_bf16 v[196:199], v[96:99], v[28:31], v[196:199]
    v_mfma_f32_16x16x32_bf16 v[216:219], v[96:99], v[32:35], v[216:219]
    v_mfma_f32_16x16x32_bf16 v[236:239], v[96:99], v[36:39], v[236:239]
    v_mfma_f32_16x16x32_bf16 v[180:183], v[100:103], v[24:27], v[180:183]
    v_mfma_f32_16x16x32_bf16 v[200:203], v[100:103], v[28:31], v[200:203]
    v_mfma_f32_16x16x32_bf16 v[220:223], v[100:103], v[32:35], v[220:223]
    v_mfma_f32_16x16x32_bf16 v[240:243], v[100:103], v[36:39], v[240:243]
    v_mfma_f32_16x16x32_bf16 v[184:187], v[104:107], v[24:27], v[184:187]
    v_mfma_f32_16x16x32_bf16 v[204:207], v[104:107], v[28:31], v[204:207]
    v_mfma_f32_16x16x32_bf16 v[224:227], v[104:107], v[32:35], v[224:227]
    v_mfma_f32_16x16x32_bf16 v[244:247], v[104:107], v[36:39], v[244:247]
    v_mfma_f32_16x16x32_bf16 v[188:191], v[108:111], v[24:27], v[188:191]
    v_mfma_f32_16x16x32_bf16 v[208:211], v[108:111], v[28:31], v[208:211]
    v_mfma_f32_16x16x32_bf16 v[228:231], v[108:111], v[32:35], v[228:231]
    v_mfma_f32_16x16x32_bf16 v[248:251], v[108:111], v[36:39], v[248:251]
    v_mfma_f32_16x16x32_bf16 v[192:195], v[112:115], v[24:27], v[192:195]
    v_mfma_f32_16x16x32_bf16 v[212:215], v[112:115], v[28:31], v[212:215]
    v_mfma_f32_16x16x32_bf16 v[232:235], v[112:115], v[32:35], v[232:235]
    v_mfma_f32_16x16x32_bf16 v[252:255], v[112:115], v[36:39], v[252:255]
    s_cmp_ge_u32 s24, 4
    s_cbranch_scc0 P2_AE
    s_waitcnt vmcnt(4)
    v_mfma_f32_16x16x32_bf16 v[176:179], v[116:119], v[40:43], v[176:179]
    v_mfma_f32_16x16x32_bf16 v[196:199], v[116:119], v[44:47], v[196:199]
    v_mfma_f32_16x16x32_bf16 v[216:219], v[116:119], v[48:51], v[216:219]
    v_mfma_f32_16x16x32_bf16 v[236:239], v[116:119], v[52:55], v[236:239]
    v_mfma_f32_16x16x32_bf16 v[180:183], v[120:123], v[40:43], v[180:183]
    v_mfma_f32_16x16x32_bf16 v[200:203], v[120:123], v[44:47], v[200:203]
    v_mfma_f32_16x16x32_bf16 v[220:223], v[120:123], v[48:51], v[220:223]
    v_mfma_f32_16x16x32_bf16 v[240:243], v[120:123], v[52:55], v[240:243]
    v_mfma_f32_16x16x32_bf16 v[184:187], v[124:127], v[40:43], v[184:187]
    v_mfma_f32_16x16x32_bf16 v[204:207], v[124:127], v[44:47], v[204:207]
    v_mfma_f32_16x16x32_bf16 v[224:227], v[124:127], v[48:51], v[224:227]
    v_mfma_f32_16x16x32_bf16 v[244:247], v[124:127], v[52:55], v[244:247]
    v_mfma_f32_16x16x32_bf16 v[188:191], v[128:131], v[40:43], v[188:191]
    v_mfma_f32_16x16x32_bf16 v[208:211], v[128:131], v[44:47], v[208:211]
    v_mfma_f32_16x16x32_bf16 v[228:231], v[128:131], v[48:51], v[228:231]
    v_mfma_f32_16x16x32_bf16 v[248:251], v[128:131], v[52:55], v[248:251]
    v_mfma_f32_16x16x32_bf16 v[192:195], v[132:135], v[40:43], v[192:195]
    v_mfma_f32_16x16x32_bf16 v[212:215], v[132:135], v[44:47], v[212:215]
    v_mfma_f32_16x16x32_bf16 v[232:235], v[132:135], v[48:51], v[232:235]
    v_mfma_f32_16x16x32_bf16 v[252:255], v[132:135], v[52:55], v[252:255]
    s_waitcnt vmcnt(0)
    v_mfma_f32_16x16x32_bf16 v[176:179], v[136:139], v[56:59], v[176:179]
    v_mfma_f32_16x16x32_bf16 v[196:199], v[136:139], v[60:63], v[196:199]
    v_mfma_f32_16x16x32_bf16 v[216:219], v[136:139], v[64:67], v[216:219]
    v_mfma_f32_16x16x32_bf16 v[236:239], v[136:139], v[68:71], v[236:239]
    v_mfma_f32_16x16x32_bf16 v[180:183], v[140:143], v[56:59], v[180:183]
    v_mfma_f32_16x16x32_bf16 v[200:203], v[140:143], v[60:63], v[200:203]
    v_mfma_f32_16x16x32_bf16 v[220:223], v[140:143], v[64:67], v[220:223]
    v_mfma_f32_16x16x32_bf16 v[240:243], v[140:143], v[68:71], v[240:243]
    v_mfma_f32_16x16x32_bf16 v[184:187], v[144:147], v[56:59], v[184:187]
    v_mfma_f32_16x16x32_bf16 v[204:207], v[144:147], v[60:63], v[204:207]
    v_mfma_f32_16x16x32_bf16 v[224:227], v[144:147], v[64:67], v[224:227]
    v_mfma_f32_16x16x32_bf16 v[244:247], v[144:147], v[68:71], v[244:247]
    v_mfma_f32_16x16x32_bf16 v[188:191], v[148:151], v[56:59], v[188:191]
    v_mfma_f32_16x16x32_bf16 v[208:211], v[148:151], v[60:63], v[208:211]
    v_mfma_f32_16x16x32_bf16 v[228:231], v[148:151], v[64:67], v[228:231]
    v_mfma_f32_16x16x32_bf16 v[248:251], v[148:151], v[68:71], v[248:251]
    v_mfma_f32_16x16x32_bf16 v[192:195], v[152:155], v[56:59], v[192:195]
    v_mfma_f32_16x16x32_bf16 v[212:215], v[152:155], v[60:63], v[212:215]
    v_mfma_f32_16x16x32_bf16 v[232:235], v[152:155], v[64:67], v[232:235]
    v_mfma_f32_16x16x32_bf16 v[252:255], v[152:155], v[68:71], v[252:255]
    s_branch P2_FIN
P2_AE:
    s_waitcnt vmcnt(8)
    v_mfma_f32_16x16x32_bf16 v[176:179], v[116:119], v[40:43], v[176:179]
    v_mfma_f32_16x16x32_bf16 v[196:199], v[116:119], v[44:47], v[196:199]
    v_mfma_f32_16x16x32_bf16 v[216:219], v[116:119], v[48:51], v[216:219]
    v_mfma_f32_16x16x32_bf16 v[236:239], v[116:119], v[52:55], v[236:239]
    v_mfma_f32_16x16x32_bf16 v[180:183], v[120:123], v[40:43], v[180:183]
    v_mfma_f32_16x16x32_bf16 v[200:203], v[120:123], v[44:47], v[200:203]
    v_mfma_f32_16x16x32_bf16 v[220:223], v[120:123], v[48:51], v[220:223]
    v_mfma_f32_16x16x32_bf16 v[240:243], v[120:123], v[52:55], v[240:243]
    v_mfma_f32_16x16x32_bf16 v[184:187], v[124:127], v[40:43], v[184:187]
    v_mfma_f32_16x16x32_bf16 v[204:207], v[124:127], v[44:47], v[204:207]
    v_mfma_f32_16x16x32_bf16 v[224:227], v[124:127], v[48:51], v[224:227]
    v_mfma_f32_16x16x32_bf16 v[244:247], v[124:127], v[52:55], v[244:247]
    v_mfma_f32_16x16x32_bf16 v[188:191], v[128:131], v[40:43], v[188:191]
    v_mfma_f32_16x16x32_bf16 v[208:211], v[128:131], v[44:47], v[208:211]
    v_mfma_f32_16x16x32_bf16 v[228:231], v[128:131], v[48:51], v[228:231]
    v_mfma_f32_16x16x32_bf16 v[248:251], v[128:131], v[52:55], v[248:251]
    v_mfma_f32_16x16x32_bf16 v[192:195], v[132:135], v[40:43], v[192:195]
    v_mfma_f32_16x16x32_bf16 v[212:215], v[132:135], v[44:47], v[212:215]
    v_mfma_f32_16x16x32_bf16 v[232:235], v[132:135], v[48:51], v[232:235]
    v_mfma_f32_16x16x32_bf16 v[252:255], v[132:135], v[52:55], v[252:255]
    s_cmp_ge_u32 s24, 4
    s_cbranch_scc1 WB_53
    ds_read_b128 v[116:119], v3 offset:0
    ds_read_b128 v[120:123], v3 offset:1024
    ds_read_b128 v[124:127], v3 offset:2048
    ds_read_b128 v[128:131], v3 offset:3072
WB_53:
    s_waitcnt vmcnt(4)
    v_mfma_f32_16x16x32_bf16 v[176:179], v[136:139], v[56:59], v[176:179]
    v_mfma_f32_16x16x32_bf16 v[196:199], v[136:139], v[60:63], v[196:199]
    v_mfma_f32_16x16x32_bf16 v[216:219], v[136:139], v[64:67], v[216:219]
    v_mfma_f32_16x16x32_bf16 v[236:239], v[136:139], v[68:71], v[236:239]
    v_mfma_f32_16x16x32_bf16 v[180:183], v[140:143], v[56:59], v[180:183]
    v_mfma_f32_16x16x32_bf16 v[200:203], v[140:143], v[60:63], v[200:203]
    v_mfma_f32_16x16x32_bf16 v[220:223], v[140:143], v[64:67], v[220:223]
    v_mfma_f32_16x16x32_bf16 v[240:243], v[140:143], v[68:71], v[240:243]
    v_mfma_f32_16x16x32_bf16 v[184:187], v[144:147], v[56:59], v[184:187]
    v_mfma_f32_16x16x32_bf16 v[204:207], v[144:147], v[60:63], v[204:207]
    v_mfma_f32_16x16x32_bf16 v[224:227], v[144:147], v[64:67], v[224:227]
    v_mfma_f32_16x16x32_bf16 v[244:247], v[144:147], v[68:71], v[244:247]
    v_mfma_f32_16x16x32_bf16 v[188:191], v[148:151], v[56:59], v[188:191]
    v_mfma_f32_16x16x32_bf16 v[208:211], v[148:151], v[60:63], v[208:211]
    v_mfma_f32_16x16x32_bf16 v[228:231], v[148:151], v[64:67], v[228:231]
    v_mfma_f32_16x16x32_bf16 v[248:251], v[148:151], v[68:71], v[248:251]
    v_mfma_f32_16x16x32_bf16 v[192:195], v[152:155], v[56:59], v[192:195]
    v_mfma_f32_16x16x32_bf16 v[212:215], v[152:155], v[60:63], v[212:215]
    v_mfma_f32_16x16x32_bf16 v[232:235], v[152:155], v[64:67], v[232:235]
    v_mfma_f32_16x16x32_bf16 v[252:255], v[152:155], v[68:71], v[252:255]
    s_cmp_ge_u32 s24, 4
    s_cbranch_scc1 P2_FIN
    s_waitcnt vmcnt(0) lgkmcnt(0)
    v_mfma_f32_16x16x32_bf16 v[176:179], v[72:75], v[156:159], v[176:179]
    v_mfma_f32_16x16x32_bf16 v[196:199], v[72:75], v[160:163], v[196:199]
    v_mfma_f32_16x16x32_bf16 v[216:219], v[72:75], v[164:167], v[216:219]
    v_mfma_f32_16x16x32_bf16 v[236:239], v[72:75], v[168:171], v[236:239]
    v_mfma_f32_16x16x32_bf16 v[180:183], v[116:119], v[156:159], v[180:183]
    v_mfma_f32_16x16x32_bf16 v[200:203], v[116:119], v[160:163], v[200:203]
    v_mfma_f32_16x16x32_bf16 v[220:223], v[116:119], v[164:167], v[220:223]
    v_mfma_f32_16x16x32_bf16 v[240:243], v[116:119], v[168:171], v[240:243]
    v_mfma_f32_16x16x32_bf16 v[184:187], v[120:123], v[156:159], v[184:187]
    v_mfma_f32_16x16x32_bf16 v[204:207], v[120:123], v[160:163], v[204:207]
    v_mfma_f32_16x16x32_bf16 v[224:227], v[120:123], v[164:167], v[224:227]
    v_mfma_f32_16x16x32_bf16 v[244:247], v[120:123], v[168:171], v[244:247]
    v_mfma_f32_16x16x32_bf16 v[188:191], v[124:127], v[156:159], v[188:191]
    v_mfma_f32_16x16x32_bf16 v[208:211], v[124:127], v[160:163], v[208:211]
    v_mfma_f32_16x16x32_bf16 v[228:231], v[124:127], v[164:167], v[228:231]
    v_mfma_f32_16x16x32_bf16 v[248:251], v[124:127], v[168:171], v[248:251]
    v_mfma_f32_16x16x32_bf16 v[192:195], v[128:131], v[156:159], v[192:195]
    v_mfma_f32_16x16x32_bf16 v[212:215], v[128:131], v[160:163], v[212:215]
    v_mfma_f32_16x16x32_bf16 v[232:235], v[128:131], v[164:167], v[232:235]
    v_mfma_f32_16x16x32_bf16 v[252:255], v[128:131], v[168:171], v[252:255]
P2_FIN:
    v_mov_b32 v3, s75
    v_mov_b32 v90, s71
    ds_read_b32 v88, v3
    ds_read_b32 v89, v90
    buffer_load_dwordx2 v[76:77], v5, s[32:35], s52 offen
    buffer_load_dwordx2 v[78:79], v5, s[32:35], s53 offen
    buffer_load_dwordx2 v[80:81], v5, s[32:35], s54 offen
    v_add_u32 v4, s55, v2
    v_add_u32 v84, s56, v2
    v_add_u32 v85, s57, v2

    v_cvt_pk_bf16_f32 v96, v176, v177
    v_cvt_pk_bf16_f32 v97, v178, v179
    v_cvt_pk_bf16_f32 v98, v196, v197
    v_cvt_pk_bf16_f32 v99, v198, v199
    v_cvt_pk_bf16_f32 v116, v216, v217
    v_cvt_pk_bf16_f32 v117, v218, v219
    v_cvt_pk_bf16_f32 v118, v236, v237
    v_cvt_pk_bf16_f32 v119, v238, v239
    s_waitcnt lgkmcnt(0)
    v_min_u32 v88, v88, v89
    s_nop 0
    v_readfirstlane_b32 s27, v88
    s_nop 1
    s_cmp_ge_u32 s27, 4
    s_cbranch_scc1 P2_NS
LS_54:
    ds_read_b32 v88, v3 offset:0
    s_waitcnt lgkmcnt(0)
    v_readfirstlane_b32 s27, v88
    s_nop 1
    s_cmp_ge_u32 s27, 4
    s_cbranch_scc1 LS_54_D
    s_sleep 2
    s_branch LS_54

LS_54_D:
LS_55:
    ds_read_b32 v88, v90 offset:0
    s_waitcnt lgkmcnt(0)
    v_readfirstlane_b32 s27, v88
    s_nop 1
    s_cmp_ge_u32 s27, 4
    s_cbranch_scc1 LS_55_D
    s_sleep 2
    s_branch LS_55

LS_55_D:
P2_NS:
    ds_write_b128 v4, v[96:99] offset:0
    ds_write_b128 v4, v[116:119] offset:5120
    v_cvt_pk_bf16_f32 v100, v180, v181
    v_cvt_pk_bf16_f32 v101, v182, v183
    v_cvt_pk_bf16_f32 v102, v200, v201
    v_cvt_pk_bf16_f32 v103, v202, v203
    ds_write_b128 v4, v[100:103] offset:1024
    v_cvt_pk_bf16_f32 v120, v220, v221
    v_cvt_pk_bf16_f32 v121, v222, v223
    v_cvt_pk_bf16_f32 v122, v240, v241
    v_cvt_pk_bf16_f32 v123, v242, v243
    ds_write_b128 v4, v[120:123] offset:6144
    v_cvt_pk_bf16_f32 v104, v184, v185
    v_cvt_pk_bf16_f32 v105, v186, v187
    v_cvt_pk_bf16_f32 v106, v204, v205
    v_cvt_pk_bf16_f32 v107, v206, v207
    ds_write_b128 v4, v[104:107] offset:2048
    v_cvt_pk_bf16_f32 v124, v224, v225
    v_cvt_pk_bf16_f32 v125, v226, v227
    v_cvt_pk_bf16_f32 v126, v244, v245
    v_cvt_pk_bf16_f32 v127, v246, v247
    ds_write_b128 v4, v[124:127] offset:7168
    v_cvt_pk_bf16_f32 v108, v188, v189
    v_cvt_pk_bf16_f32 v109, v190, v191
    v_cvt_pk_bf16_f32 v110, v208, v209
    v_cvt_pk_bf16_f32 v111, v210, v211
    ds_write_b128 v4, v[108:111] offset:3072
    v_cvt_pk_bf16_f32 v128, v228, v229
    v_cvt_pk_bf16_f32 v129, v230, v231
    v_cvt_pk_bf16_f32 v130, v248, v249
    v_cvt_pk_bf16_f32 v131, v250, v251
    ds_write_b128 v4, v[128:131] offset:8192
    v_cvt_pk_bf16_f32 v112, v192, v193
    v_cvt_pk_bf16_f32 v113, v194, v195
    v_cvt_pk_bf16_f32 v114, v212, v213
    v_cvt_pk_bf16_f32 v115, v214, v215
    ds_write_b128 v4, v[112:115] offset:4096
    v_cvt_pk_bf16_f32 v132, v232, v233
    v_cvt_pk_bf16_f32 v133, v234, v235
    v_cvt_pk_bf16_f32 v134, v252, v253
    v_cvt_pk_bf16_f32 v135, v254, v255
    ds_write_b128 v4, v[132:135] offset:9216
    v_bfe_u32 v88, v1, 2, 2
    v_lshrrev_b32 v89, 4, v1
    v_cmp_eq_u32 vcc, v88, v89
    v_and_b32 v88, 1, v1
    v_lshlrev_b32 v88, 4, v88
    v_mov_b32 v89, 0x3f80
    v_lshlrev_b32 v89, v88, v89
    v_cndmask_b32 v89, 0, v89, vcc
    v_and_b32 v88, 2, v1
    v_cmp_eq_u32 vcc, 0, v88
    v_add_u32 v86, 8, v84
    s_nop 0
    v_cndmask_b32 v92, 0, v89, vcc
    v_cndmask_b32 v93, v89, 0, vcc
    v_cndmask_b32 v94, 0, v89, vcc
    v_cndmask_b32 v95, v89, 0, vcc
    s_waitcnt lgkmcnt(0)
    s_barrier

    ds_read2st64_b64 v[176:179], v84 offset0:0 offset1:20
    ds_read2st64_b64 v[180:183], v86 offset0:0 offset1:20
    ds_read2st64_b64 v[184:187], v85 offset0:0 offset1:20
    ds_read2st64_b64 v[188:191], v84 offset0:40 offset1:60
    ds_read2st64_b64 v[192:195], v86 offset0:40 offset1:60
    ds_read2st64_b64 v[196:199], v85 offset0:40 offset1:60
    ds_read2st64_b64 v[200:203], v84 offset0:80 offset1:100
    ds_read2st64_b64 v[204:207], v86 offset0:80 offset1:100
    ds_read2st64_b64 v[208:211], v85 offset0:80 offset1:100
    ds_read2st64_b64 v[212:215], v84 offset0:120 offset1:140
    ds_read2st64_b64 v[216:219], v86 offset0:120 offset1:140
    ds_read2st64_b64 v[220:223], v85 offset0:120 offset1:140
    s_waitcnt vmcnt(0)
    v_lshlrev_b32 v96, 16, v76
    v_and_b32 v97, 0xffff0000, v76
    v_lshlrev_b32 v98, 16, v77
    v_and_b32 v99, 0xffff0000, v77
    v_lshlrev_b32 v100, 16, v78
    v_and_b32 v101, 0xffff0000, v78
    v_lshlrev_b32 v102, 16, v79
    v_and_b32 v103, 0xffff0000, v79
    v_lshlrev_b32 v104, 16, v80
    v_and_b32 v105, 0xffff0000, v80
    v_lshlrev_b32 v106, 16, v81
    v_and_b32 v107, 0xffff0000, v81
    s_waitcnt lgkmcnt(9)
    s_nop 0
    v_mfma_f32_16x16x32_bf16 v[96:99], v[92:95], v[176:179], v[96:99]
    v_mfma_f32_16x16x32_bf16 v[100:103], v[92:95], v[180:183], v[100:103]
    v_mfma_f32_16x16x32_bf16 v[104:107], v[92:95], v[184:187], v[104:107]
    s_waitcnt lgkmcnt(6)
    v_mfma_f32_16x16x32_bf16 v[96:99], v[92:95], v[188:191], v[96:99]
    v_mfma_f32_16x16x32_bf16 v[100:103], v[92:95], v[192:195], v[100:103]
    v_mfma_f32_16x16x32_bf16 v[104:107], v[92:95], v[196:199], v[104:107]
    s_waitcnt lgkmcnt(3)
    v_mfma_f32_16x16x32_bf16 v[96:99], v[92:95], v[200:203], v[96:99]
    v_mfma_f32_16x16x32_bf16 v[100:103], v[92:95], v[204:207], v[100:103]
    v_mfma_f32_16x16x32_bf16 v[104:107], v[92:95], v[208:211], v[104:107]
    s_waitcnt lgkmcnt(0)
    v_mfma_f32_16x16x32_bf16 v[96:99], v[92:95], v[212:215], v[96:99]
    v_mfma_f32_16x16x32_bf16 v[100:103], v[92:95], v[216:219], v[100:103]
    v_mfma_f32_16x16x32_bf16 v[104:107], v[92:95], v[220:223], v[104:107]
    s_nop 5
    v_cvt_pk_bf16_f32 v112, v96, v97
    v_cvt_pk_bf16_f32 v113, v98, v99
    buffer_store_dwordx2 v[112:113], v5, s[48:51], s52 offen
    v_cvt_pk_bf16_f32 v114, v100, v101
    v_cvt_pk_bf16_f32 v115, v102, v103
    buffer_store_dwordx2 v[114:115], v5, s[48:51], s53 offen
    v_cvt_pk_bf16_f32 v116, v104, v105
    v_cvt_pk_bf16_f32 v117, v106, v107
    buffer_store_dwordx2 v[116:117], v5, s[48:51], s54 offen
K_END:
    s_endpgm
.section .rodata,"a"
.p2align 6
.amdhsa_kernel parallel_sum__linear_attn_block__glu_gated_bilinear__prompt_kernel
  .amdhsa_next_free_vgpr 256
  .amdhsa_next_free_sgpr 102
  .amdhsa_accum_offset 256
  .amdhsa_group_segment_fixed_size 0
  .amdhsa_kernarg_size 80
  .amdhsa_user_sgpr_count 2
  .amdhsa_user_sgpr_kernarg_segment_ptr 1
  .amdhsa_system_sgpr_workgroup_id_x 1
.end_amdhsa_kernel
```
